```python
import torch

def _softmax(x, axis=-1):
    return torch.softmax(x, dim=axis)

def _gelu(x):
    return torch.nn.functional.gelu(x, approximate='tanh')

def _silu(x):
    return torch.nn.functional.silu(x)

def _sigmoid(x):
    return torch.sigmoid(x)

def _layernorm(x, axis=-1, eps=1e-05):
    m = x.mean(dim=axis, keepdim=True)
    v = x.var(dim=axis, keepdim=True, unbiased=False)
    return (x - m) / torch.sqrt(v + eps)

def _scatter_add(tgt, idx, src, axis=0):
    return tgt.clone().index_add_(axis, idx, src)

def _segment_sum(src, seg, n):
    out = torch.zeros((n,) + src.shape[1:], dtype=src.dtype)
    return out.index_add_(0, seg, src)

def _pad(x, pw):
    flat = tuple((v for pair in reversed(pw) for v in pair))
    return torch.nn.functional.pad(x, flat)
kernel_name = 'recurrent_scan__memory_aug_recurrent_mem_tr__dense_activation_squared_relu__prompt'

def setup_inputs():

    _w = lambda a: (lambda t: t.to(torch.bfloat16) if t.is_floating_point() else t)(torch.as_tensor(a))

    def _A_setup():
        B, S, Dm = (1, 2048, 448)
        H, Dh = (16, 256)
        M, seg = (8, 32)
        seg = min(seg, S)
        S = S // seg * seg
        return {'x': _w((lambda *s: torch.randn(*s, dtype=torch.bfloat16) * 0.05)(B, S, Dm)), 'mem0': _w((lambda *s: torch.randn(*s, dtype=torch.bfloat16) * 0.05)(B, M, Dm)), 'Wq': _w((lambda *s: torch.randn(*s, dtype=torch.bfloat16) * 1.6)(Dm, H, Dh) * Dm ** (-0.5)), 'Wk': _w((lambda *s: torch.randn(*s, dtype=torch.bfloat16) * 1.6)(Dm, H, Dh) * Dm ** (-0.5)), 'Wv': _w((lambda *s: torch.randn(*s, dtype=torch.bfloat16) * 0.05)(Dm, H, Dh) * Dm ** (-0.5)), 'Wo': _w((lambda *s: torch.randn(*s, dtype=torch.bfloat16) * 0.05)(H, Dh, Dm) * (H * Dh) ** (-0.5)), 'seg_len': seg}
    _A_in = _A_setup()

    def _B_setup():
        B, S, D, F = (1, 2048, 448, 1792)
        return {'x': _w((lambda *s: torch.randn(*s, dtype=torch.bfloat16) * 0.05)(B, S, D)), 'w1': _w((lambda *s: torch.randn(*s, dtype=torch.bfloat16) * 0.05)(D, F)), 'b1': _w((lambda *s: torch.randn(*s, dtype=torch.bfloat16) * 0.4)(F)), 'w2': _w((lambda *s: torch.randn(*s, dtype=torch.bfloat16) * 0.05)(F, D)), 'b2': _w((lambda *s: torch.randn(*s, dtype=torch.bfloat16) * 1.6)(D))}
    _B_in = _B_setup()
    return {'A_x': _A_in['x'], 'A_mem0': _A_in['mem0'], 'A_Wq': _A_in['Wq'], 'A_Wk': _A_in['Wk'], 'A_Wv': _A_in['Wv'], 'A_Wo': _A_in['Wo'], 'A_seg_len': _A_in['seg_len'], 'B_x': _B_in['x'], 'B_w1': _B_in['w1'], 'B_b1': _B_in['b1'], 'B_w2': _B_in['w2'], 'B_b2': _B_in['b2']}

def reference(A_x, A_mem0, A_Wq, A_Wk, A_Wv, A_Wo, A_seg_len, B_x, B_w1, B_b1, B_w2, B_b2):

    def _A_ref(x, mem0, Wq, Wk, Wv, Wo, seg_len):
        B, S, Dm = x.shape
        H, Dh = (Wq.shape[1], Wq.shape[2])
        M = mem0.shape[1]
        scale = Dh ** (-0.5)
        n_seg = S // seg_len
        L = M + seg_len
        idx = torch.arange(L)
        mask = (idx[:, None] < M) | (idx[:, None] >= idx[None, :])
        mem = mem0
        outs = []
        for s in range(n_seg):
            xs = x[:, s * seg_len:(s + 1) * seg_len, :].clone()
            h = torch.concatenate([mem, xs], axis=1)
            q = torch.einsum('btd,dhe->bhte', h, Wq)
            k = torch.einsum('btd,dhe->bhte', h, Wk)
            v = torch.einsum('btd,dhe->bhte', h, Wv)
            scores = torch.einsum('bhqe,bhke->bhqk', q, k) * scale
            scores = torch.where(mask[None, None], scores, -1000000000.0)
            p = _softmax(scores, axis=-1)
            o = torch.einsum('bhqk,bhke->bhqe', p, v)
            o = torch.einsum('bhte,hed->btd', o, Wo)
            mem = o[:, :M, :].clone()
            outs.append(o[:, M:, :])
        return torch.concatenate(outs, axis=1)

    def _B_ref(x, w1, b1, w2, b2):
        h = torch.einsum('bsd,df->bsf', x, w1) + b1
        zero = torch.zeros_like(h)
        r = torch.where(h > zero, h, zero)
        h = r * r
        out = torch.einsum('bsf,fd->bsd', h, w2) + b2
        return out
    x = A_x
    xn = _layernorm(x, axis=-1)
    s = _A_ref(xn, A_mem0, A_Wq, A_Wk, A_Wv, A_Wo, A_seg_len)
    g = _silu(_B_ref(xn, B_w1, B_b1, B_w2, B_b2))
    return x + s * g
```

```asm
; @launch grid=(256,1,1) block=(256,1,1) lds=163840
.amdgcn_target "amdgcn-amd-amdhsa--gfx950"
.text
.globl recurrent_scan__memory_aug_recurrent_mem_tr__dense_activation_squared_relu__prompt_kernel
.p2align 8
.type recurrent_scan__memory_aug_recurrent_mem_tr__dense_activation_squared_relu__prompt_kernel,@function
recurrent_scan__memory_aug_recurrent_mem_tr__dense_activation_squared_relu__prompt_kernel:
M_start:
s_cmp_ge_u32 s2, 256
s_cbranch_scc1 M_exit0
s_load_dwordx4 s[28:31], s[0:1], 0
s_load_dwordx8 s[36:43], s[0:1], 16
s_load_dwordx2 s[4:5], s[0:1], 112
s_load_dwordx2 s[48:49], s[0:1], 104
s_getreg_b32 s54, hwreg(HW_REG_XCC_ID, 0, 3)
v_lshrrev_b32 v1, 6, v0
s_nop 0
v_readfirstlane_b32 s9, v1
v_and_b32 v0, 63, v0
s_waitcnt lgkmcnt(0)
s_add_u32 s4, s4, 0
s_addc_u32 s5, s5, 0
s_mov_b32 s6, 268435456
s_mov_b32 s7, 0x20000
s_mov_b32 s50, 256
s_mov_b32 s51, 0x20000
s_lshl_b32 s54, s54, 2
s_lshr_b32 s54, 0x43210765, s54
s_and_b32 s54, s54, 7
s_mov_b32 s12, s54
v_mov_b32 v2, 0x27c00
s_cmp_lg_u32 s9, 0
s_cbranch_scc1 M_noat
v_mov_b32 v249, 1
s_lshl_b32 s11, s12, 5
s_mov_b64 exec, 1
buffer_atomic_add v249, off, s[48:51], s11 sc0 sc1
s_mov_b64 exec, -1
M_noat:
s_getpc_b64 s[20:21]
M_pc:
s_sub_u32 s20, s20, M_pc-M_start
s_subb_u32 s21, s21, 0
s_mov_b32 s22, M_end-M_start
s_mov_b32 s23, 0x20000
s_lshr_b32 s11, s2, 3
s_lshl_b32 s11, s11, 2
s_add_u32 s11, s11, s9
s_lshl_b32 s11, s11, 10
v_lshlrev_b32 v5, 4, v0
buffer_load_dword v251, v5, s[20:23], s11 offen
s_cmp_lg_u32 s9, 0
s_cbranch_scc1 M_ranked
s_waitcnt vmcnt(1)
v_readfirstlane_b32 s3, v249
v_and_b32 v4, 7, v0
v_lshlrev_b32 v4, 5, v4
s_lshl_b32 s11, s12, 5
s_cmp_lt_u32 s3, 32
s_cselect_b32 s15, 0, 1
s_add_u32 s3, s3, s11
s_cmp_eq_u32 s15, 0
s_cbranch_scc1 M_have
v_mov_b32 v3, 1
s_mov_b64 exec, 1
buffer_atomic_add v3, off, s[48:51], 0 offset:4 sc0 sc1
s_waitcnt vmcnt(0)
s_mov_b64 exec, -1
v_readfirstlane_b32 s15, v3
s_mov_b32 s19, 0x40000
M_ovf:
buffer_load_dword v3, v4, s[48:51], 0 offen sc1
s_sub_u32 s19, s19, 1
s_cbranch_scc1 M_exit0
s_waitcnt vmcnt(0)
v_readlane_b32 s47, v3, 0
s_mov_b32 s46, s47
v_readlane_b32 s11, v3, 1
s_add_u32 s46, s46, s11
v_readlane_b32 s11, v3, 2
s_add_u32 s46, s46, s11
v_readlane_b32 s11, v3, 3
s_add_u32 s46, s46, s11
v_readlane_b32 s11, v3, 4
s_add_u32 s46, s46, s11
v_readlane_b32 s11, v3, 5
s_add_u32 s46, s46, s11
v_readlane_b32 s11, v3, 6
s_add_u32 s46, s46, s11
v_readlane_b32 s11, v3, 7
s_add_u32 s46, s46, s11
s_cmp_lt_u32 s46, 256
s_cbranch_scc1 M_ovf_again
s_mov_b32 s3, 0
v_readlane_b32 s11, v3, 0
s_min_u32 s11, s11, 32
s_sub_u32 s16, 32, s11
s_cmp_lt_u32 s15, s16
s_cbranch_scc0 M_nx0
s_add_u32 s3, s11, s15
s_add_u32 s3, s3, 0
s_branch M_have
M_nx0:
s_sub_u32 s15, s15, s16
v_readlane_b32 s11, v3, 1
s_min_u32 s11, s11, 32
s_sub_u32 s16, 32, s11
s_cmp_lt_u32 s15, s16
s_cbranch_scc0 M_nx1
s_add_u32 s3, s11, s15
s_add_u32 s3, s3, 32
s_branch M_have
M_nx1:
s_sub_u32 s15, s15, s16
v_readlane_b32 s11, v3, 2
s_min_u32 s11, s11, 32
s_sub_u32 s16, 32, s11
s_cmp_lt_u32 s15, s16
s_cbranch_scc0 M_nx2
s_add_u32 s3, s11, s15
s_add_u32 s3, s3, 64
s_branch M_have
M_nx2:
s_sub_u32 s15, s15, s16
v_readlane_b32 s11, v3, 3
s_min_u32 s11, s11, 32
s_sub_u32 s16, 32, s11
s_cmp_lt_u32 s15, s16
s_cbranch_scc0 M_nx3
s_add_u32 s3, s11, s15
s_add_u32 s3, s3, 96
s_branch M_have
M_nx3:
s_sub_u32 s15, s15, s16
v_readlane_b32 s11, v3, 4
s_min_u32 s11, s11, 32
s_sub_u32 s16, 32, s11
s_cmp_lt_u32 s15, s16
s_cbranch_scc0 M_nx4
s_add_u32 s3, s11, s15
s_add_u32 s3, s3, 128
s_branch M_have
M_nx4:
s_sub_u32 s15, s15, s16
v_readlane_b32 s11, v3, 5
s_min_u32 s11, s11, 32
s_sub_u32 s16, 32, s11
s_cmp_lt_u32 s15, s16
s_cbranch_scc0 M_nx5
s_add_u32 s3, s11, s15
s_add_u32 s3, s3, 160
s_branch M_have
M_nx5:
s_sub_u32 s15, s15, s16
v_readlane_b32 s11, v3, 6
s_min_u32 s11, s11, 32
s_sub_u32 s16, 32, s11
s_cmp_lt_u32 s15, s16
s_cbranch_scc0 M_nx6
s_add_u32 s3, s11, s15
s_add_u32 s3, s3, 192
s_branch M_have
M_nx6:
s_sub_u32 s15, s15, s16
v_readlane_b32 s11, v3, 7
s_min_u32 s11, s11, 32
s_sub_u32 s16, 32, s11
s_cmp_lt_u32 s15, s16
s_cbranch_scc0 M_nx7
s_add_u32 s3, s11, s15
s_add_u32 s3, s3, 224
s_branch M_have
M_nx7:
s_sub_u32 s15, s15, s16
M_exit0:
s_endpgm
M_ovf_again:
s_branch M_ovf
M_have:
v_mov_b32 v7, s3
ds_write_b32 v2, v7
s_waitcnt lgkmcnt(0)
M_ranked:
s_barrier
ds_read_b32 v7, v2
s_waitcnt lgkmcnt(0)
v_readfirstlane_b32 s3, v7
s_barrier
s_cmp_lt_u32 s3, 32
s_cbranch_scc1 M_rec
s_sub_u32 s10, s3, 32
s_mul_i32 s16, s10, 4682
s_lshr_b32 s16, s16, 16
s_mul_i32 s13, s16, 14
s_sub_u32 s13, s10, s13
s_and_b32 s12, s13, 1
s_lshr_b32 s13, s13, 1
s_mul_i32 s17, s12, 7
s_lshl_b32 s11, s9, 1
s_add_u32 s17, s17, s11
s_lshl_b32 s18, s16, 9
s_lshl_b32 s52, s17, 18
s_add_u32 s52, s52, s18
s_add_u32 s53, s52, 0x40000
s_cmp_eq_u32 s9, 3
s_cselect_b32 s53, 1073741824, s53
s_lshl_b32 s35, s9, 15
s_lshl_b32 s34, s9, 13
s_mov_b32 s20, s40
s_mov_b32 s21, s41
s_mov_b32 s22, 3670016
s_mov_b32 s23, 0x20000
s_mov_b32 s24, s42
s_mov_b32 s25, s43
s_mov_b32 s26, 3670016
s_mov_b32 s27, 0x20000
s_mov_b32 s56, s36
s_mov_b32 s57, s37
s_mov_b32 s58, 3670016
s_mov_b32 s59, 0x20000
s_mov_b32 s60, s38
s_mov_b32 s61, s39
s_mov_b32 s62, 3670016
s_mov_b32 s63, 0x20000
v_lshrrev_b32 v58, 3, v0
v_mov_b32 v57, 0x380
v_mul_lo_u32 v59, v58, v57
v_and_b32 v56, 7, v0
v_lshrrev_b32 v52, 4, v0
v_and_b32 v53, 1, v52
v_lshlrev_b32 v54, 1, v53
v_add_u32 v55, 0, v54
v_xor_b32 v58, v56, v55
v_lshlrev_b32 v57, 4, v58
v_add_u32 v24, v59, v57
v_lshrrev_b32 v59, 3, v0
v_mov_b32 v58, 0x380
v_mul_lo_u32 v57, v59, v58
v_and_b32 v55, 7, v0
v_lshrrev_b32 v52, 4, v0
v_and_b32 v53, 1, v52
v_lshlrev_b32 v54, 1, v53
v_add_u32 v56, 4, v54
v_xor_b32 v59, v55, v56
v_lshlrev_b32 v58, 4, v59
v_add_u32 v25, v57, v58
s_lshl_b32 s19, s16, 8
s_lshl_b32 s33, s9, 6
s_add_u32 s19, s19, s33
s_mul_i32 s19, s19, 896
s_lshl_b32 s33, s13, 7
s_add_u32 s19, s19, s33
s_add_u32 m0, s34, 131072
s_add_u32 s33, s19, 0
buffer_load_dwordx4 v24, s[24:27], s33 offen lds
s_add_u32 m0, s34, 132096
s_add_u32 s33, s19, 7168
buffer_load_dwordx4 v25, s[24:27], s33 offen lds
s_add_u32 m0, s34, 133120
s_add_u32 s33, s19, 14336
buffer_load_dwordx4 v24, s[24:27], s33 offen lds
s_add_u32 m0, s34, 134144
s_add_u32 s33, s19, 21504
buffer_load_dwordx4 v25, s[24:27], s33 offen lds
s_add_u32 m0, s34, 135168
s_add_u32 s33, s19, 28672
buffer_load_dwordx4 v24, s[24:27], s33 offen lds
s_add_u32 m0, s34, 136192
s_add_u32 s33, s19, 35840
buffer_load_dwordx4 v25, s[24:27], s33 offen lds
s_add_u32 m0, s34, 137216
s_add_u32 s33, s19, 43008
buffer_load_dwordx4 v24, s[24:27], s33 offen lds
s_add_u32 m0, s34, 138240
s_add_u32 s33, s19, 50176
buffer_load_dwordx4 v25, s[24:27], s33 offen lds
v_lshrrev_b32 v53, 5, v0
v_add_u32 v54, 0, v53
v_lshrrev_b32 v55, 2, v54
v_lshlrev_b32 v56, 3, v55
v_lshrrev_b32 v53, 5, v0
v_add_u32 v54, 0, v53
v_and_b32 v55, 3, v54
v_add_u32 v59, v56, v55
v_lshlrev_b32 v57, 13, v59
v_and_b32 v56, 31, v0
v_lshrrev_b32 v53, 5, v0
v_add_u32 v54, 0, v53
v_xor_b32 v55, v56, v54
v_lshlrev_b32 v59, 4, v55
v_add_u32 v58, v57, v59
v_mov_b32 v59, 0
v_sub_u32 v8, v58, v59
v_lshrrev_b32 v53, 5, v0
v_add_u32 v56, 2, v53
v_lshrrev_b32 v54, 2, v56
v_lshlrev_b32 v55, 3, v54
v_lshrrev_b32 v53, 5, v0
v_add_u32 v56, 2, v53
v_and_b32 v54, 3, v56
v_add_u32 v57, v55, v54
v_lshlrev_b32 v58, 13, v57
v_and_b32 v55, 31, v0
v_lshrrev_b32 v53, 5, v0
v_add_u32 v56, 2, v53
v_xor_b32 v54, v55, v56
v_lshlrev_b32 v57, 4, v54
v_add_u32 v59, v58, v57
v_mov_b32 v57, 0x400
v_sub_u32 v9, v59, v57
v_lshrrev_b32 v53, 5, v0
v_add_u32 v55, 4, v53
v_lshrrev_b32 v56, 2, v55
v_lshlrev_b32 v54, 3, v56
v_lshrrev_b32 v53, 5, v0
v_add_u32 v55, 4, v53
v_and_b32 v56, 3, v55
v_add_u32 v58, v54, v56
v_lshlrev_b32 v59, 13, v58
v_and_b32 v54, 31, v0
v_lshrrev_b32 v53, 5, v0
v_add_u32 v55, 4, v53
v_xor_b32 v56, v54, v55
v_lshlrev_b32 v58, 4, v56
v_add_u32 v57, v59, v58
v_mov_b32 v58, 0x800
v_sub_u32 v10, v57, v58
v_lshrrev_b32 v53, 5, v0
v_add_u32 v54, 6, v53
v_lshrrev_b32 v55, 2, v54
v_lshlrev_b32 v56, 3, v55
v_lshrrev_b32 v53, 5, v0
v_add_u32 v54, 6, v53
v_and_b32 v55, 3, v54
v_add_u32 v59, v56, v55
v_lshlrev_b32 v57, 13, v59
v_and_b32 v56, 31, v0
v_lshrrev_b32 v53, 5, v0
v_add_u32 v54, 6, v53
v_xor_b32 v55, v56, v54
v_lshlrev_b32 v59, 4, v55
v_add_u32 v58, v57, v59
v_mov_b32 v59, 0xc00
v_sub_u32 v11, v58, v59
v_lshrrev_b32 v53, 5, v0
v_add_u32 v56, 8, v53
v_lshrrev_b32 v54, 2, v56
v_lshlrev_b32 v55, 3, v54
v_lshrrev_b32 v53, 5, v0
v_add_u32 v56, 8, v53
v_and_b32 v54, 3, v56
v_add_u32 v57, v55, v54
v_lshlrev_b32 v58, 13, v57
v_and_b32 v55, 31, v0
v_lshrrev_b32 v53, 5, v0
v_add_u32 v56, 8, v53
v_xor_b32 v54, v55, v56
v_lshlrev_b32 v57, 4, v54
v_add_u32 v59, v58, v57
v_mov_b32 v57, 0
v_sub_u32 v12, v59, v57
v_lshrrev_b32 v53, 5, v0
v_add_u32 v55, 10, v53
v_lshrrev_b32 v56, 2, v55
v_lshlrev_b32 v54, 3, v56
v_lshrrev_b32 v53, 5, v0
v_add_u32 v55, 10, v53
v_and_b32 v56, 3, v55
v_add_u32 v58, v54, v56
v_lshlrev_b32 v59, 13, v58
v_and_b32 v54, 31, v0
v_lshrrev_b32 v53, 5, v0
v_add_u32 v55, 10, v53
v_xor_b32 v56, v54, v55
v_lshlrev_b32 v58, 4, v56
v_add_u32 v57, v59, v58
v_mov_b32 v58, 0x400
v_sub_u32 v13, v57, v58
v_lshrrev_b32 v53, 5, v0
v_add_u32 v54, 12, v53
v_lshrrev_b32 v55, 2, v54
v_lshlrev_b32 v56, 3, v55
v_lshrrev_b32 v53, 5, v0
v_add_u32 v54, 12, v53
v_and_b32 v55, 3, v54
v_add_u32 v59, v56, v55
v_lshlrev_b32 v57, 13, v59
v_and_b32 v56, 31, v0
v_lshrrev_b32 v53, 5, v0
v_add_u32 v54, 12, v53
v_xor_b32 v55, v56, v54
v_lshlrev_b32 v59, 4, v55
v_add_u32 v58, v57, v59
v_mov_b32 v59, 0x800
v_sub_u32 v14, v58, v59
v_lshrrev_b32 v53, 5, v0
v_add_u32 v56, 14, v53
v_lshrrev_b32 v54, 2, v56
v_lshlrev_b32 v55, 3, v54
v_lshrrev_b32 v53, 5, v0
v_add_u32 v56, 14, v53
v_and_b32 v54, 3, v56
v_add_u32 v57, v55, v54
v_lshlrev_b32 v58, 13, v57
v_and_b32 v55, 31, v0
v_lshrrev_b32 v53, 5, v0
v_add_u32 v56, 14, v53
v_xor_b32 v54, v55, v56
v_lshlrev_b32 v57, 4, v54
v_add_u32 v59, v58, v57
v_mov_b32 v57, 0xc00
v_sub_u32 v15, v59, v57
s_add_u32 s33, s52, 32768
s_add_u32 m0, s35, 0
s_nop 0
buffer_load_dwordx4 v8, s[20:23], s52 offen offset:0 lds
buffer_load_dwordx4 v9, s[20:23], s52 offen offset:1024 lds
buffer_load_dwordx4 v10, s[20:23], s52 offen offset:2048 lds
buffer_load_dwordx4 v11, s[20:23], s52 offen offset:3072 lds
s_add_u32 m0, s35, 4096
s_nop 0
buffer_load_dwordx4 v12, s[20:23], s52 offen offset:0 lds
buffer_load_dwordx4 v13, s[20:23], s52 offen offset:1024 lds
buffer_load_dwordx4 v14, s[20:23], s52 offen offset:2048 lds
buffer_load_dwordx4 v15, s[20:23], s52 offen offset:3072 lds
s_add_u32 m0, s35, 8192
s_nop 0
buffer_load_dwordx4 v8, s[20:23], s33 offen offset:0 lds
buffer_load_dwordx4 v9, s[20:23], s33 offen offset:1024 lds
buffer_load_dwordx4 v10, s[20:23], s33 offen offset:2048 lds
buffer_load_dwordx4 v11, s[20:23], s33 offen offset:3072 lds
s_add_u32 m0, s35, 12288
s_nop 0
buffer_load_dwordx4 v12, s[20:23], s33 offen offset:0 lds
buffer_load_dwordx4 v13, s[20:23], s33 offen offset:1024 lds
buffer_load_dwordx4 v14, s[20:23], s33 offen offset:2048 lds
buffer_load_dwordx4 v15, s[20:23], s33 offen offset:3072 lds
s_add_u32 s33, s53, 32768
s_add_u32 m0, s35, 16384
s_nop 0
buffer_load_dwordx4 v8, s[20:23], s53 offen offset:0 lds
buffer_load_dwordx4 v9, s[20:23], s53 offen offset:1024 lds
buffer_load_dwordx4 v10, s[20:23], s53 offen offset:2048 lds
buffer_load_dwordx4 v11, s[20:23], s53 offen offset:3072 lds
s_add_u32 m0, s35, 20480
s_nop 0
buffer_load_dwordx4 v12, s[20:23], s53 offen offset:0 lds
buffer_load_dwordx4 v13, s[20:23], s53 offen offset:1024 lds
buffer_load_dwordx4 v14, s[20:23], s53 offen offset:2048 lds
buffer_load_dwordx4 v15, s[20:23], s53 offen offset:3072 lds
s_add_u32 m0, s35, 24576
s_nop 0
buffer_load_dwordx4 v8, s[20:23], s33 offen offset:0 lds
buffer_load_dwordx4 v9, s[20:23], s33 offen offset:1024 lds
buffer_load_dwordx4 v10, s[20:23], s33 offen offset:2048 lds
buffer_load_dwordx4 v11, s[20:23], s33 offen offset:3072 lds
s_add_u32 m0, s35, 28672
s_nop 0
buffer_load_dwordx4 v12, s[20:23], s33 offen offset:0 lds
buffer_load_dwordx4 v13, s[20:23], s33 offen offset:1024 lds
buffer_load_dwordx4 v14, s[20:23], s33 offen offset:2048 lds
buffer_load_dwordx4 v15, s[20:23], s33 offen offset:3072 lds
v_lshrrev_b32 v55, 4, v0
v_lshlrev_b32 v56, 3, v55
v_lshrrev_b32 v53, 2, v0
v_and_b32 v55, 3, v53
v_add_u32 v54, v56, v55
v_lshlrev_b32 v58, 7, v54
v_add_u32 v59, 0x20000, v58
v_lshrrev_b32 v49, 2, v0
v_and_b32 v50, 3, v49
v_lshrrev_b32 v51, 1, v50
v_and_b32 v52, 1, v51
v_lshlrev_b32 v53, 1, v52
v_lshrrev_b32 v50, 4, v0
v_and_b32 v51, 1, v50
v_lshlrev_b32 v52, 2, v51
v_add_u32 v56, v53, v52
v_xor_b32 v55, 0, v56
v_and_b32 v52, 3, v0
v_lshrrev_b32 v56, 1, v52
v_add_u32 v54, v55, v56
v_lshlrev_b32 v58, 4, v54
v_add_u32 v57, v59, v58
v_and_b32 v54, 3, v0
v_and_b32 v59, 1, v54
v_lshlrev_b32 v58, 3, v59
v_add_u32 v20, v57, v58
v_lshrrev_b32 v55, 4, v0
v_lshlrev_b32 v56, 3, v55
v_lshrrev_b32 v52, 2, v0
v_and_b32 v55, 3, v52
v_add_u32 v54, v56, v55
v_lshlrev_b32 v59, 7, v54
v_add_u32 v57, 0x20000, v59
v_lshrrev_b32 v49, 2, v0
v_and_b32 v50, 3, v49
v_lshrrev_b32 v51, 1, v50
v_and_b32 v53, 1, v51
v_lshlrev_b32 v52, 1, v53
v_lshrrev_b32 v50, 4, v0
v_and_b32 v51, 1, v50
v_lshlrev_b32 v53, 2, v51
v_add_u32 v56, v52, v53
v_xor_b32 v55, 2, v56
v_and_b32 v53, 3, v0
v_lshrrev_b32 v56, 1, v53
v_add_u32 v54, v55, v56
v_lshlrev_b32 v59, 4, v54
v_add_u32 v58, v57, v59
v_and_b32 v54, 3, v0
v_and_b32 v57, 1, v54
v_lshlrev_b32 v59, 3, v57
v_add_u32 v21, v58, v59
v_lshrrev_b32 v55, 4, v0
v_lshlrev_b32 v56, 3, v55
v_lshrrev_b32 v53, 2, v0
v_and_b32 v55, 3, v53
v_add_u32 v54, v56, v55
v_lshlrev_b32 v57, 7, v54
v_add_u32 v58, 0x20000, v57
v_lshrrev_b32 v49, 2, v0
v_and_b32 v50, 3, v49
v_lshrrev_b32 v51, 1, v50
v_and_b32 v52, 1, v51
v_lshlrev_b32 v53, 1, v52
v_lshrrev_b32 v50, 4, v0
v_and_b32 v51, 1, v50
v_lshlrev_b32 v52, 2, v51
v_add_u32 v56, v53, v52
v_xor_b32 v55, 4, v56
v_and_b32 v52, 3, v0
v_lshrrev_b32 v56, 1, v52
v_add_u32 v54, v55, v56
v_lshlrev_b32 v57, 4, v54
v_add_u32 v59, v58, v57
v_and_b32 v54, 3, v0
v_and_b32 v58, 1, v54
v_lshlrev_b32 v57, 3, v58
v_add_u32 v22, v59, v57
v_lshrrev_b32 v55, 4, v0
v_lshlrev_b32 v56, 3, v55
v_lshrrev_b32 v52, 2, v0
v_and_b32 v55, 3, v52
v_add_u32 v54, v56, v55
v_lshlrev_b32 v58, 7, v54
v_add_u32 v59, 0x20000, v58
v_lshrrev_b32 v49, 2, v0
v_and_b32 v50, 3, v49
v_lshrrev_b32 v51, 1, v50
v_and_b32 v53, 1, v51
v_lshlrev_b32 v52, 1, v53
v_lshrrev_b32 v50, 4, v0
v_and_b32 v51, 1, v50
v_lshlrev_b32 v53, 2, v51
v_add_u32 v56, v52, v53
v_xor_b32 v55, 6, v56
v_and_b32 v53, 3, v0
v_lshrrev_b32 v56, 1, v53
v_add_u32 v54, v55, v56
v_lshlrev_b32 v58, 4, v54
v_add_u32 v57, v59, v58
v_and_b32 v54, 3, v0
v_and_b32 v59, 1, v54
v_lshlrev_b32 v58, 3, v59
v_add_u32 v23, v57, v58
v_and_b32 v57, 15, v0
v_lshlrev_b32 v58, 9, v57
v_and_b32 v55, 15, v0
v_and_b32 v56, 12, v55
v_xor_b32 v54, 0, v56
v_lshrrev_b32 v55, 4, v0
v_and_b32 v52, 15, v0
v_and_b32 v53, 3, v52
v_xor_b32 v56, v55, v53
v_add_u32 v59, v54, v56
v_lshlrev_b32 v57, 4, v59
v_add_u32 v4, v58, v57
v_add_u32 v16, 131072, v4
v_add_u32 v4, s35, v4
v_and_b32 v58, 15, v0
v_lshlrev_b32 v57, 9, v58
v_and_b32 v53, 15, v0
v_and_b32 v54, 12, v53
v_xor_b32 v56, 4, v54
v_lshrrev_b32 v53, 4, v0
v_and_b32 v52, 15, v0
v_and_b32 v55, 3, v52
v_xor_b32 v54, v53, v55
v_add_u32 v59, v56, v54
v_lshlrev_b32 v58, 4, v59
v_add_u32 v5, v57, v58
v_add_u32 v17, 131072, v5
v_add_u32 v5, s35, v5
v_and_b32 v57, 15, v0
v_lshlrev_b32 v58, 9, v57
v_and_b32 v55, 15, v0
v_and_b32 v56, 12, v55
v_xor_b32 v54, 8, v56
v_lshrrev_b32 v55, 4, v0
v_and_b32 v52, 15, v0
v_and_b32 v53, 3, v52
v_xor_b32 v56, v55, v53
v_add_u32 v59, v54, v56
v_lshlrev_b32 v57, 4, v59
v_add_u32 v6, v58, v57
v_add_u32 v18, 131072, v6
v_add_u32 v6, s35, v6
v_and_b32 v58, 15, v0
v_lshlrev_b32 v57, 9, v58
v_and_b32 v53, 15, v0
v_and_b32 v54, 12, v53
v_xor_b32 v56, 12, v54
v_lshrrev_b32 v53, 4, v0
v_and_b32 v52, 15, v0
v_and_b32 v55, 3, v52
v_xor_b32 v54, v53, v55
v_add_u32 v59, v56, v54
v_lshlrev_b32 v58, 4, v59
v_add_u32 v7, v57, v58
v_add_u32 v19, 131072, v7
v_add_u32 v7, s35, v7
v_lshrrev_b32 v57, 4, v0
v_mov_b32 v59, 0x1c00
v_mul_lo_u32 v58, v57, v59
v_and_b32 v57, 15, v0
v_lshlrev_b32 v59, 4, v57
v_add_u32 v2, v58, v59
v_lshlrev_b32 v3, 4, v0
s_waitcnt vmcnt(32)
s_barrier
ds_read_b64_tr_b16 a[0:1], v20 offset:0
ds_read_b64_tr_b16 a[2:3], v20 offset:512
ds_read_b64_tr_b16 a[4:5], v20 offset:4096
ds_read_b64_tr_b16 a[6:7], v20 offset:4608
ds_read_b64_tr_b16 a[8:9], v20 offset:8192
ds_read_b64_tr_b16 a[10:11], v20 offset:8704
ds_read_b64_tr_b16 a[12:13], v20 offset:12288
ds_read_b64_tr_b16 a[14:15], v20 offset:12800
ds_read_b64_tr_b16 a[16:17], v20 offset:16384
ds_read_b64_tr_b16 a[18:19], v20 offset:16896
ds_read_b64_tr_b16 a[20:21], v20 offset:20480
ds_read_b64_tr_b16 a[22:23], v20 offset:20992
ds_read_b64_tr_b16 a[24:25], v20 offset:24576
ds_read_b64_tr_b16 a[26:27], v20 offset:25088
ds_read_b64_tr_b16 a[28:29], v20 offset:28672
ds_read_b64_tr_b16 a[30:31], v20 offset:29184
ds_read_b64_tr_b16 a[32:33], v21 offset:0
ds_read_b64_tr_b16 a[34:35], v21 offset:512
ds_read_b64_tr_b16 a[36:37], v21 offset:4096
ds_read_b64_tr_b16 a[38:39], v21 offset:4608
ds_read_b64_tr_b16 a[40:41], v21 offset:8192
ds_read_b64_tr_b16 a[42:43], v21 offset:8704
ds_read_b64_tr_b16 a[44:45], v21 offset:12288
ds_read_b64_tr_b16 a[46:47], v21 offset:12800
ds_read_b64_tr_b16 a[48:49], v21 offset:16384
ds_read_b64_tr_b16 a[50:51], v21 offset:16896
ds_read_b64_tr_b16 a[52:53], v21 offset:20480
ds_read_b64_tr_b16 a[54:55], v21 offset:20992
ds_read_b64_tr_b16 a[56:57], v21 offset:24576
ds_read_b64_tr_b16 a[58:59], v21 offset:25088
ds_read_b64_tr_b16 a[60:61], v21 offset:28672
ds_read_b64_tr_b16 a[62:63], v21 offset:29184
ds_read_b64_tr_b16 a[64:65], v22 offset:0
ds_read_b64_tr_b16 a[66:67], v22 offset:512
ds_read_b64_tr_b16 a[68:69], v22 offset:4096
ds_read_b64_tr_b16 a[70:71], v22 offset:4608
ds_read_b64_tr_b16 a[72:73], v22 offset:8192
ds_read_b64_tr_b16 a[74:75], v22 offset:8704
ds_read_b64_tr_b16 a[76:77], v22 offset:12288
ds_read_b64_tr_b16 a[78:79], v22 offset:12800
ds_read_b64_tr_b16 a[80:81], v22 offset:16384
ds_read_b64_tr_b16 a[82:83], v22 offset:16896
ds_read_b64_tr_b16 a[84:85], v22 offset:20480
ds_read_b64_tr_b16 a[86:87], v22 offset:20992
ds_read_b64_tr_b16 a[88:89], v22 offset:24576
ds_read_b64_tr_b16 a[90:91], v22 offset:25088
ds_read_b64_tr_b16 a[92:93], v22 offset:28672
ds_read_b64_tr_b16 a[94:95], v22 offset:29184
ds_read_b64_tr_b16 a[96:97], v23 offset:0
ds_read_b64_tr_b16 a[98:99], v23 offset:512
ds_read_b64_tr_b16 a[100:101], v23 offset:4096
ds_read_b64_tr_b16 a[102:103], v23 offset:4608
ds_read_b64_tr_b16 a[104:105], v23 offset:8192
ds_read_b64_tr_b16 a[106:107], v23 offset:8704
ds_read_b64_tr_b16 a[108:109], v23 offset:12288
ds_read_b64_tr_b16 a[110:111], v23 offset:12800
ds_read_b64_tr_b16 a[112:113], v23 offset:16384
ds_read_b64_tr_b16 a[114:115], v23 offset:16896
ds_read_b64_tr_b16 a[116:117], v23 offset:20480
ds_read_b64_tr_b16 a[118:119], v23 offset:20992
ds_read_b64_tr_b16 a[120:121], v23 offset:24576
ds_read_b64_tr_b16 a[122:123], v23 offset:25088
ds_read_b64_tr_b16 a[124:125], v23 offset:28672
ds_read_b64_tr_b16 a[126:127], v23 offset:29184
s_mul_i32 s44, s16, 401408
s_lshl_b32 s19, s13, 10
s_add_u32 s44, s44, s19
s_add_u32 s44, s44, 9437184
s_waitcnt vmcnt(16)
ds_read_b128 v[64:67], v4 offset:0
ds_read_b128 v[96:99], v4 offset:8192
ds_read_b128 v[68:71], v5 offset:0
ds_read_b128 v[100:103], v5 offset:8192
ds_read_b128 v[72:75], v6 offset:0
ds_read_b128 v[104:107], v6 offset:8192
ds_read_b128 v[76:79], v7 offset:0
ds_read_b128 v[108:111], v7 offset:8192
ds_read_b128 v[80:83], v4 offset:256
ds_read_b128 v[112:115], v4 offset:8448
ds_read_b128 v[84:87], v5 offset:256
ds_read_b128 v[116:119], v5 offset:8448
ds_read_b128 v[88:91], v6 offset:256
ds_read_b128 v[120:123], v6 offset:8448
ds_read_b128 v[92:95], v7 offset:256
ds_read_b128 v[124:127], v7 offset:8448
s_waitcnt lgkmcnt(0)
s_barrier
v_mfma_f32_16x16x32_bf16 v[32:35], v[64:67], a[0:3], 0
v_mfma_f32_16x16x32_bf16 v[36:39], v[64:67], a[32:35], 0
v_mfma_f32_16x16x32_bf16 v[40:43], v[64:67], a[64:67], 0
v_mfma_f32_16x16x32_bf16 v[44:47], v[64:67], a[96:99], 0
v_mfma_f32_16x16x32_bf16 v[48:51], v[96:99], a[0:3], 0
v_mfma_f32_16x16x32_bf16 v[52:55], v[96:99], a[32:35], 0
v_mfma_f32_16x16x32_bf16 v[56:59], v[96:99], a[64:67], 0
v_mfma_f32_16x16x32_bf16 v[60:63], v[96:99], a[96:99], 0
v_mfma_f32_16x16x32_bf16 v[32:35], v[68:71], a[4:7], v[32:35]
v_mfma_f32_16x16x32_bf16 v[36:39], v[68:71], a[36:39], v[36:39]
v_mfma_f32_16x16x32_bf16 v[40:43], v[68:71], a[68:71], v[40:43]
v_mfma_f32_16x16x32_bf16 v[44:47], v[68:71], a[100:103], v[44:47]
v_mfma_f32_16x16x32_bf16 v[48:51], v[100:103], a[4:7], v[48:51]
v_mfma_f32_16x16x32_bf16 v[52:55], v[100:103], a[36:39], v[52:55]
v_mfma_f32_16x16x32_bf16 v[56:59], v[100:103], a[68:71], v[56:59]
v_mfma_f32_16x16x32_bf16 v[60:63], v[100:103], a[100:103], v[60:63]
v_mfma_f32_16x16x32_bf16 v[32:35], v[72:75], a[8:11], v[32:35]
v_mfma_f32_16x16x32_bf16 v[36:39], v[72:75], a[40:43], v[36:39]
v_mfma_f32_16x16x32_bf16 v[40:43], v[72:75], a[72:75], v[40:43]
v_mfma_f32_16x16x32_bf16 v[44:47], v[72:75], a[104:107], v[44:47]
v_mfma_f32_16x16x32_bf16 v[48:51], v[104:107], a[8:11], v[48:51]
v_mfma_f32_16x16x32_bf16 v[52:55], v[104:107], a[40:43], v[52:55]
v_mfma_f32_16x16x32_bf16 v[56:59], v[104:107], a[72:75], v[56:59]
v_mfma_f32_16x16x32_bf16 v[60:63], v[104:107], a[104:107], v[60:63]
v_mfma_f32_16x16x32_bf16 v[32:35], v[76:79], a[12:15], v[32:35]
v_mfma_f32_16x16x32_bf16 v[36:39], v[76:79], a[44:47], v[36:39]
v_mfma_f32_16x16x32_bf16 v[40:43], v[76:79], a[76:79], v[40:43]
v_mfma_f32_16x16x32_bf16 v[44:47], v[76:79], a[108:111], v[44:47]
v_mfma_f32_16x16x32_bf16 v[48:51], v[108:111], a[12:15], v[48:51]
v_mfma_f32_16x16x32_bf16 v[52:55], v[108:111], a[44:47], v[52:55]
v_mfma_f32_16x16x32_bf16 v[56:59], v[108:111], a[76:79], v[56:59]
v_mfma_f32_16x16x32_bf16 v[60:63], v[108:111], a[108:111], v[60:63]
v_mfma_f32_16x16x32_bf16 v[32:35], v[80:83], a[16:19], v[32:35]
v_mfma_f32_16x16x32_bf16 v[36:39], v[80:83], a[48:51], v[36:39]
v_mfma_f32_16x16x32_bf16 v[40:43], v[80:83], a[80:83], v[40:43]
v_mfma_f32_16x16x32_bf16 v[44:47], v[80:83], a[112:115], v[44:47]
s_waitcnt vmcnt(0)
buffer_load_dword v26, off, s[48:51], 0 offset:132 sc1
ds_read_b128 v[128:131], v4 offset:16384
ds_read_b128 v[132:135], v5 offset:16384
v_mfma_f32_16x16x32_bf16 v[48:51], v[112:115], a[16:19], v[48:51]
v_mfma_f32_16x16x32_bf16 v[52:55], v[112:115], a[48:51], v[52:55]
v_mfma_f32_16x16x32_bf16 v[56:59], v[112:115], a[80:83], v[56:59]
v_mfma_f32_16x16x32_bf16 v[60:63], v[112:115], a[112:115], v[60:63]
ds_read_b128 v[160:163], v4 offset:24576
ds_read_b128 v[164:167], v5 offset:24576
v_mfma_f32_16x16x32_bf16 v[32:35], v[84:87], a[20:23], v[32:35]
v_mfma_f32_16x16x32_bf16 v[36:39], v[84:87], a[52:55], v[36:39]
v_mfma_f32_16x16x32_bf16 v[40:43], v[84:87], a[84:87], v[40:43]
v_mfma_f32_16x16x32_bf16 v[44:47], v[84:87], a[116:119], v[44:47]
ds_read_b128 v[136:139], v6 offset:16384
ds_read_b128 v[140:143], v7 offset:16384
v_mfma_f32_16x16x32_bf16 v[48:51], v[116:119], a[20:23], v[48:51]
v_mfma_f32_16x16x32_bf16 v[52:55], v[116:119], a[52:55], v[52:55]
v_mfma_f32_16x16x32_bf16 v[56:59], v[116:119], a[84:87], v[56:59]
v_mfma_f32_16x16x32_bf16 v[60:63], v[116:119], a[116:119], v[60:63]
ds_read_b128 v[168:171], v6 offset:24576
ds_read_b128 v[172:175], v7 offset:24576
v_mfma_f32_16x16x32_bf16 v[32:35], v[88:91], a[24:27], v[32:35]
v_mfma_f32_16x16x32_bf16 v[36:39], v[88:91], a[56:59], v[36:39]
v_mfma_f32_16x16x32_bf16 v[40:43], v[88:91], a[88:91], v[40:43]
v_mfma_f32_16x16x32_bf16 v[44:47], v[88:91], a[120:123], v[44:47]
ds_read_b128 v[144:147], v4 offset:16640
ds_read_b128 v[148:151], v5 offset:16640
v_mfma_f32_16x16x32_bf16 v[48:51], v[120:123], a[24:27], v[48:51]
v_mfma_f32_16x16x32_bf16 v[52:55], v[120:123], a[56:59], v[52:55]
v_mfma_f32_16x16x32_bf16 v[56:59], v[120:123], a[88:91], v[56:59]
v_mfma_f32_16x16x32_bf16 v[60:63], v[120:123], a[120:123], v[60:63]
ds_read_b128 v[176:179], v4 offset:24832
ds_read_b128 v[180:183], v5 offset:24832
v_mfma_f32_16x16x32_bf16 v[32:35], v[92:95], a[28:31], v[32:35]
v_mfma_f32_16x16x32_bf16 v[36:39], v[92:95], a[60:63], v[36:39]
v_mfma_f32_16x16x32_bf16 v[40:43], v[92:95], a[92:95], v[40:43]
v_mfma_f32_16x16x32_bf16 v[44:47], v[92:95], a[124:127], v[44:47]
ds_read_b128 v[152:155], v6 offset:16640
ds_read_b128 v[156:159], v7 offset:16640
v_mfma_f32_16x16x32_bf16 v[48:51], v[124:127], a[28:31], v[48:51]
v_mfma_f32_16x16x32_bf16 v[52:55], v[124:127], a[60:63], v[52:55]
v_mfma_f32_16x16x32_bf16 v[56:59], v[124:127], a[92:95], v[56:59]
v_mfma_f32_16x16x32_bf16 v[60:63], v[124:127], a[124:127], v[60:63]
ds_read_b128 v[184:187], v6 offset:24832
ds_read_b128 v[188:191], v7 offset:24832
v_cvt_pk_bf16_f32 v192, v32, v33
v_cvt_pk_bf16_f32 v193, v34, v35
v_cvt_pk_bf16_f32 v194, v48, v49
v_cvt_pk_bf16_f32 v195, v50, v51
v_cvt_pk_bf16_f32 v196, v36, v37
v_cvt_pk_bf16_f32 v197, v38, v39
v_cvt_pk_bf16_f32 v198, v52, v53
v_cvt_pk_bf16_f32 v199, v54, v55
v_cvt_pk_bf16_f32 v200, v40, v41
v_cvt_pk_bf16_f32 v201, v42, v43
v_cvt_pk_bf16_f32 v202, v56, v57
v_cvt_pk_bf16_f32 v203, v58, v59
v_cvt_pk_bf16_f32 v204, v44, v45
v_cvt_pk_bf16_f32 v205, v46, v47
v_cvt_pk_bf16_f32 v206, v60, v61
v_cvt_pk_bf16_f32 v207, v62, v63
s_waitcnt lgkmcnt(0)
s_add_u32 s19, s17, 0
s_mul_i32 s19, s19, 28672
s_add_u32 s19, s19, s44
buffer_store_dwordx4 v[192:195], v2, s[4:7], s19 offen sc1
s_add_u32 s19, s19, 256
buffer_store_dwordx4 v[196:199], v2, s[4:7], s19 offen sc1
s_add_u32 s19, s19, 256
buffer_store_dwordx4 v[200:203], v2, s[4:7], s19 offen sc1
s_add_u32 s19, s19, 256
buffer_store_dwordx4 v[204:207], v2, s[4:7], s19 offen sc1
s_cmp_eq_u32 s9, 3
s_cbranch_scc1 P_skip0
v_mfma_f32_16x16x32_bf16 v[32:35], v[128:131], a[0:3], 0
v_mfma_f32_16x16x32_bf16 v[36:39], v[128:131], a[32:35], 0
v_mfma_f32_16x16x32_bf16 v[40:43], v[128:131], a[64:67], 0
v_mfma_f32_16x16x32_bf16 v[44:47], v[128:131], a[96:99], 0
v_mfma_f32_16x16x32_bf16 v[48:51], v[160:163], a[0:3], 0
v_mfma_f32_16x16x32_bf16 v[52:55], v[160:163], a[32:35], 0
v_mfma_f32_16x16x32_bf16 v[56:59], v[160:163], a[64:67], 0
v_mfma_f32_16x16x32_bf16 v[60:63], v[160:163], a[96:99], 0
v_mfma_f32_16x16x32_bf16 v[32:35], v[132:135], a[4:7], v[32:35]
v_mfma_f32_16x16x32_bf16 v[36:39], v[132:135], a[36:39], v[36:39]
v_mfma_f32_16x16x32_bf16 v[40:43], v[132:135], a[68:71], v[40:43]
v_mfma_f32_16x16x32_bf16 v[44:47], v[132:135], a[100:103], v[44:47]
v_mfma_f32_16x16x32_bf16 v[48:51], v[164:167], a[4:7], v[48:51]
v_mfma_f32_16x16x32_bf16 v[52:55], v[164:167], a[36:39], v[52:55]
v_mfma_f32_16x16x32_bf16 v[56:59], v[164:167], a[68:71], v[56:59]
v_mfma_f32_16x16x32_bf16 v[60:63], v[164:167], a[100:103], v[60:63]
v_mfma_f32_16x16x32_bf16 v[32:35], v[136:139], a[8:11], v[32:35]
v_mfma_f32_16x16x32_bf16 v[36:39], v[136:139], a[40:43], v[36:39]
v_mfma_f32_16x16x32_bf16 v[40:43], v[136:139], a[72:75], v[40:43]
v_mfma_f32_16x16x32_bf16 v[44:47], v[136:139], a[104:107], v[44:47]
v_mfma_f32_16x16x32_bf16 v[48:51], v[168:171], a[8:11], v[48:51]
v_mfma_f32_16x16x32_bf16 v[52:55], v[168:171], a[40:43], v[52:55]
v_mfma_f32_16x16x32_bf16 v[56:59], v[168:171], a[72:75], v[56:59]
v_mfma_f32_16x16x32_bf16 v[60:63], v[168:171], a[104:107], v[60:63]
v_mfma_f32_16x16x32_bf16 v[32:35], v[140:143], a[12:15], v[32:35]
v_mfma_f32_16x16x32_bf16 v[36:39], v[140:143], a[44:47], v[36:39]
v_mfma_f32_16x16x32_bf16 v[40:43], v[140:143], a[76:79], v[40:43]
v_mfma_f32_16x16x32_bf16 v[44:47], v[140:143], a[108:111], v[44:47]
v_mfma_f32_16x16x32_bf16 v[48:51], v[172:175], a[12:15], v[48:51]
v_mfma_f32_16x16x32_bf16 v[52:55], v[172:175], a[44:47], v[52:55]
v_mfma_f32_16x16x32_bf16 v[56:59], v[172:175], a[76:79], v[56:59]
v_mfma_f32_16x16x32_bf16 v[60:63], v[172:175], a[108:111], v[60:63]
v_mfma_f32_16x16x32_bf16 v[32:35], v[144:147], a[16:19], v[32:35]
v_mfma_f32_16x16x32_bf16 v[36:39], v[144:147], a[48:51], v[36:39]
v_mfma_f32_16x16x32_bf16 v[40:43], v[144:147], a[80:83], v[40:43]
v_mfma_f32_16x16x32_bf16 v[44:47], v[144:147], a[112:115], v[44:47]
v_mfma_f32_16x16x32_bf16 v[48:51], v[176:179], a[16:19], v[48:51]
v_mfma_f32_16x16x32_bf16 v[52:55], v[176:179], a[48:51], v[52:55]
v_mfma_f32_16x16x32_bf16 v[56:59], v[176:179], a[80:83], v[56:59]
v_mfma_f32_16x16x32_bf16 v[60:63], v[176:179], a[112:115], v[60:63]
v_mfma_f32_16x16x32_bf16 v[32:35], v[148:151], a[20:23], v[32:35]
v_mfma_f32_16x16x32_bf16 v[36:39], v[148:151], a[52:55], v[36:39]
v_mfma_f32_16x16x32_bf16 v[40:43], v[148:151], a[84:87], v[40:43]
v_mfma_f32_16x16x32_bf16 v[44:47], v[148:151], a[116:119], v[44:47]
v_mfma_f32_16x16x32_bf16 v[48:51], v[180:183], a[20:23], v[48:51]
v_mfma_f32_16x16x32_bf16 v[52:55], v[180:183], a[52:55], v[52:55]
v_mfma_f32_16x16x32_bf16 v[56:59], v[180:183], a[84:87], v[56:59]
v_mfma_f32_16x16x32_bf16 v[60:63], v[180:183], a[116:119], v[60:63]
v_mfma_f32_16x16x32_bf16 v[32:35], v[152:155], a[24:27], v[32:35]
v_mfma_f32_16x16x32_bf16 v[36:39], v[152:155], a[56:59], v[36:39]
v_mfma_f32_16x16x32_bf16 v[40:43], v[152:155], a[88:91], v[40:43]
v_mfma_f32_16x16x32_bf16 v[44:47], v[152:155], a[120:123], v[44:47]
v_mfma_f32_16x16x32_bf16 v[48:51], v[184:187], a[24:27], v[48:51]
v_mfma_f32_16x16x32_bf16 v[52:55], v[184:187], a[56:59], v[52:55]
v_mfma_f32_16x16x32_bf16 v[56:59], v[184:187], a[88:91], v[56:59]
v_mfma_f32_16x16x32_bf16 v[60:63], v[184:187], a[120:123], v[60:63]
v_mfma_f32_16x16x32_bf16 v[32:35], v[156:159], a[28:31], v[32:35]
v_mfma_f32_16x16x32_bf16 v[36:39], v[156:159], a[60:63], v[36:39]
v_mfma_f32_16x16x32_bf16 v[40:43], v[156:159], a[92:95], v[40:43]
v_mfma_f32_16x16x32_bf16 v[44:47], v[156:159], a[124:127], v[44:47]
v_mfma_f32_16x16x32_bf16 v[48:51], v[188:191], a[28:31], v[48:51]
v_mfma_f32_16x16x32_bf16 v[52:55], v[188:191], a[60:63], v[52:55]
v_mfma_f32_16x16x32_bf16 v[56:59], v[188:191], a[92:95], v[56:59]
v_mfma_f32_16x16x32_bf16 v[60:63], v[188:191], a[124:127], v[60:63]
v_cvt_pk_bf16_f32 v208, v32, v33
v_cvt_pk_bf16_f32 v209, v34, v35
v_cvt_pk_bf16_f32 v210, v48, v49
v_cvt_pk_bf16_f32 v211, v50, v51
v_cvt_pk_bf16_f32 v212, v36, v37
v_cvt_pk_bf16_f32 v213, v38, v39
v_cvt_pk_bf16_f32 v214, v52, v53
v_cvt_pk_bf16_f32 v215, v54, v55
v_cvt_pk_bf16_f32 v216, v40, v41
v_cvt_pk_bf16_f32 v217, v42, v43
v_cvt_pk_bf16_f32 v218, v56, v57
v_cvt_pk_bf16_f32 v219, v58, v59
v_cvt_pk_bf16_f32 v220, v44, v45
v_cvt_pk_bf16_f32 v221, v46, v47
v_cvt_pk_bf16_f32 v222, v60, v61
v_cvt_pk_bf16_f32 v223, v62, v63
s_add_u32 s19, s17, 1
s_mul_i32 s19, s19, 28672
s_add_u32 s19, s19, s44
buffer_store_dwordx4 v[208:211], v2, s[4:7], s19 offen sc1
s_add_u32 s19, s19, 256
buffer_store_dwordx4 v[212:215], v2, s[4:7], s19 offen sc1
s_add_u32 s19, s19, 256
buffer_store_dwordx4 v[216:219], v2, s[4:7], s19 offen sc1
s_add_u32 s19, s19, 256
buffer_store_dwordx4 v[220:223], v2, s[4:7], s19 offen sc1
P_skip0:
s_mov_b32 s45, s16
s_lshl_b32 s19, s13, 1
s_lshr_b32 s33, s9, 1
s_add_u32 s19, s19, s33
s_lshl_b32 s19, s19, 18
s_and_b32 s33, s9, 1
s_lshl_b32 s33, s33, 15
s_add_u32 s19, s19, s33
s_add_u32 s19, s19, s18
s_add_u32 m0, s34, 131072
s_nop 0
buffer_load_dwordx4 v8, s[60:63], s19 offen offset:0 lds
buffer_load_dwordx4 v9, s[60:63], s19 offen offset:1024 lds
buffer_load_dwordx4 v10, s[60:63], s19 offen offset:2048 lds
buffer_load_dwordx4 v11, s[60:63], s19 offen offset:3072 lds
s_add_u32 m0, s34, 135168
s_nop 0
buffer_load_dwordx4 v12, s[60:63], s19 offen offset:0 lds
buffer_load_dwordx4 v13, s[60:63], s19 offen offset:1024 lds
buffer_load_dwordx4 v14, s[60:63], s19 offen offset:2048 lds
buffer_load_dwordx4 v15, s[60:63], s19 offen offset:3072 lds
s_waitcnt vmcnt(8)
s_barrier
s_cmp_lg_u32 s9, 0
s_cbranch_scc1 P_sig0
v_cmp_eq_u32 vcc, 0, v26
s_cbranch_vccz P_zok
s_mov_b32 s19, 0x40000
P_zr:
buffer_load_dword v1, off, s[48:51], 0 offset:132 sc1
s_sub_u32 s19, s19, 1
s_cbranch_scc1 M_exit0
s_waitcnt vmcnt(0)
v_cmp_eq_u32 vcc, 0, v1
s_cbranch_vccnz P_zr
P_zok:
s_lshl_b32 s19, s45, 7
s_add_u32 s19, s19, 54730752
v_mov_b32 v1, 1
s_mov_b64 exec, 1
buffer_atomic_add v1, off, s[4:7], s19 sc1
s_mov_b64 exec, -1
P_sig0:
s_add_u32 s33, s52, 32768
s_add_u32 m0, s35, 0
s_nop 0
buffer_load_dwordx4 v8, s[56:59], s52 offen offset:0 lds
buffer_load_dwordx4 v9, s[56:59], s52 offen offset:1024 lds
buffer_load_dwordx4 v10, s[56:59], s52 offen offset:2048 lds
buffer_load_dwordx4 v11, s[56:59], s52 offen offset:3072 lds
s_add_u32 m0, s35, 4096
s_nop 0
buffer_load_dwordx4 v12, s[56:59], s52 offen offset:0 lds
buffer_load_dwordx4 v13, s[56:59], s52 offen offset:1024 lds
buffer_load_dwordx4 v14, s[56:59], s52 offen offset:2048 lds
buffer_load_dwordx4 v15, s[56:59], s52 offen offset:3072 lds
s_add_u32 m0, s35, 8192
s_nop 0
buffer_load_dwordx4 v8, s[56:59], s33 offen offset:0 lds
buffer_load_dwordx4 v9, s[56:59], s33 offen offset:1024 lds
buffer_load_dwordx4 v10, s[56:59], s33 offen offset:2048 lds
buffer_load_dwordx4 v11, s[56:59], s33 offen offset:3072 lds
s_add_u32 m0, s35, 12288
s_nop 0
buffer_load_dwordx4 v12, s[56:59], s33 offen offset:0 lds
buffer_load_dwordx4 v13, s[56:59], s33 offen offset:1024 lds
buffer_load_dwordx4 v14, s[56:59], s33 offen offset:2048 lds
buffer_load_dwordx4 v15, s[56:59], s33 offen offset:3072 lds
s_add_u32 s33, s53, 32768
s_add_u32 m0, s35, 16384
s_nop 0
buffer_load_dwordx4 v8, s[56:59], s53 offen offset:0 lds
buffer_load_dwordx4 v9, s[56:59], s53 offen offset:1024 lds
buffer_load_dwordx4 v10, s[56:59], s53 offen offset:2048 lds
buffer_load_dwordx4 v11, s[56:59], s53 offen offset:3072 lds
s_add_u32 m0, s35, 20480
s_nop 0
buffer_load_dwordx4 v12, s[56:59], s53 offen offset:0 lds
buffer_load_dwordx4 v13, s[56:59], s53 offen offset:1024 lds
buffer_load_dwordx4 v14, s[56:59], s53 offen offset:2048 lds
buffer_load_dwordx4 v15, s[56:59], s53 offen offset:3072 lds
s_add_u32 m0, s35, 24576
s_nop 0
buffer_load_dwordx4 v8, s[56:59], s33 offen offset:0 lds
buffer_load_dwordx4 v9, s[56:59], s33 offen offset:1024 lds
buffer_load_dwordx4 v10, s[56:59], s33 offen offset:2048 lds
buffer_load_dwordx4 v11, s[56:59], s33 offen offset:3072 lds
s_add_u32 m0, s35, 28672
s_nop 0
buffer_load_dwordx4 v12, s[56:59], s33 offen offset:0 lds
buffer_load_dwordx4 v13, s[56:59], s33 offen offset:1024 lds
buffer_load_dwordx4 v14, s[56:59], s33 offen offset:2048 lds
buffer_load_dwordx4 v15, s[56:59], s33 offen offset:3072 lds
s_waitcnt vmcnt(16)
s_barrier
ds_read_b128 a[0:3], v16 offset:0
ds_read_b128 a[4:7], v17 offset:0
ds_read_b128 a[8:11], v18 offset:0
ds_read_b128 a[12:15], v19 offset:0
ds_read_b128 a[16:19], v16 offset:256
ds_read_b128 a[20:23], v17 offset:256
ds_read_b128 a[24:27], v18 offset:256
ds_read_b128 a[28:31], v19 offset:256
ds_read_b128 a[32:35], v16 offset:8192
ds_read_b128 a[36:39], v17 offset:8192
ds_read_b128 a[40:43], v18 offset:8192
ds_read_b128 a[44:47], v19 offset:8192
ds_read_b128 a[48:51], v16 offset:8448
ds_read_b128 a[52:55], v17 offset:8448
ds_read_b128 a[56:59], v18 offset:8448
ds_read_b128 a[60:63], v19 offset:8448
ds_read_b128 a[64:67], v16 offset:16384
ds_read_b128 a[68:71], v17 offset:16384
ds_read_b128 a[72:75], v18 offset:16384
ds_read_b128 a[76:79], v19 offset:16384
ds_read_b128 a[80:83], v16 offset:16640
ds_read_b128 a[84:87], v17 offset:16640
ds_read_b128 a[88:91], v18 offset:16640
ds_read_b128 a[92:95], v19 offset:16640
ds_read_b128 a[96:99], v16 offset:24576
ds_read_b128 a[100:103], v17 offset:24576
ds_read_b128 a[104:107], v18 offset:24576
ds_read_b128 a[108:111], v19 offset:24576
ds_read_b128 a[112:115], v16 offset:24832
ds_read_b128 a[116:119], v17 offset:24832
ds_read_b128 a[120:123], v18 offset:24832
ds_read_b128 a[124:127], v19 offset:24832
s_mul_i32 s44, s16, 401408
s_mul_i32 s19, s13, 57344
s_add_u32 s44, s44, s19
s_add_u32 s44, s44, 2097152
s_mov_b32 s47, 0x3db8aa3b
ds_read_b128 v[64:67], v4 offset:0
ds_read_b128 v[96:99], v4 offset:8192
ds_read_b128 v[68:71], v5 offset:0
ds_read_b128 v[100:103], v5 offset:8192
ds_read_b128 v[72:75], v6 offset:0
ds_read_b128 v[104:107], v6 offset:8192
ds_read_b128 v[76:79], v7 offset:0
ds_read_b128 v[108:111], v7 offset:8192
ds_read_b128 v[80:83], v4 offset:256
ds_read_b128 v[112:115], v4 offset:8448
ds_read_b128 v[84:87], v5 offset:256
ds_read_b128 v[116:119], v5 offset:8448
ds_read_b128 v[88:91], v6 offset:256
ds_read_b128 v[120:123], v6 offset:8448
ds_read_b128 v[92:95], v7 offset:256
ds_read_b128 v[124:127], v7 offset:8448
s_waitcnt lgkmcnt(0)
v_mfma_f32_16x16x32_bf16 v[32:35], v[64:67], a[0:3], 0
v_mfma_f32_16x16x32_bf16 v[36:39], v[64:67], a[32:35], 0
v_mfma_f32_16x16x32_bf16 v[40:43], v[64:67], a[64:67], 0
v_mfma_f32_16x16x32_bf16 v[44:47], v[64:67], a[96:99], 0
v_mfma_f32_16x16x32_bf16 v[48:51], v[96:99], a[0:3], 0
v_mfma_f32_16x16x32_bf16 v[52:55], v[96:99], a[32:35], 0
v_mfma_f32_16x16x32_bf16 v[56:59], v[96:99], a[64:67], 0
v_mfma_f32_16x16x32_bf16 v[60:63], v[96:99], a[96:99], 0
v_mfma_f32_16x16x32_bf16 v[32:35], v[68:71], a[4:7], v[32:35]
v_mfma_f32_16x16x32_bf16 v[36:39], v[68:71], a[36:39], v[36:39]
v_mfma_f32_16x16x32_bf16 v[40:43], v[68:71], a[68:71], v[40:43]
v_mfma_f32_16x16x32_bf16 v[44:47], v[68:71], a[100:103], v[44:47]
v_mfma_f32_16x16x32_bf16 v[48:51], v[100:103], a[4:7], v[48:51]
v_mfma_f32_16x16x32_bf16 v[52:55], v[100:103], a[36:39], v[52:55]
v_mfma_f32_16x16x32_bf16 v[56:59], v[100:103], a[68:71], v[56:59]
v_mfma_f32_16x16x32_bf16 v[60:63], v[100:103], a[100:103], v[60:63]
v_mfma_f32_16x16x32_bf16 v[32:35], v[72:75], a[8:11], v[32:35]
v_mfma_f32_16x16x32_bf16 v[36:39], v[72:75], a[40:43], v[36:39]
v_mfma_f32_16x16x32_bf16 v[40:43], v[72:75], a[72:75], v[40:43]
v_mfma_f32_16x16x32_bf16 v[44:47], v[72:75], a[104:107], v[44:47]
v_mfma_f32_16x16x32_bf16 v[48:51], v[104:107], a[8:11], v[48:51]
v_mfma_f32_16x16x32_bf16 v[52:55], v[104:107], a[40:43], v[52:55]
v_mfma_f32_16x16x32_bf16 v[56:59], v[104:107], a[72:75], v[56:59]
v_mfma_f32_16x16x32_bf16 v[60:63], v[104:107], a[104:107], v[60:63]
v_mfma_f32_16x16x32_bf16 v[32:35], v[76:79], a[12:15], v[32:35]
v_mfma_f32_16x16x32_bf16 v[36:39], v[76:79], a[44:47], v[36:39]
v_mfma_f32_16x16x32_bf16 v[40:43], v[76:79], a[76:79], v[40:43]
v_mfma_f32_16x16x32_bf16 v[44:47], v[76:79], a[108:111], v[44:47]
v_mfma_f32_16x16x32_bf16 v[48:51], v[108:111], a[12:15], v[48:51]
v_mfma_f32_16x16x32_bf16 v[52:55], v[108:111], a[44:47], v[52:55]
v_mfma_f32_16x16x32_bf16 v[56:59], v[108:111], a[76:79], v[56:59]
v_mfma_f32_16x16x32_bf16 v[60:63], v[108:111], a[108:111], v[60:63]
v_mfma_f32_16x16x32_bf16 v[32:35], v[80:83], a[16:19], v[32:35]
v_mfma_f32_16x16x32_bf16 v[36:39], v[80:83], a[48:51], v[36:39]
v_mfma_f32_16x16x32_bf16 v[40:43], v[80:83], a[80:83], v[40:43]
v_mfma_f32_16x16x32_bf16 v[44:47], v[80:83], a[112:115], v[44:47]
s_waitcnt vmcnt(0)
ds_read_b128 v[128:131], v4 offset:16384
ds_read_b128 v[132:135], v5 offset:16384
v_mfma_f32_16x16x32_bf16 v[48:51], v[112:115], a[16:19], v[48:51]
v_mfma_f32_16x16x32_bf16 v[52:55], v[112:115], a[48:51], v[52:55]
v_mfma_f32_16x16x32_bf16 v[56:59], v[112:115], a[80:83], v[56:59]
v_mfma_f32_16x16x32_bf16 v[60:63], v[112:115], a[112:115], v[60:63]
ds_read_b128 v[160:163], v4 offset:24576
ds_read_b128 v[164:167], v5 offset:24576
v_mfma_f32_16x16x32_bf16 v[32:35], v[84:87], a[20:23], v[32:35]
v_mfma_f32_16x16x32_bf16 v[36:39], v[84:87], a[52:55], v[36:39]
v_mfma_f32_16x16x32_bf16 v[40:43], v[84:87], a[84:87], v[40:43]
v_mfma_f32_16x16x32_bf16 v[44:47], v[84:87], a[116:119], v[44:47]
ds_read_b128 v[136:139], v6 offset:16384
ds_read_b128 v[140:143], v7 offset:16384
v_mfma_f32_16x16x32_bf16 v[48:51], v[116:119], a[20:23], v[48:51]
v_mfma_f32_16x16x32_bf16 v[52:55], v[116:119], a[52:55], v[52:55]
v_mfma_f32_16x16x32_bf16 v[56:59], v[116:119], a[84:87], v[56:59]
v_mfma_f32_16x16x32_bf16 v[60:63], v[116:119], a[116:119], v[60:63]
ds_read_b128 v[168:171], v6 offset:24576
ds_read_b128 v[172:175], v7 offset:24576
v_mfma_f32_16x16x32_bf16 v[32:35], v[88:91], a[24:27], v[32:35]
v_mfma_f32_16x16x32_bf16 v[36:39], v[88:91], a[56:59], v[36:39]
v_mfma_f32_16x16x32_bf16 v[40:43], v[88:91], a[88:91], v[40:43]
v_mfma_f32_16x16x32_bf16 v[44:47], v[88:91], a[120:123], v[44:47]
ds_read_b128 v[144:147], v4 offset:16640
ds_read_b128 v[148:151], v5 offset:16640
v_mfma_f32_16x16x32_bf16 v[48:51], v[120:123], a[24:27], v[48:51]
v_mfma_f32_16x16x32_bf16 v[52:55], v[120:123], a[56:59], v[52:55]
v_mfma_f32_16x16x32_bf16 v[56:59], v[120:123], a[88:91], v[56:59]
v_mfma_f32_16x16x32_bf16 v[60:63], v[120:123], a[120:123], v[60:63]
ds_read_b128 v[176:179], v4 offset:24832
ds_read_b128 v[180:183], v5 offset:24832
v_mfma_f32_16x16x32_bf16 v[32:35], v[92:95], a[28:31], v[32:35]
v_mfma_f32_16x16x32_bf16 v[36:39], v[92:95], a[60:63], v[36:39]
v_mfma_f32_16x16x32_bf16 v[40:43], v[92:95], a[92:95], v[40:43]
v_mfma_f32_16x16x32_bf16 v[44:47], v[92:95], a[124:127], v[44:47]
ds_read_b128 v[152:155], v6 offset:16640
ds_read_b128 v[156:159], v7 offset:16640
v_mfma_f32_16x16x32_bf16 v[48:51], v[124:127], a[28:31], v[48:51]
v_mfma_f32_16x16x32_bf16 v[52:55], v[124:127], a[60:63], v[52:55]
v_mfma_f32_16x16x32_bf16 v[56:59], v[124:127], a[92:95], v[56:59]
v_mfma_f32_16x16x32_bf16 v[60:63], v[124:127], a[124:127], v[60:63]
ds_read_b128 v[184:187], v6 offset:24832
ds_read_b128 v[188:191], v7 offset:24832
v_mul_f32 v32, s47, v32
v_mul_f32 v33, s47, v33
v_mul_f32 v34, s47, v34
v_mul_f32 v35, s47, v35
v_cvt_pk_bf16_f32 v192, v32, v33
v_cvt_pk_bf16_f32 v193, v34, v35
v_mul_f32 v48, s47, v48
v_mul_f32 v49, s47, v49
v_mul_f32 v50, s47, v50
v_mul_f32 v51, s47, v51
v_cvt_pk_bf16_f32 v194, v48, v49
v_cvt_pk_bf16_f32 v195, v50, v51
v_mul_f32 v36, s47, v36
v_mul_f32 v37, s47, v37
v_mul_f32 v38, s47, v38
v_mul_f32 v39, s47, v39
v_cvt_pk_bf16_f32 v196, v36, v37
v_cvt_pk_bf16_f32 v197, v38, v39
v_mul_f32 v52, s47, v52
v_mul_f32 v53, s47, v53
v_mul_f32 v54, s47, v54
v_mul_f32 v55, s47, v55
v_cvt_pk_bf16_f32 v198, v52, v53
v_cvt_pk_bf16_f32 v199, v54, v55
v_mul_f32 v40, s47, v40
v_mul_f32 v41, s47, v41
v_mul_f32 v42, s47, v42
v_mul_f32 v43, s47, v43
v_cvt_pk_bf16_f32 v200, v40, v41
v_cvt_pk_bf16_f32 v201, v42, v43
v_mul_f32 v56, s47, v56
v_mul_f32 v57, s47, v57
v_mul_f32 v58, s47, v58
v_mul_f32 v59, s47, v59
v_cvt_pk_bf16_f32 v202, v56, v57
v_cvt_pk_bf16_f32 v203, v58, v59
v_mul_f32 v44, s47, v44
v_mul_f32 v45, s47, v45
v_mul_f32 v46, s47, v46
v_mul_f32 v47, s47, v47
v_cvt_pk_bf16_f32 v204, v44, v45
v_cvt_pk_bf16_f32 v205, v46, v47
v_mul_f32 v60, s47, v60
v_mul_f32 v61, s47, v61
v_mul_f32 v62, s47, v62
v_mul_f32 v63, s47, v63
v_cvt_pk_bf16_f32 v206, v60, v61
v_cvt_pk_bf16_f32 v207, v62, v63
s_waitcnt lgkmcnt(0)
s_add_u32 s19, s17, 0
s_mul_i32 s19, s19, 1024
s_add_u32 s19, s19, s44
buffer_store_dwordx4 v[192:195], v3, s[4:7], s19 offen sc1
s_add_u32 s19, s19, 14336
buffer_store_dwordx4 v[196:199], v3, s[4:7], s19 offen sc1
s_add_u32 s19, s19, 14336
buffer_store_dwordx4 v[200:203], v3, s[4:7], s19 offen sc1
s_add_u32 s19, s19, 14336
buffer_store_dwordx4 v[204:207], v3, s[4:7], s19 offen sc1
s_cmp_eq_u32 s9, 3
s_cbranch_scc1 P_skip1
v_mfma_f32_16x16x32_bf16 v[32:35], v[128:131], a[0:3], 0
v_mfma_f32_16x16x32_bf16 v[36:39], v[128:131], a[32:35], 0
v_mfma_f32_16x16x32_bf16 v[40:43], v[128:131], a[64:67], 0
v_mfma_f32_16x16x32_bf16 v[44:47], v[128:131], a[96:99], 0
v_mfma_f32_16x16x32_bf16 v[48:51], v[160:163], a[0:3], 0
v_mfma_f32_16x16x32_bf16 v[52:55], v[160:163], a[32:35], 0
v_mfma_f32_16x16x32_bf16 v[56:59], v[160:163], a[64:67], 0
v_mfma_f32_16x16x32_bf16 v[60:63], v[160:163], a[96:99], 0
v_mfma_f32_16x16x32_bf16 v[32:35], v[132:135], a[4:7], v[32:35]
v_mfma_f32_16x16x32_bf16 v[36:39], v[132:135], a[36:39], v[36:39]
v_mfma_f32_16x16x32_bf16 v[40:43], v[132:135], a[68:71], v[40:43]
v_mfma_f32_16x16x32_bf16 v[44:47], v[132:135], a[100:103], v[44:47]
v_mfma_f32_16x16x32_bf16 v[48:51], v[164:167], a[4:7], v[48:51]
v_mfma_f32_16x16x32_bf16 v[52:55], v[164:167], a[36:39], v[52:55]
v_mfma_f32_16x16x32_bf16 v[56:59], v[164:167], a[68:71], v[56:59]
v_mfma_f32_16x16x32_bf16 v[60:63], v[164:167], a[100:103], v[60:63]
v_mfma_f32_16x16x32_bf16 v[32:35], v[136:139], a[8:11], v[32:35]
v_mfma_f32_16x16x32_bf16 v[36:39], v[136:139], a[40:43], v[36:39]
v_mfma_f32_16x16x32_bf16 v[40:43], v[136:139], a[72:75], v[40:43]
v_mfma_f32_16x16x32_bf16 v[44:47], v[136:139], a[104:107], v[44:47]
v_mfma_f32_16x16x32_bf16 v[48:51], v[168:171], a[8:11], v[48:51]
v_mfma_f32_16x16x32_bf16 v[52:55], v[168:171], a[40:43], v[52:55]
v_mfma_f32_16x16x32_bf16 v[56:59], v[168:171], a[72:75], v[56:59]
v_mfma_f32_16x16x32_bf16 v[60:63], v[168:171], a[104:107], v[60:63]
v_mfma_f32_16x16x32_bf16 v[32:35], v[140:143], a[12:15], v[32:35]
v_mfma_f32_16x16x32_bf16 v[36:39], v[140:143], a[44:47], v[36:39]
v_mfma_f32_16x16x32_bf16 v[40:43], v[140:143], a[76:79], v[40:43]
v_mfma_f32_16x16x32_bf16 v[44:47], v[140:143], a[108:111], v[44:47]
v_mfma_f32_16x16x32_bf16 v[48:51], v[172:175], a[12:15], v[48:51]
v_mfma_f32_16x16x32_bf16 v[52:55], v[172:175], a[44:47], v[52:55]
v_mfma_f32_16x16x32_bf16 v[56:59], v[172:175], a[76:79], v[56:59]
v_mfma_f32_16x16x32_bf16 v[60:63], v[172:175], a[108:111], v[60:63]
v_mfma_f32_16x16x32_bf16 v[32:35], v[144:147], a[16:19], v[32:35]
v_mfma_f32_16x16x32_bf16 v[36:39], v[144:147], a[48:51], v[36:39]
v_mfma_f32_16x16x32_bf16 v[40:43], v[144:147], a[80:83], v[40:43]
v_mfma_f32_16x16x32_bf16 v[44:47], v[144:147], a[112:115], v[44:47]
v_mfma_f32_16x16x32_bf16 v[48:51], v[176:179], a[16:19], v[48:51]
v_mfma_f32_16x16x32_bf16 v[52:55], v[176:179], a[48:51], v[52:55]
v_mfma_f32_16x16x32_bf16 v[56:59], v[176:179], a[80:83], v[56:59]
v_mfma_f32_16x16x32_bf16 v[60:63], v[176:179], a[112:115], v[60:63]
v_mfma_f32_16x16x32_bf16 v[32:35], v[148:151], a[20:23], v[32:35]
v_mfma_f32_16x16x32_bf16 v[36:39], v[148:151], a[52:55], v[36:39]
v_mfma_f32_16x16x32_bf16 v[40:43], v[148:151], a[84:87], v[40:43]
v_mfma_f32_16x16x32_bf16 v[44:47], v[148:151], a[116:119], v[44:47]
v_mfma_f32_16x16x32_bf16 v[48:51], v[180:183], a[20:23], v[48:51]
v_mfma_f32_16x16x32_bf16 v[52:55], v[180:183], a[52:55], v[52:55]
v_mfma_f32_16x16x32_bf16 v[56:59], v[180:183], a[84:87], v[56:59]
v_mfma_f32_16x16x32_bf16 v[60:63], v[180:183], a[116:119], v[60:63]
v_mfma_f32_16x16x32_bf16 v[32:35], v[152:155], a[24:27], v[32:35]
v_mfma_f32_16x16x32_bf16 v[36:39], v[152:155], a[56:59], v[36:39]
v_mfma_f32_16x16x32_bf16 v[40:43], v[152:155], a[88:91], v[40:43]
v_mfma_f32_16x16x32_bf16 v[44:47], v[152:155], a[120:123], v[44:47]
v_mfma_f32_16x16x32_bf16 v[48:51], v[184:187], a[24:27], v[48:51]
v_mfma_f32_16x16x32_bf16 v[52:55], v[184:187], a[56:59], v[52:55]
v_mfma_f32_16x16x32_bf16 v[56:59], v[184:187], a[88:91], v[56:59]
v_mfma_f32_16x16x32_bf16 v[60:63], v[184:187], a[120:123], v[60:63]
v_mfma_f32_16x16x32_bf16 v[32:35], v[156:159], a[28:31], v[32:35]
v_mfma_f32_16x16x32_bf16 v[36:39], v[156:159], a[60:63], v[36:39]
v_mfma_f32_16x16x32_bf16 v[40:43], v[156:159], a[92:95], v[40:43]
v_mfma_f32_16x16x32_bf16 v[44:47], v[156:159], a[124:127], v[44:47]
v_mfma_f32_16x16x32_bf16 v[48:51], v[188:191], a[28:31], v[48:51]
v_mfma_f32_16x16x32_bf16 v[52:55], v[188:191], a[60:63], v[52:55]
v_mfma_f32_16x16x32_bf16 v[56:59], v[188:191], a[92:95], v[56:59]
v_mfma_f32_16x16x32_bf16 v[60:63], v[188:191], a[124:127], v[60:63]
v_mul_f32 v32, s47, v32
v_mul_f32 v33, s47, v33
v_mul_f32 v34, s47, v34
v_mul_f32 v35, s47, v35
v_cvt_pk_bf16_f32 v208, v32, v33
v_cvt_pk_bf16_f32 v209, v34, v35
v_mul_f32 v48, s47, v48
v_mul_f32 v49, s47, v49
v_mul_f32 v50, s47, v50
v_mul_f32 v51, s47, v51
v_cvt_pk_bf16_f32 v210, v48, v49
v_cvt_pk_bf16_f32 v211, v50, v51
v_mul_f32 v36, s47, v36
v_mul_f32 v37, s47, v37
v_mul_f32 v38, s47, v38
v_mul_f32 v39, s47, v39
v_cvt_pk_bf16_f32 v212, v36, v37
v_cvt_pk_bf16_f32 v213, v38, v39
v_mul_f32 v52, s47, v52
v_mul_f32 v53, s47, v53
v_mul_f32 v54, s47, v54
v_mul_f32 v55, s47, v55
v_cvt_pk_bf16_f32 v214, v52, v53
v_cvt_pk_bf16_f32 v215, v54, v55
v_mul_f32 v40, s47, v40
v_mul_f32 v41, s47, v41
v_mul_f32 v42, s47, v42
v_mul_f32 v43, s47, v43
v_cvt_pk_bf16_f32 v216, v40, v41
v_cvt_pk_bf16_f32 v217, v42, v43
v_mul_f32 v56, s47, v56
v_mul_f32 v57, s47, v57
v_mul_f32 v58, s47, v58
v_mul_f32 v59, s47, v59
v_cvt_pk_bf16_f32 v218, v56, v57
v_cvt_pk_bf16_f32 v219, v58, v59
v_mul_f32 v44, s47, v44
v_mul_f32 v45, s47, v45
v_mul_f32 v46, s47, v46
v_mul_f32 v47, s47, v47
v_cvt_pk_bf16_f32 v220, v44, v45
v_cvt_pk_bf16_f32 v221, v46, v47
v_mul_f32 v60, s47, v60
v_mul_f32 v61, s47, v61
v_mul_f32 v62, s47, v62
v_mul_f32 v63, s47, v63
v_cvt_pk_bf16_f32 v222, v60, v61
v_cvt_pk_bf16_f32 v223, v62, v63
s_add_u32 s19, s17, 1
s_mul_i32 s19, s19, 1024
s_add_u32 s19, s19, s44
buffer_store_dwordx4 v[208:211], v3, s[4:7], s19 offen sc1
s_add_u32 s19, s19, 14336
buffer_store_dwordx4 v[212:215], v3, s[4:7], s19 offen sc1
s_add_u32 s19, s19, 14336
buffer_store_dwordx4 v[216:219], v3, s[4:7], s19 offen sc1
s_add_u32 s19, s19, 14336
buffer_store_dwordx4 v[220:223], v3, s[4:7], s19 offen sc1
P_skip1:
s_waitcnt vmcnt(0)
s_barrier
s_cmp_lg_u32 s9, 0
s_cbranch_scc1 P_sig1
s_lshl_b32 s19, s16, 7
s_add_u32 s19, s19, 54734848
v_mov_b32 v1, 1
s_mov_b64 exec, 1
buffer_atomic_add v1, off, s[4:7], s19 sc1
s_mov_b64 exec, -1
P_sig1:
s_sub_u32 s11, s3, 32
s_and_b32 s10, s11, 63
s_lshr_b32 s11, s11, 6
s_cmp_eq_u32 s11, 2
s_cbranch_scc1 M_F
s_cmp_eq_u32 s11, 3
s_cbranch_scc1 M_exit
s_cmp_lg_u32 s11, 1
s_cbranch_scc1 M_noT
s_cmp_lt_u32 s10, 32
s_cbranch_scc1 M_T
M_noT:
s_and_b32 s12, s10, 3
s_lshr_b32 s10, s10, 2
s_cmp_eq_u32 s11, 1
s_cbranch_scc1 M_Q
v_and_b32 v0, 63, v0
v_lshlrev_b32 v119, 4, v0
v_mov_b32 v29, 0x44444444
v_mov_b32 v28, 0xeeeeeeee
v_and_b32 v27, 2, v0
v_mov_b32 v26, 1
v_cmp_lt_u32 vcc, v27, v26
s_nop 1
v_cndmask_b32 v118, v28, v29, vcc
v_lshrrev_b32 v27, 4, v0
v_mov_b32 v28, 0x1c00
v_mul_lo_u32 v26, v27, v28
v_mov_b32 v25, s9
v_mov_b32 v24, 0x70
v_mul_lo_u32 v29, v25, v24
v_and_b32 v24, 15, v0
v_add_u32 v27, v29, v24
v_lshlrev_b32 v28, 4, v27
v_add_u32 v117, v26, v28
v_mov_b32 v24, s9
v_mov_b32 v29, 0x70
v_mul_lo_u32 v27, v24, v29
v_and_b32 v29, 15, v0
v_add_u32 v26, v27, v29
v_lshlrev_b32 v28, 4, v26
v_lshrrev_b32 v29, 4, v0
v_lshlrev_b32 v26, 2, v29
v_add_u32 v116, v28, v26
s_mul_i32 s13, s10, 401408
s_add_u32 s13, s13, 9437184
s_mul_i32 s20, s12, 28672
s_cmp_lg_u32 s9, 0
s_cbranch_scc1 WV_wb_go
v_mov_b32 v10, s10
v_lshlrev_b32 v11, 7, v10
v_add_u32 v12, 0x3432000, v11
v_mov_b32 v11, 0x343e000
v_mov_b32 v10, 1
v_cmp_lt_u32 vcc, v0, v10
s_nop 1
v_cndmask_b32 v1, v11, v12, vcc
v_mov_b32 v10, 14
v_mov_b32 v11, 32
v_mov_b32 v12, 1
v_cmp_lt_u32 vcc, v0, v12
s_nop 1
v_cndmask_b32 v2, v11, v10, vcc
s_mov_b32 s19, 0x40000
WV_wb:
buffer_load_dword v3, v1, s[4:7], 0 offen sc1
s_sub_u32 s19, s19, 1
s_cbranch_scc1 M_exit
s_waitcnt vmcnt(0)
v_cmp_gt_u32 vcc, v2, v3
s_cbranch_vccnz WV_wb
WV_wb_go:
s_barrier
s_mov_b32 s8, s12
s_mul_i32 s14, s10, 28672
s_add_u32 s11, s20, 0
buffer_load_dwordx4 v[56:59], v119, s[4:7], s11 offen offset:0
s_add_u32 s11, s20, 12288
buffer_load_dwordx4 v[60:63], v119, s[4:7], s11 offen offset:2048
s_add_u32 s11, s20, 0
buffer_load_dwordx4 v[64:67], v119, s[4:7], s11 offen offset:1024
s_add_u32 s11, s20, 12288
buffer_load_dwordx4 v[68:71], v119, s[4:7], s11 offen offset:3072
s_add_u32 s11, s20, 0
buffer_load_dwordx4 v[72:75], v119, s[4:7], s11 offen offset:2048
s_add_u32 s11, s20, 16384
buffer_load_dwordx4 v[76:79], v119, s[4:7], s11 offen offset:0
s_add_u32 s11, s20, 0
buffer_load_dwordx4 v[80:83], v119, s[4:7], s11 offen offset:3072
s_add_u32 s11, s20, 16384
buffer_load_dwordx4 v[84:87], v119, s[4:7], s11 offen offset:1024
s_add_u32 s11, s13, 0
buffer_load_dwordx4 a[0:3], v117, s[4:7], s11 offen
s_add_u32 s11, s13, 256
buffer_load_dwordx4 a[56:59], v117, s[4:7], s11 offen
s_add_u32 s11, s13, 512
buffer_load_dwordx4 a[112:115], v117, s[4:7], s11 offen
s_add_u32 s11, s13, 768
buffer_load_dwordx4 a[168:171], v117, s[4:7], s11 offen
s_add_u32 s11, s13, 1024
buffer_load_dwordx4 a[224:227], v117, s[4:7], s11 offen
s_add_u32 s11, s13, 1280
buffer_load_dwordx4 v[144:147], v117, s[4:7], s11 offen
s_add_u32 s11, s13, 1536
buffer_load_dwordx4 v[200:203], v117, s[4:7], s11 offen
s_add_u32 s11, s13, 28672
buffer_load_dwordx4 a[4:7], v117, s[4:7], s11 offen
s_add_u32 s11, s13, 28928
buffer_load_dwordx4 a[60:63], v117, s[4:7], s11 offen
s_add_u32 s11, s13, 29184
buffer_load_dwordx4 a[116:119], v117, s[4:7], s11 offen
s_add_u32 s11, s13, 29440
buffer_load_dwordx4 a[172:175], v117, s[4:7], s11 offen
s_add_u32 s11, s13, 29696
buffer_load_dwordx4 a[228:231], v117, s[4:7], s11 offen
s_add_u32 s11, s13, 29952
buffer_load_dwordx4 v[148:151], v117, s[4:7], s11 offen
s_add_u32 s11, s13, 30208
buffer_load_dwordx4 v[204:207], v117, s[4:7], s11 offen
s_add_u32 s11, s13, 57344
buffer_load_dwordx4 a[8:11], v117, s[4:7], s11 offen
s_add_u32 s11, s13, 57600
buffer_load_dwordx4 a[64:67], v117, s[4:7], s11 offen
s_add_u32 s11, s13, 57856
buffer_load_dwordx4 a[120:123], v117, s[4:7], s11 offen
s_add_u32 s11, s13, 58112
buffer_load_dwordx4 a[176:179], v117, s[4:7], s11 offen
s_add_u32 s11, s13, 58368
buffer_load_dwordx4 a[232:235], v117, s[4:7], s11 offen
s_add_u32 s11, s13, 58624
buffer_load_dwordx4 v[152:155], v117, s[4:7], s11 offen
s_add_u32 s11, s13, 58880
buffer_load_dwordx4 v[208:211], v117, s[4:7], s11 offen
s_add_u32 s11, s13, 86016
buffer_load_dwordx4 a[12:15], v117, s[4:7], s11 offen
s_add_u32 s11, s13, 86272
buffer_load_dwordx4 a[68:71], v117, s[4:7], s11 offen
s_add_u32 s11, s13, 86528
buffer_load_dwordx4 a[124:127], v117, s[4:7], s11 offen
s_add_u32 s11, s13, 86784
buffer_load_dwordx4 a[180:183], v117, s[4:7], s11 offen
s_add_u32 s11, s13, 87040
buffer_load_dwordx4 a[236:239], v117, s[4:7], s11 offen
s_add_u32 s11, s13, 87296
buffer_load_dwordx4 v[156:159], v117, s[4:7], s11 offen
s_add_u32 s11, s13, 87552
buffer_load_dwordx4 v[212:215], v117, s[4:7], s11 offen
s_add_u32 s11, s13, 114688
buffer_load_dwordx4 a[16:19], v117, s[4:7], s11 offen
s_add_u32 s11, s13, 114944
buffer_load_dwordx4 a[72:75], v117, s[4:7], s11 offen
s_add_u32 s11, s13, 115200
buffer_load_dwordx4 a[128:131], v117, s[4:7], s11 offen
s_add_u32 s11, s13, 115456
buffer_load_dwordx4 a[184:187], v117, s[4:7], s11 offen
s_add_u32 s11, s13, 115712
buffer_load_dwordx4 a[240:243], v117, s[4:7], s11 offen
s_add_u32 s11, s13, 115968
buffer_load_dwordx4 v[160:163], v117, s[4:7], s11 offen
s_add_u32 s11, s13, 116224
buffer_load_dwordx4 v[216:219], v117, s[4:7], s11 offen
s_add_u32 s11, s13, 143360
buffer_load_dwordx4 a[20:23], v117, s[4:7], s11 offen
s_add_u32 s11, s13, 143616
buffer_load_dwordx4 a[76:79], v117, s[4:7], s11 offen
s_add_u32 s11, s13, 143872
buffer_load_dwordx4 a[132:135], v117, s[4:7], s11 offen
s_add_u32 s11, s13, 144128
buffer_load_dwordx4 a[188:191], v117, s[4:7], s11 offen
s_add_u32 s11, s13, 144384
buffer_load_dwordx4 a[244:247], v117, s[4:7], s11 offen
s_add_u32 s11, s13, 144640
buffer_load_dwordx4 v[164:167], v117, s[4:7], s11 offen
s_add_u32 s11, s13, 144896
buffer_load_dwordx4 v[220:223], v117, s[4:7], s11 offen
s_waitcnt vmcnt(32)
s_add_u32 s21, s20, 114688
v_mfma_f32_16x16x32_bf16 v[0:3], v[56:59], a[0:3], 0
v_mfma_f32_16x16x32_bf16 v[4:7], v[60:63], a[0:3], 0
v_mfma_f32_16x16x32_bf16 v[8:11], v[56:59], a[56:59], 0
v_mfma_f32_16x16x32_bf16 v[12:15], v[60:63], a[56:59], 0
v_mfma_f32_16x16x32_bf16 v[16:19], v[56:59], a[112:115], 0
v_mfma_f32_16x16x32_bf16 v[20:23], v[60:63], a[112:115], 0
v_mfma_f32_16x16x32_bf16 v[24:27], v[56:59], a[168:171], 0
v_mfma_f32_16x16x32_bf16 v[28:31], v[60:63], a[168:171], 0
v_mfma_f32_16x16x32_bf16 v[32:35], v[56:59], a[224:227], 0
v_mfma_f32_16x16x32_bf16 v[36:39], v[60:63], a[224:227], 0
v_mfma_f32_16x16x32_bf16 v[40:43], v[56:59], v[144:147], 0
v_mfma_f32_16x16x32_bf16 v[44:47], v[60:63], v[144:147], 0
v_mfma_f32_16x16x32_bf16 v[48:51], v[56:59], v[200:203], 0
v_mfma_f32_16x16x32_bf16 v[52:55], v[60:63], v[200:203], 0
s_add_u32 s11, s20, 4096
buffer_load_dwordx4 v[56:59], v119, s[4:7], s11 offen offset:0
s_add_u32 s11, s20, 16384
buffer_load_dwordx4 v[60:63], v119, s[4:7], s11 offen offset:2048
s_add_u32 s11, s13, 172032
buffer_load_dwordx4 a[24:27], v117, s[4:7], s11 offen
s_add_u32 s11, s13, 172288
buffer_load_dwordx4 a[80:83], v117, s[4:7], s11 offen
s_add_u32 s11, s13, 172544
buffer_load_dwordx4 a[136:139], v117, s[4:7], s11 offen
s_add_u32 s11, s13, 172800
buffer_load_dwordx4 a[192:195], v117, s[4:7], s11 offen
s_add_u32 s11, s13, 173056
buffer_load_dwordx4 a[248:251], v117, s[4:7], s11 offen
s_add_u32 s11, s13, 173312
buffer_load_dwordx4 v[168:171], v117, s[4:7], s11 offen
s_add_u32 s11, s13, 173568
buffer_load_dwordx4 v[224:227], v117, s[4:7], s11 offen
s_waitcnt vmcnt(37)
v_mfma_f32_16x16x32_bf16 v[0:3], v[64:67], a[4:7], v[0:3]
v_mfma_f32_16x16x32_bf16 v[4:7], v[68:71], a[4:7], v[4:7]
v_mfma_f32_16x16x32_bf16 v[8:11], v[64:67], a[60:63], v[8:11]
v_mfma_f32_16x16x32_bf16 v[12:15], v[68:71], a[60:63], v[12:15]
v_mfma_f32_16x16x32_bf16 v[16:19], v[64:67], a[116:119], v[16:19]
v_mfma_f32_16x16x32_bf16 v[20:23], v[68:71], a[116:119], v[20:23]
v_mfma_f32_16x16x32_bf16 v[24:27], v[64:67], a[172:175], v[24:27]
v_mfma_f32_16x16x32_bf16 v[28:31], v[68:71], a[172:175], v[28:31]
v_mfma_f32_16x16x32_bf16 v[32:35], v[64:67], a[228:231], v[32:35]
v_mfma_f32_16x16x32_bf16 v[36:39], v[68:71], a[228:231], v[36:39]
v_mfma_f32_16x16x32_bf16 v[40:43], v[64:67], v[148:151], v[40:43]
v_mfma_f32_16x16x32_bf16 v[44:47], v[68:71], v[148:151], v[44:47]
v_mfma_f32_16x16x32_bf16 v[48:51], v[64:67], v[204:207], v[48:51]
v_mfma_f32_16x16x32_bf16 v[52:55], v[68:71], v[204:207], v[52:55]
s_add_u32 s11, s20, 4096
buffer_load_dwordx4 v[64:67], v119, s[4:7], s11 offen offset:1024
s_add_u32 s11, s20, 16384
buffer_load_dwordx4 v[68:71], v119, s[4:7], s11 offen offset:3072
s_add_u32 s11, s13, 200704
buffer_load_dwordx4 a[28:31], v117, s[4:7], s11 offen
s_add_u32 s11, s13, 200960
buffer_load_dwordx4 a[84:87], v117, s[4:7], s11 offen
s_add_u32 s11, s13, 201216
buffer_load_dwordx4 a[140:143], v117, s[4:7], s11 offen
s_add_u32 s11, s13, 201472
buffer_load_dwordx4 a[196:199], v117, s[4:7], s11 offen
s_add_u32 s11, s13, 201728
buffer_load_dwordx4 a[252:255], v117, s[4:7], s11 offen
s_add_u32 s11, s13, 201984
buffer_load_dwordx4 v[172:175], v117, s[4:7], s11 offen
s_add_u32 s11, s13, 202240
buffer_load_dwordx4 v[228:231], v117, s[4:7], s11 offen
s_waitcnt vmcnt(39)
v_mfma_f32_16x16x32_bf16 v[0:3], v[72:75], a[8:11], v[0:3]
v_mfma_f32_16x16x32_bf16 v[4:7], v[76:79], a[8:11], v[4:7]
v_mfma_f32_16x16x32_bf16 v[8:11], v[72:75], a[64:67], v[8:11]
v_mfma_f32_16x16x32_bf16 v[12:15], v[76:79], a[64:67], v[12:15]
v_mfma_f32_16x16x32_bf16 v[16:19], v[72:75], a[120:123], v[16:19]
v_mfma_f32_16x16x32_bf16 v[20:23], v[76:79], a[120:123], v[20:23]
v_mfma_f32_16x16x32_bf16 v[24:27], v[72:75], a[176:179], v[24:27]
v_mfma_f32_16x16x32_bf16 v[28:31], v[76:79], a[176:179], v[28:31]
v_mfma_f32_16x16x32_bf16 v[32:35], v[72:75], a[232:235], v[32:35]
v_mfma_f32_16x16x32_bf16 v[36:39], v[76:79], a[232:235], v[36:39]
v_mfma_f32_16x16x32_bf16 v[40:43], v[72:75], v[152:155], v[40:43]
v_mfma_f32_16x16x32_bf16 v[44:47], v[76:79], v[152:155], v[44:47]
v_mfma_f32_16x16x32_bf16 v[48:51], v[72:75], v[208:211], v[48:51]
v_mfma_f32_16x16x32_bf16 v[52:55], v[76:79], v[208:211], v[52:55]
s_add_u32 s11, s20, 4096
buffer_load_dwordx4 v[72:75], v119, s[4:7], s11 offen offset:2048
s_add_u32 s11, s20, 20480
buffer_load_dwordx4 v[76:79], v119, s[4:7], s11 offen offset:0
s_add_u32 s11, s13, 229376
buffer_load_dwordx4 a[32:35], v117, s[4:7], s11 offen
s_add_u32 s11, s13, 229632
buffer_load_dwordx4 a[88:91], v117, s[4:7], s11 offen
s_add_u32 s11, s13, 229888
buffer_load_dwordx4 a[144:147], v117, s[4:7], s11 offen
s_add_u32 s11, s13, 230144
buffer_load_dwordx4 a[200:203], v117, s[4:7], s11 offen
s_add_u32 s11, s13, 230400
buffer_load_dwordx4 v[120:123], v117, s[4:7], s11 offen
s_add_u32 s11, s13, 230656
buffer_load_dwordx4 v[176:179], v117, s[4:7], s11 offen
s_add_u32 s11, s13, 230912
buffer_load_dwordx4 v[232:235], v117, s[4:7], s11 offen
s_waitcnt vmcnt(41)
v_mfma_f32_16x16x32_bf16 v[0:3], v[80:83], a[12:15], v[0:3]
v_mfma_f32_16x16x32_bf16 v[4:7], v[84:87], a[12:15], v[4:7]
v_mfma_f32_16x16x32_bf16 v[8:11], v[80:83], a[68:71], v[8:11]
v_mfma_f32_16x16x32_bf16 v[12:15], v[84:87], a[68:71], v[12:15]
v_mfma_f32_16x16x32_bf16 v[16:19], v[80:83], a[124:127], v[16:19]
v_mfma_f32_16x16x32_bf16 v[20:23], v[84:87], a[124:127], v[20:23]
v_mfma_f32_16x16x32_bf16 v[24:27], v[80:83], a[180:183], v[24:27]
v_mfma_f32_16x16x32_bf16 v[28:31], v[84:87], a[180:183], v[28:31]
v_mfma_f32_16x16x32_bf16 v[32:35], v[80:83], a[236:239], v[32:35]
v_mfma_f32_16x16x32_bf16 v[36:39], v[84:87], a[236:239], v[36:39]
v_mfma_f32_16x16x32_bf16 v[40:43], v[80:83], v[156:159], v[40:43]
v_mfma_f32_16x16x32_bf16 v[44:47], v[84:87], v[156:159], v[44:47]
v_mfma_f32_16x16x32_bf16 v[48:51], v[80:83], v[212:215], v[48:51]
v_mfma_f32_16x16x32_bf16 v[52:55], v[84:87], v[212:215], v[52:55]
s_add_u32 s11, s20, 4096
buffer_load_dwordx4 v[80:83], v119, s[4:7], s11 offen offset:3072
s_add_u32 s11, s20, 20480
buffer_load_dwordx4 v[84:87], v119, s[4:7], s11 offen offset:1024
s_add_u32 s11, s13, 258048
buffer_load_dwordx4 a[36:39], v117, s[4:7], s11 offen
s_add_u32 s11, s13, 258304
buffer_load_dwordx4 a[92:95], v117, s[4:7], s11 offen
s_add_u32 s11, s13, 258560
buffer_load_dwordx4 a[148:151], v117, s[4:7], s11 offen
s_add_u32 s11, s13, 258816
buffer_load_dwordx4 a[204:207], v117, s[4:7], s11 offen
s_add_u32 s11, s13, 259072
buffer_load_dwordx4 v[124:127], v117, s[4:7], s11 offen
s_add_u32 s11, s13, 259328
buffer_load_dwordx4 v[180:183], v117, s[4:7], s11 offen
s_add_u32 s11, s13, 259584
buffer_load_dwordx4 v[236:239], v117, s[4:7], s11 offen
s_waitcnt vmcnt(34)
v_mfma_f32_16x16x32_bf16 v[0:3], v[56:59], a[16:19], v[0:3]
v_mfma_f32_16x16x32_bf16 v[4:7], v[60:63], a[16:19], v[4:7]
v_mfma_f32_16x16x32_bf16 v[8:11], v[56:59], a[72:75], v[8:11]
v_mfma_f32_16x16x32_bf16 v[12:15], v[60:63], a[72:75], v[12:15]
v_mfma_f32_16x16x32_bf16 v[16:19], v[56:59], a[128:131], v[16:19]
v_mfma_f32_16x16x32_bf16 v[20:23], v[60:63], a[128:131], v[20:23]
v_mfma_f32_16x16x32_bf16 v[24:27], v[56:59], a[184:187], v[24:27]
v_mfma_f32_16x16x32_bf16 v[28:31], v[60:63], a[184:187], v[28:31]
v_mfma_f32_16x16x32_bf16 v[32:35], v[56:59], a[240:243], v[32:35]
v_mfma_f32_16x16x32_bf16 v[36:39], v[60:63], a[240:243], v[36:39]
v_mfma_f32_16x16x32_bf16 v[40:43], v[56:59], v[160:163], v[40:43]
v_mfma_f32_16x16x32_bf16 v[44:47], v[60:63], v[160:163], v[44:47]
v_mfma_f32_16x16x32_bf16 v[48:51], v[56:59], v[216:219], v[48:51]
v_mfma_f32_16x16x32_bf16 v[52:55], v[60:63], v[216:219], v[52:55]
s_add_u32 s11, s20, 8192
buffer_load_dwordx4 v[56:59], v119, s[4:7], s11 offen offset:0
s_add_u32 s11, s20, 20480
buffer_load_dwordx4 v[60:63], v119, s[4:7], s11 offen offset:2048
s_add_u32 s11, s13, 286720
buffer_load_dwordx4 a[40:43], v117, s[4:7], s11 offen
s_add_u32 s11, s13, 286976
buffer_load_dwordx4 a[96:99], v117, s[4:7], s11 offen
s_add_u32 s11, s13, 287232
buffer_load_dwordx4 a[152:155], v117, s[4:7], s11 offen
s_add_u32 s11, s13, 287488
buffer_load_dwordx4 a[208:211], v117, s[4:7], s11 offen
s_add_u32 s11, s13, 287744
buffer_load_dwordx4 v[128:131], v117, s[4:7], s11 offen
s_add_u32 s11, s13, 288000
buffer_load_dwordx4 v[184:187], v117, s[4:7], s11 offen
s_add_u32 s11, s13, 288256
buffer_load_dwordx4 v[240:243], v117, s[4:7], s11 offen
s_waitcnt vmcnt(34)
v_mfma_f32_16x16x32_bf16 v[0:3], v[64:67], a[20:23], v[0:3]
v_mfma_f32_16x16x32_bf16 v[4:7], v[68:71], a[20:23], v[4:7]
v_mfma_f32_16x16x32_bf16 v[8:11], v[64:67], a[76:79], v[8:11]
v_mfma_f32_16x16x32_bf16 v[12:15], v[68:71], a[76:79], v[12:15]
v_mfma_f32_16x16x32_bf16 v[16:19], v[64:67], a[132:135], v[16:19]
v_mfma_f32_16x16x32_bf16 v[20:23], v[68:71], a[132:135], v[20:23]
v_mfma_f32_16x16x32_bf16 v[24:27], v[64:67], a[188:191], v[24:27]
v_mfma_f32_16x16x32_bf16 v[28:31], v[68:71], a[188:191], v[28:31]
v_mfma_f32_16x16x32_bf16 v[32:35], v[64:67], a[244:247], v[32:35]
v_mfma_f32_16x16x32_bf16 v[36:39], v[68:71], a[244:247], v[36:39]
v_mfma_f32_16x16x32_bf16 v[40:43], v[64:67], v[164:167], v[40:43]
v_mfma_f32_16x16x32_bf16 v[44:47], v[68:71], v[164:167], v[44:47]
v_mfma_f32_16x16x32_bf16 v[48:51], v[64:67], v[220:223], v[48:51]
v_mfma_f32_16x16x32_bf16 v[52:55], v[68:71], v[220:223], v[52:55]
s_add_u32 s11, s20, 8192
buffer_load_dwordx4 v[64:67], v119, s[4:7], s11 offen offset:1024
s_add_u32 s11, s20, 20480
buffer_load_dwordx4 v[68:71], v119, s[4:7], s11 offen offset:3072
s_add_u32 s11, s13, 315392
buffer_load_dwordx4 a[44:47], v117, s[4:7], s11 offen
s_add_u32 s11, s13, 315648
buffer_load_dwordx4 a[100:103], v117, s[4:7], s11 offen
s_add_u32 s11, s13, 315904
buffer_load_dwordx4 a[156:159], v117, s[4:7], s11 offen
s_add_u32 s11, s13, 316160
buffer_load_dwordx4 a[212:215], v117, s[4:7], s11 offen
s_add_u32 s11, s13, 316416
buffer_load_dwordx4 v[132:135], v117, s[4:7], s11 offen
s_add_u32 s11, s13, 316672
buffer_load_dwordx4 v[188:191], v117, s[4:7], s11 offen
s_add_u32 s11, s13, 316928
buffer_load_dwordx4 v[244:247], v117, s[4:7], s11 offen
s_waitcnt vmcnt(34)
v_mfma_f32_16x16x32_bf16 v[0:3], v[72:75], a[24:27], v[0:3]
v_mfma_f32_16x16x32_bf16 v[4:7], v[76:79], a[24:27], v[4:7]
v_mfma_f32_16x16x32_bf16 v[8:11], v[72:75], a[80:83], v[8:11]
v_mfma_f32_16x16x32_bf16 v[12:15], v[76:79], a[80:83], v[12:15]
v_mfma_f32_16x16x32_bf16 v[16:19], v[72:75], a[136:139], v[16:19]
v_mfma_f32_16x16x32_bf16 v[20:23], v[76:79], a[136:139], v[20:23]
v_mfma_f32_16x16x32_bf16 v[24:27], v[72:75], a[192:195], v[24:27]
v_mfma_f32_16x16x32_bf16 v[28:31], v[76:79], a[192:195], v[28:31]
v_mfma_f32_16x16x32_bf16 v[32:35], v[72:75], a[248:251], v[32:35]
v_mfma_f32_16x16x32_bf16 v[36:39], v[76:79], a[248:251], v[36:39]
v_mfma_f32_16x16x32_bf16 v[40:43], v[72:75], v[168:171], v[40:43]
v_mfma_f32_16x16x32_bf16 v[44:47], v[76:79], v[168:171], v[44:47]
v_mfma_f32_16x16x32_bf16 v[48:51], v[72:75], v[224:227], v[48:51]
v_mfma_f32_16x16x32_bf16 v[52:55], v[76:79], v[224:227], v[52:55]
s_add_u32 s11, s20, 8192
buffer_load_dwordx4 v[72:75], v119, s[4:7], s11 offen offset:2048
s_add_u32 s11, s20, 24576
buffer_load_dwordx4 v[76:79], v119, s[4:7], s11 offen offset:0
s_add_u32 s11, s13, 344064
buffer_load_dwordx4 a[48:51], v117, s[4:7], s11 offen
s_add_u32 s11, s13, 344320
buffer_load_dwordx4 a[104:107], v117, s[4:7], s11 offen
s_add_u32 s11, s13, 344576
buffer_load_dwordx4 a[160:163], v117, s[4:7], s11 offen
s_add_u32 s11, s13, 344832
buffer_load_dwordx4 a[216:219], v117, s[4:7], s11 offen
s_add_u32 s11, s13, 345088
buffer_load_dwordx4 v[136:139], v117, s[4:7], s11 offen
s_add_u32 s11, s13, 345344
buffer_load_dwordx4 v[192:195], v117, s[4:7], s11 offen
s_add_u32 s11, s13, 345600
buffer_load_dwordx4 v[248:251], v117, s[4:7], s11 offen
s_waitcnt vmcnt(34)
v_mfma_f32_16x16x32_bf16 v[0:3], v[80:83], a[28:31], v[0:3]
v_mfma_f32_16x16x32_bf16 v[4:7], v[84:87], a[28:31], v[4:7]
v_mfma_f32_16x16x32_bf16 v[8:11], v[80:83], a[84:87], v[8:11]
v_mfma_f32_16x16x32_bf16 v[12:15], v[84:87], a[84:87], v[12:15]
v_mfma_f32_16x16x32_bf16 v[16:19], v[80:83], a[140:143], v[16:19]
v_mfma_f32_16x16x32_bf16 v[20:23], v[84:87], a[140:143], v[20:23]
v_mfma_f32_16x16x32_bf16 v[24:27], v[80:83], a[196:199], v[24:27]
v_mfma_f32_16x16x32_bf16 v[28:31], v[84:87], a[196:199], v[28:31]
v_mfma_f32_16x16x32_bf16 v[32:35], v[80:83], a[252:255], v[32:35]
v_mfma_f32_16x16x32_bf16 v[36:39], v[84:87], a[252:255], v[36:39]
v_mfma_f32_16x16x32_bf16 v[40:43], v[80:83], v[172:175], v[40:43]
v_mfma_f32_16x16x32_bf16 v[44:47], v[84:87], v[172:175], v[44:47]
v_mfma_f32_16x16x32_bf16 v[48:51], v[80:83], v[228:231], v[48:51]
v_mfma_f32_16x16x32_bf16 v[52:55], v[84:87], v[228:231], v[52:55]
s_add_u32 s11, s20, 8192
buffer_load_dwordx4 v[80:83], v119, s[4:7], s11 offen offset:3072
s_add_u32 s11, s20, 24576
buffer_load_dwordx4 v[84:87], v119, s[4:7], s11 offen offset:1024
s_add_u32 s11, s13, 372736
buffer_load_dwordx4 a[52:55], v117, s[4:7], s11 offen
s_add_u32 s11, s13, 372992
buffer_load_dwordx4 a[108:111], v117, s[4:7], s11 offen
s_add_u32 s11, s13, 373248
buffer_load_dwordx4 a[164:167], v117, s[4:7], s11 offen
s_add_u32 s11, s13, 373504
buffer_load_dwordx4 a[220:223], v117, s[4:7], s11 offen
s_add_u32 s11, s13, 373760
buffer_load_dwordx4 v[140:143], v117, s[4:7], s11 offen
s_add_u32 s11, s13, 374016
buffer_load_dwordx4 v[196:199], v117, s[4:7], s11 offen
s_add_u32 s11, s13, 374272
buffer_load_dwordx4 v[252:255], v117, s[4:7], s11 offen
s_waitcnt vmcnt(34)
v_mfma_f32_16x16x32_bf16 v[0:3], v[56:59], a[32:35], v[0:3]
v_mfma_f32_16x16x32_bf16 v[4:7], v[60:63], a[32:35], v[4:7]
v_mfma_f32_16x16x32_bf16 v[8:11], v[56:59], a[88:91], v[8:11]
v_mfma_f32_16x16x32_bf16 v[12:15], v[60:63], a[88:91], v[12:15]
v_mfma_f32_16x16x32_bf16 v[16:19], v[56:59], a[144:147], v[16:19]
v_mfma_f32_16x16x32_bf16 v[20:23], v[60:63], a[144:147], v[20:23]
v_mfma_f32_16x16x32_bf16 v[24:27], v[56:59], a[200:203], v[24:27]
v_mfma_f32_16x16x32_bf16 v[28:31], v[60:63], a[200:203], v[28:31]
v_mfma_f32_16x16x32_bf16 v[32:35], v[56:59], v[120:123], v[32:35]
v_mfma_f32_16x16x32_bf16 v[36:39], v[60:63], v[120:123], v[36:39]
v_mfma_f32_16x16x32_bf16 v[40:43], v[56:59], v[176:179], v[40:43]
v_mfma_f32_16x16x32_bf16 v[44:47], v[60:63], v[176:179], v[44:47]
v_mfma_f32_16x16x32_bf16 v[48:51], v[56:59], v[232:235], v[48:51]
v_mfma_f32_16x16x32_bf16 v[52:55], v[60:63], v[232:235], v[52:55]
s_add_u32 s11, s20, 12288
buffer_load_dwordx4 v[56:59], v119, s[4:7], s11 offen offset:0
s_add_u32 s11, s20, 24576
buffer_load_dwordx4 v[60:63], v119, s[4:7], s11 offen offset:2048
s_waitcnt vmcnt(27)
v_mfma_f32_16x16x32_bf16 v[0:3], v[64:67], a[36:39], v[0:3]
v_mfma_f32_16x16x32_bf16 v[4:7], v[68:71], a[36:39], v[4:7]
v_mfma_f32_16x16x32_bf16 v[8:11], v[64:67], a[92:95], v[8:11]
v_mfma_f32_16x16x32_bf16 v[12:15], v[68:71], a[92:95], v[12:15]
v_mfma_f32_16x16x32_bf16 v[16:19], v[64:67], a[148:151], v[16:19]
v_mfma_f32_16x16x32_bf16 v[20:23], v[68:71], a[148:151], v[20:23]
v_mfma_f32_16x16x32_bf16 v[24:27], v[64:67], a[204:207], v[24:27]
v_mfma_f32_16x16x32_bf16 v[28:31], v[68:71], a[204:207], v[28:31]
v_mfma_f32_16x16x32_bf16 v[32:35], v[64:67], v[124:127], v[32:35]
v_mfma_f32_16x16x32_bf16 v[36:39], v[68:71], v[124:127], v[36:39]
v_mfma_f32_16x16x32_bf16 v[40:43], v[64:67], v[180:183], v[40:43]
v_mfma_f32_16x16x32_bf16 v[44:47], v[68:71], v[180:183], v[44:47]
v_mfma_f32_16x16x32_bf16 v[48:51], v[64:67], v[236:239], v[48:51]
v_mfma_f32_16x16x32_bf16 v[52:55], v[68:71], v[236:239], v[52:55]
s_add_u32 s11, s20, 12288
buffer_load_dwordx4 v[64:67], v119, s[4:7], s11 offen offset:1024
s_add_u32 s11, s20, 24576
buffer_load_dwordx4 v[68:71], v119, s[4:7], s11 offen offset:3072
s_waitcnt vmcnt(20)
v_mfma_f32_16x16x32_bf16 v[0:3], v[72:75], a[40:43], v[0:3]
v_mfma_f32_16x16x32_bf16 v[4:7], v[76:79], a[40:43], v[4:7]
v_mfma_f32_16x16x32_bf16 v[8:11], v[72:75], a[96:99], v[8:11]
v_mfma_f32_16x16x32_bf16 v[12:15], v[76:79], a[96:99], v[12:15]
v_mfma_f32_16x16x32_bf16 v[16:19], v[72:75], a[152:155], v[16:19]
v_mfma_f32_16x16x32_bf16 v[20:23], v[76:79], a[152:155], v[20:23]
v_mfma_f32_16x16x32_bf16 v[24:27], v[72:75], a[208:211], v[24:27]
v_mfma_f32_16x16x32_bf16 v[28:31], v[76:79], a[208:211], v[28:31]
v_mfma_f32_16x16x32_bf16 v[32:35], v[72:75], v[128:131], v[32:35]
v_mfma_f32_16x16x32_bf16 v[36:39], v[76:79], v[128:131], v[36:39]
v_mfma_f32_16x16x32_bf16 v[40:43], v[72:75], v[184:187], v[40:43]
v_mfma_f32_16x16x32_bf16 v[44:47], v[76:79], v[184:187], v[44:47]
v_mfma_f32_16x16x32_bf16 v[48:51], v[72:75], v[240:243], v[48:51]
v_mfma_f32_16x16x32_bf16 v[52:55], v[76:79], v[240:243], v[52:55]
s_waitcnt vmcnt(11)
v_mfma_f32_16x16x32_bf16 v[0:3], v[80:83], a[44:47], v[0:3]
v_mfma_f32_16x16x32_bf16 v[4:7], v[84:87], a[44:47], v[4:7]
v_mfma_f32_16x16x32_bf16 v[8:11], v[80:83], a[100:103], v[8:11]
v_mfma_f32_16x16x32_bf16 v[12:15], v[84:87], a[100:103], v[12:15]
v_mfma_f32_16x16x32_bf16 v[16:19], v[80:83], a[156:159], v[16:19]
v_mfma_f32_16x16x32_bf16 v[20:23], v[84:87], a[156:159], v[20:23]
v_mfma_f32_16x16x32_bf16 v[24:27], v[80:83], a[212:215], v[24:27]
v_mfma_f32_16x16x32_bf16 v[28:31], v[84:87], a[212:215], v[28:31]
v_mfma_f32_16x16x32_bf16 v[32:35], v[80:83], v[132:135], v[32:35]
v_mfma_f32_16x16x32_bf16 v[36:39], v[84:87], v[132:135], v[36:39]
v_mfma_f32_16x16x32_bf16 v[40:43], v[80:83], v[188:191], v[40:43]
v_mfma_f32_16x16x32_bf16 v[44:47], v[84:87], v[188:191], v[44:47]
v_mfma_f32_16x16x32_bf16 v[48:51], v[80:83], v[244:247], v[48:51]
v_mfma_f32_16x16x32_bf16 v[52:55], v[84:87], v[244:247], v[52:55]
s_waitcnt vmcnt(2)
v_mfma_f32_16x16x32_bf16 v[0:3], v[56:59], a[48:51], v[0:3]
v_mfma_f32_16x16x32_bf16 v[4:7], v[60:63], a[48:51], v[4:7]
v_mfma_f32_16x16x32_bf16 v[8:11], v[56:59], a[104:107], v[8:11]
v_mfma_f32_16x16x32_bf16 v[12:15], v[60:63], a[104:107], v[12:15]
v_mfma_f32_16x16x32_bf16 v[16:19], v[56:59], a[160:163], v[16:19]
v_mfma_f32_16x16x32_bf16 v[20:23], v[60:63], a[160:163], v[20:23]
v_mfma_f32_16x16x32_bf16 v[24:27], v[56:59], a[216:219], v[24:27]
v_mfma_f32_16x16x32_bf16 v[28:31], v[60:63], a[216:219], v[28:31]
v_mfma_f32_16x16x32_bf16 v[32:35], v[56:59], v[136:139], v[32:35]
v_mfma_f32_16x16x32_bf16 v[36:39], v[60:63], v[136:139], v[36:39]
v_mfma_f32_16x16x32_bf16 v[40:43], v[56:59], v[192:195], v[40:43]
v_mfma_f32_16x16x32_bf16 v[44:47], v[60:63], v[192:195], v[44:47]
v_mfma_f32_16x16x32_bf16 v[48:51], v[56:59], v[248:251], v[48:51]
v_mfma_f32_16x16x32_bf16 v[52:55], v[60:63], v[248:251], v[52:55]
s_waitcnt vmcnt(0)
v_mfma_f32_16x16x32_bf16 v[0:3], v[64:67], a[52:55], v[0:3]
v_mfma_f32_16x16x32_bf16 v[4:7], v[68:71], a[52:55], v[4:7]
v_mfma_f32_16x16x32_bf16 v[8:11], v[64:67], a[108:111], v[8:11]
v_mfma_f32_16x16x32_bf16 v[12:15], v[68:71], a[108:111], v[12:15]
v_mfma_f32_16x16x32_bf16 v[16:19], v[64:67], a[164:167], v[16:19]
v_mfma_f32_16x16x32_bf16 v[20:23], v[68:71], a[164:167], v[20:23]
v_mfma_f32_16x16x32_bf16 v[24:27], v[64:67], a[220:223], v[24:27]
v_mfma_f32_16x16x32_bf16 v[28:31], v[68:71], a[220:223], v[28:31]
v_mfma_f32_16x16x32_bf16 v[32:35], v[64:67], v[140:143], v[32:35]
v_mfma_f32_16x16x32_bf16 v[36:39], v[68:71], v[140:143], v[36:39]
v_mfma_f32_16x16x32_bf16 v[40:43], v[64:67], v[196:199], v[40:43]
v_mfma_f32_16x16x32_bf16 v[44:47], v[68:71], v[196:199], v[44:47]
v_mfma_f32_16x16x32_bf16 v[48:51], v[64:67], v[252:255], v[48:51]
v_mfma_f32_16x16x32_bf16 v[52:55], v[68:71], v[252:255], v[52:55]
s_add_u32 s11, s21, 0
buffer_load_dwordx4 v[56:59], v119, s[4:7], s11 offen offset:0
s_add_u32 s11, s21, 12288
buffer_load_dwordx4 v[60:63], v119, s[4:7], s11 offen offset:2048
s_add_u32 s11, s21, 0
buffer_load_dwordx4 v[64:67], v119, s[4:7], s11 offen offset:1024
s_add_u32 s11, s21, 12288
buffer_load_dwordx4 v[68:71], v119, s[4:7], s11 offen offset:3072
s_add_u32 s11, s21, 0
buffer_load_dwordx4 v[72:75], v119, s[4:7], s11 offen offset:2048
s_add_u32 s11, s21, 16384
buffer_load_dwordx4 v[76:79], v119, s[4:7], s11 offen offset:0
s_add_u32 s11, s21, 0
buffer_load_dwordx4 v[80:83], v119, s[4:7], s11 offen offset:3072
s_add_u32 s11, s21, 16384
buffer_load_dwordx4 v[84:87], v119, s[4:7], s11 offen offset:1024
s_branch WV_epi
WV_loop:
s_add_u32 s21, s20, 114688
s_waitcnt vmcnt(6)
v_mfma_f32_16x16x32_bf16 v[0:3], v[56:59], a[0:3], 0
v_mfma_f32_16x16x32_bf16 v[4:7], v[60:63], a[0:3], 0
v_mfma_f32_16x16x32_bf16 v[8:11], v[56:59], a[56:59], 0
v_mfma_f32_16x16x32_bf16 v[12:15], v[60:63], a[56:59], 0
v_mfma_f32_16x16x32_bf16 v[16:19], v[56:59], a[112:115], 0
v_mfma_f32_16x16x32_bf16 v[20:23], v[60:63], a[112:115], 0
v_mfma_f32_16x16x32_bf16 v[24:27], v[56:59], a[168:171], 0
v_mfma_f32_16x16x32_bf16 v[28:31], v[60:63], a[168:171], 0
v_mfma_f32_16x16x32_bf16 v[32:35], v[56:59], a[224:227], 0
v_mfma_f32_16x16x32_bf16 v[36:39], v[60:63], a[224:227], 0
v_mfma_f32_16x16x32_bf16 v[40:43], v[56:59], v[144:147], 0
v_mfma_f32_16x16x32_bf16 v[44:47], v[60:63], v[144:147], 0
v_mfma_f32_16x16x32_bf16 v[48:51], v[56:59], v[200:203], 0
v_mfma_f32_16x16x32_bf16 v[52:55], v[60:63], v[200:203], 0
s_add_u32 s11, s20, 4096
buffer_load_dwordx4 v[56:59], v119, s[4:7], s11 offen offset:0
s_add_u32 s11, s20, 16384
buffer_load_dwordx4 v[60:63], v119, s[4:7], s11 offen offset:2048
s_waitcnt vmcnt(6)
v_mfma_f32_16x16x32_bf16 v[0:3], v[64:67], a[4:7], v[0:3]
v_mfma_f32_16x16x32_bf16 v[4:7], v[68:71], a[4:7], v[4:7]
v_mfma_f32_16x16x32_bf16 v[8:11], v[64:67], a[60:63], v[8:11]
v_mfma_f32_16x16x32_bf16 v[12:15], v[68:71], a[60:63], v[12:15]
v_mfma_f32_16x16x32_bf16 v[16:19], v[64:67], a[116:119], v[16:19]
v_mfma_f32_16x16x32_bf16 v[20:23], v[68:71], a[116:119], v[20:23]
v_mfma_f32_16x16x32_bf16 v[24:27], v[64:67], a[172:175], v[24:27]
v_mfma_f32_16x16x32_bf16 v[28:31], v[68:71], a[172:175], v[28:31]
v_mfma_f32_16x16x32_bf16 v[32:35], v[64:67], a[228:231], v[32:35]
v_mfma_f32_16x16x32_bf16 v[36:39], v[68:71], a[228:231], v[36:39]
v_mfma_f32_16x16x32_bf16 v[40:43], v[64:67], v[148:151], v[40:43]
v_mfma_f32_16x16x32_bf16 v[44:47], v[68:71], v[148:151], v[44:47]
v_mfma_f32_16x16x32_bf16 v[48:51], v[64:67], v[204:207], v[48:51]
v_mfma_f32_16x16x32_bf16 v[52:55], v[68:71], v[204:207], v[52:55]
s_add_u32 s11, s20, 4096
buffer_load_dwordx4 v[64:67], v119, s[4:7], s11 offen offset:1024
s_add_u32 s11, s20, 16384
buffer_load_dwordx4 v[68:71], v119, s[4:7], s11 offen offset:3072
s_waitcnt vmcnt(6)
v_mfma_f32_16x16x32_bf16 v[0:3], v[72:75], a[8:11], v[0:3]
v_mfma_f32_16x16x32_bf16 v[4:7], v[76:79], a[8:11], v[4:7]
v_mfma_f32_16x16x32_bf16 v[8:11], v[72:75], a[64:67], v[8:11]
v_mfma_f32_16x16x32_bf16 v[12:15], v[76:79], a[64:67], v[12:15]
v_mfma_f32_16x16x32_bf16 v[16:19], v[72:75], a[120:123], v[16:19]
v_mfma_f32_16x16x32_bf16 v[20:23], v[76:79], a[120:123], v[20:23]
v_mfma_f32_16x16x32_bf16 v[24:27], v[72:75], a[176:179], v[24:27]
v_mfma_f32_16x16x32_bf16 v[28:31], v[76:79], a[176:179], v[28:31]
v_mfma_f32_16x16x32_bf16 v[32:35], v[72:75], a[232:235], v[32:35]
v_mfma_f32_16x16x32_bf16 v[36:39], v[76:79], a[232:235], v[36:39]
v_mfma_f32_16x16x32_bf16 v[40:43], v[72:75], v[152:155], v[40:43]
v_mfma_f32_16x16x32_bf16 v[44:47], v[76:79], v[152:155], v[44:47]
v_mfma_f32_16x16x32_bf16 v[48:51], v[72:75], v[208:211], v[48:51]
v_mfma_f32_16x16x32_bf16 v[52:55], v[76:79], v[208:211], v[52:55]
s_add_u32 s11, s20, 4096
buffer_load_dwordx4 v[72:75], v119, s[4:7], s11 offen offset:2048
s_add_u32 s11, s20, 20480
buffer_load_dwordx4 v[76:79], v119, s[4:7], s11 offen offset:0
s_waitcnt vmcnt(6)
v_mfma_f32_16x16x32_bf16 v[0:3], v[80:83], a[12:15], v[0:3]
v_mfma_f32_16x16x32_bf16 v[4:7], v[84:87], a[12:15], v[4:7]
v_mfma_f32_16x16x32_bf16 v[8:11], v[80:83], a[68:71], v[8:11]
v_mfma_f32_16x16x32_bf16 v[12:15], v[84:87], a[68:71], v[12:15]
v_mfma_f32_16x16x32_bf16 v[16:19], v[80:83], a[124:127], v[16:19]
v_mfma_f32_16x16x32_bf16 v[20:23], v[84:87], a[124:127], v[20:23]
v_mfma_f32_16x16x32_bf16 v[24:27], v[80:83], a[180:183], v[24:27]
v_mfma_f32_16x16x32_bf16 v[28:31], v[84:87], a[180:183], v[28:31]
v_mfma_f32_16x16x32_bf16 v[32:35], v[80:83], a[236:239], v[32:35]
v_mfma_f32_16x16x32_bf16 v[36:39], v[84:87], a[236:239], v[36:39]
v_mfma_f32_16x16x32_bf16 v[40:43], v[80:83], v[156:159], v[40:43]
v_mfma_f32_16x16x32_bf16 v[44:47], v[84:87], v[156:159], v[44:47]
v_mfma_f32_16x16x32_bf16 v[48:51], v[80:83], v[212:215], v[48:51]
v_mfma_f32_16x16x32_bf16 v[52:55], v[84:87], v[212:215], v[52:55]
s_add_u32 s11, s20, 4096
buffer_load_dwordx4 v[80:83], v119, s[4:7], s11 offen offset:3072
s_add_u32 s11, s20, 20480
buffer_load_dwordx4 v[84:87], v119, s[4:7], s11 offen offset:1024
s_waitcnt vmcnt(6)
v_mfma_f32_16x16x32_bf16 v[0:3], v[56:59], a[16:19], v[0:3]
v_mfma_f32_16x16x32_bf16 v[4:7], v[60:63], a[16:19], v[4:7]
v_mfma_f32_16x16x32_bf16 v[8:11], v[56:59], a[72:75], v[8:11]
v_mfma_f32_16x16x32_bf16 v[12:15], v[60:63], a[72:75], v[12:15]
v_mfma_f32_16x16x32_bf16 v[16:19], v[56:59], a[128:131], v[16:19]
v_mfma_f32_16x16x32_bf16 v[20:23], v[60:63], a[128:131], v[20:23]
v_mfma_f32_16x16x32_bf16 v[24:27], v[56:59], a[184:187], v[24:27]
v_mfma_f32_16x16x32_bf16 v[28:31], v[60:63], a[184:187], v[28:31]
v_mfma_f32_16x16x32_bf16 v[32:35], v[56:59], a[240:243], v[32:35]
v_mfma_f32_16x16x32_bf16 v[36:39], v[60:63], a[240:243], v[36:39]
v_mfma_f32_16x16x32_bf16 v[40:43], v[56:59], v[160:163], v[40:43]
v_mfma_f32_16x16x32_bf16 v[44:47], v[60:63], v[160:163], v[44:47]
v_mfma_f32_16x16x32_bf16 v[48:51], v[56:59], v[216:219], v[48:51]
v_mfma_f32_16x16x32_bf16 v[52:55], v[60:63], v[216:219], v[52:55]
s_add_u32 s11, s20, 8192
buffer_load_dwordx4 v[56:59], v119, s[4:7], s11 offen offset:0
s_add_u32 s11, s20, 20480
buffer_load_dwordx4 v[60:63], v119, s[4:7], s11 offen offset:2048
s_waitcnt vmcnt(6)
v_mfma_f32_16x16x32_bf16 v[0:3], v[64:67], a[20:23], v[0:3]
v_mfma_f32_16x16x32_bf16 v[4:7], v[68:71], a[20:23], v[4:7]
v_mfma_f32_16x16x32_bf16 v[8:11], v[64:67], a[76:79], v[8:11]
v_mfma_f32_16x16x32_bf16 v[12:15], v[68:71], a[76:79], v[12:15]
v_mfma_f32_16x16x32_bf16 v[16:19], v[64:67], a[132:135], v[16:19]
v_mfma_f32_16x16x32_bf16 v[20:23], v[68:71], a[132:135], v[20:23]
v_mfma_f32_16x16x32_bf16 v[24:27], v[64:67], a[188:191], v[24:27]
v_mfma_f32_16x16x32_bf16 v[28:31], v[68:71], a[188:191], v[28:31]
v_mfma_f32_16x16x32_bf16 v[32:35], v[64:67], a[244:247], v[32:35]
v_mfma_f32_16x16x32_bf16 v[36:39], v[68:71], a[244:247], v[36:39]
v_mfma_f32_16x16x32_bf16 v[40:43], v[64:67], v[164:167], v[40:43]
v_mfma_f32_16x16x32_bf16 v[44:47], v[68:71], v[164:167], v[44:47]
v_mfma_f32_16x16x32_bf16 v[48:51], v[64:67], v[220:223], v[48:51]
v_mfma_f32_16x16x32_bf16 v[52:55], v[68:71], v[220:223], v[52:55]
s_add_u32 s11, s20, 8192
buffer_load_dwordx4 v[64:67], v119, s[4:7], s11 offen offset:1024
s_add_u32 s11, s20, 20480
buffer_load_dwordx4 v[68:71], v119, s[4:7], s11 offen offset:3072
s_waitcnt vmcnt(6)
v_mfma_f32_16x16x32_bf16 v[0:3], v[72:75], a[24:27], v[0:3]
v_mfma_f32_16x16x32_bf16 v[4:7], v[76:79], a[24:27], v[4:7]
v_mfma_f32_16x16x32_bf16 v[8:11], v[72:75], a[80:83], v[8:11]
v_mfma_f32_16x16x32_bf16 v[12:15], v[76:79], a[80:83], v[12:15]
v_mfma_f32_16x16x32_bf16 v[16:19], v[72:75], a[136:139], v[16:19]
v_mfma_f32_16x16x32_bf16 v[20:23], v[76:79], a[136:139], v[20:23]
v_mfma_f32_16x16x32_bf16 v[24:27], v[72:75], a[192:195], v[24:27]
v_mfma_f32_16x16x32_bf16 v[28:31], v[76:79], a[192:195], v[28:31]
v_mfma_f32_16x16x32_bf16 v[32:35], v[72:75], a[248:251], v[32:35]
v_mfma_f32_16x16x32_bf16 v[36:39], v[76:79], a[248:251], v[36:39]
v_mfma_f32_16x16x32_bf16 v[40:43], v[72:75], v[168:171], v[40:43]
v_mfma_f32_16x16x32_bf16 v[44:47], v[76:79], v[168:171], v[44:47]
v_mfma_f32_16x16x32_bf16 v[48:51], v[72:75], v[224:227], v[48:51]
v_mfma_f32_16x16x32_bf16 v[52:55], v[76:79], v[224:227], v[52:55]
s_add_u32 s11, s20, 8192
buffer_load_dwordx4 v[72:75], v119, s[4:7], s11 offen offset:2048
s_add_u32 s11, s20, 24576
buffer_load_dwordx4 v[76:79], v119, s[4:7], s11 offen offset:0
s_waitcnt vmcnt(6)
v_mfma_f32_16x16x32_bf16 v[0:3], v[80:83], a[28:31], v[0:3]
v_mfma_f32_16x16x32_bf16 v[4:7], v[84:87], a[28:31], v[4:7]
v_mfma_f32_16x16x32_bf16 v[8:11], v[80:83], a[84:87], v[8:11]
v_mfma_f32_16x16x32_bf16 v[12:15], v[84:87], a[84:87], v[12:15]
v_mfma_f32_16x16x32_bf16 v[16:19], v[80:83], a[140:143], v[16:19]
v_mfma_f32_16x16x32_bf16 v[20:23], v[84:87], a[140:143], v[20:23]
v_mfma_f32_16x16x32_bf16 v[24:27], v[80:83], a[196:199], v[24:27]
v_mfma_f32_16x16x32_bf16 v[28:31], v[84:87], a[196:199], v[28:31]
v_mfma_f32_16x16x32_bf16 v[32:35], v[80:83], a[252:255], v[32:35]
v_mfma_f32_16x16x32_bf16 v[36:39], v[84:87], a[252:255], v[36:39]
v_mfma_f32_16x16x32_bf16 v[40:43], v[80:83], v[172:175], v[40:43]
v_mfma_f32_16x16x32_bf16 v[44:47], v[84:87], v[172:175], v[44:47]
v_mfma_f32_16x16x32_bf16 v[48:51], v[80:83], v[228:231], v[48:51]
v_mfma_f32_16x16x32_bf16 v[52:55], v[84:87], v[228:231], v[52:55]
s_add_u32 s11, s20, 8192
buffer_load_dwordx4 v[80:83], v119, s[4:7], s11 offen offset:3072
s_add_u32 s11, s20, 24576
buffer_load_dwordx4 v[84:87], v119, s[4:7], s11 offen offset:1024
s_waitcnt vmcnt(6)
v_mfma_f32_16x16x32_bf16 v[0:3], v[56:59], a[32:35], v[0:3]
v_mfma_f32_16x16x32_bf16 v[4:7], v[60:63], a[32:35], v[4:7]
v_mfma_f32_16x16x32_bf16 v[8:11], v[56:59], a[88:91], v[8:11]
v_mfma_f32_16x16x32_bf16 v[12:15], v[60:63], a[88:91], v[12:15]
v_mfma_f32_16x16x32_bf16 v[16:19], v[56:59], a[144:147], v[16:19]
v_mfma_f32_16x16x32_bf16 v[20:23], v[60:63], a[144:147], v[20:23]
v_mfma_f32_16x16x32_bf16 v[24:27], v[56:59], a[200:203], v[24:27]
v_mfma_f32_16x16x32_bf16 v[28:31], v[60:63], a[200:203], v[28:31]
v_mfma_f32_16x16x32_bf16 v[32:35], v[56:59], v[120:123], v[32:35]
v_mfma_f32_16x16x32_bf16 v[36:39], v[60:63], v[120:123], v[36:39]
v_mfma_f32_16x16x32_bf16 v[40:43], v[56:59], v[176:179], v[40:43]
v_mfma_f32_16x16x32_bf16 v[44:47], v[60:63], v[176:179], v[44:47]
v_mfma_f32_16x16x32_bf16 v[48:51], v[56:59], v[232:235], v[48:51]
v_mfma_f32_16x16x32_bf16 v[52:55], v[60:63], v[232:235], v[52:55]
s_add_u32 s11, s20, 12288
buffer_load_dwordx4 v[56:59], v119, s[4:7], s11 offen offset:0
s_add_u32 s11, s20, 24576
buffer_load_dwordx4 v[60:63], v119, s[4:7], s11 offen offset:2048
s_waitcnt vmcnt(6)
v_mfma_f32_16x16x32_bf16 v[0:3], v[64:67], a[36:39], v[0:3]
v_mfma_f32_16x16x32_bf16 v[4:7], v[68:71], a[36:39], v[4:7]
v_mfma_f32_16x16x32_bf16 v[8:11], v[64:67], a[92:95], v[8:11]
v_mfma_f32_16x16x32_bf16 v[12:15], v[68:71], a[92:95], v[12:15]
v_mfma_f32_16x16x32_bf16 v[16:19], v[64:67], a[148:151], v[16:19]
v_mfma_f32_16x16x32_bf16 v[20:23], v[68:71], a[148:151], v[20:23]
v_mfma_f32_16x16x32_bf16 v[24:27], v[64:67], a[204:207], v[24:27]
v_mfma_f32_16x16x32_bf16 v[28:31], v[68:71], a[204:207], v[28:31]
v_mfma_f32_16x16x32_bf16 v[32:35], v[64:67], v[124:127], v[32:35]
v_mfma_f32_16x16x32_bf16 v[36:39], v[68:71], v[124:127], v[36:39]
v_mfma_f32_16x16x32_bf16 v[40:43], v[64:67], v[180:183], v[40:43]
v_mfma_f32_16x16x32_bf16 v[44:47], v[68:71], v[180:183], v[44:47]
v_mfma_f32_16x16x32_bf16 v[48:51], v[64:67], v[236:239], v[48:51]
v_mfma_f32_16x16x32_bf16 v[52:55], v[68:71], v[236:239], v[52:55]
s_add_u32 s11, s20, 12288
buffer_load_dwordx4 v[64:67], v119, s[4:7], s11 offen offset:1024
s_add_u32 s11, s20, 24576
buffer_load_dwordx4 v[68:71], v119, s[4:7], s11 offen offset:3072
s_waitcnt vmcnt(6)
v_mfma_f32_16x16x32_bf16 v[0:3], v[72:75], a[40:43], v[0:3]
v_mfma_f32_16x16x32_bf16 v[4:7], v[76:79], a[40:43], v[4:7]
v_mfma_f32_16x16x32_bf16 v[8:11], v[72:75], a[96:99], v[8:11]
v_mfma_f32_16x16x32_bf16 v[12:15], v[76:79], a[96:99], v[12:15]
v_mfma_f32_16x16x32_bf16 v[16:19], v[72:75], a[152:155], v[16:19]
v_mfma_f32_16x16x32_bf16 v[20:23], v[76:79], a[152:155], v[20:23]
v_mfma_f32_16x16x32_bf16 v[24:27], v[72:75], a[208:211], v[24:27]
v_mfma_f32_16x16x32_bf16 v[28:31], v[76:79], a[208:211], v[28:31]
v_mfma_f32_16x16x32_bf16 v[32:35], v[72:75], v[128:131], v[32:35]
v_mfma_f32_16x16x32_bf16 v[36:39], v[76:79], v[128:131], v[36:39]
v_mfma_f32_16x16x32_bf16 v[40:43], v[72:75], v[184:187], v[40:43]
v_mfma_f32_16x16x32_bf16 v[44:47], v[76:79], v[184:187], v[44:47]
v_mfma_f32_16x16x32_bf16 v[48:51], v[72:75], v[240:243], v[48:51]
v_mfma_f32_16x16x32_bf16 v[52:55], v[76:79], v[240:243], v[52:55]
s_waitcnt vmcnt(4)
v_mfma_f32_16x16x32_bf16 v[0:3], v[80:83], a[44:47], v[0:3]
v_mfma_f32_16x16x32_bf16 v[4:7], v[84:87], a[44:47], v[4:7]
v_mfma_f32_16x16x32_bf16 v[8:11], v[80:83], a[100:103], v[8:11]
v_mfma_f32_16x16x32_bf16 v[12:15], v[84:87], a[100:103], v[12:15]
v_mfma_f32_16x16x32_bf16 v[16:19], v[80:83], a[156:159], v[16:19]
v_mfma_f32_16x16x32_bf16 v[20:23], v[84:87], a[156:159], v[20:23]
v_mfma_f32_16x16x32_bf16 v[24:27], v[80:83], a[212:215], v[24:27]
v_mfma_f32_16x16x32_bf16 v[28:31], v[84:87], a[212:215], v[28:31]
v_mfma_f32_16x16x32_bf16 v[32:35], v[80:83], v[132:135], v[32:35]
v_mfma_f32_16x16x32_bf16 v[36:39], v[84:87], v[132:135], v[36:39]
v_mfma_f32_16x16x32_bf16 v[40:43], v[80:83], v[188:191], v[40:43]
v_mfma_f32_16x16x32_bf16 v[44:47], v[84:87], v[188:191], v[44:47]
v_mfma_f32_16x16x32_bf16 v[48:51], v[80:83], v[244:247], v[48:51]
v_mfma_f32_16x16x32_bf16 v[52:55], v[84:87], v[244:247], v[52:55]
s_waitcnt vmcnt(2)
v_mfma_f32_16x16x32_bf16 v[0:3], v[56:59], a[48:51], v[0:3]
v_mfma_f32_16x16x32_bf16 v[4:7], v[60:63], a[48:51], v[4:7]
v_mfma_f32_16x16x32_bf16 v[8:11], v[56:59], a[104:107], v[8:11]
v_mfma_f32_16x16x32_bf16 v[12:15], v[60:63], a[104:107], v[12:15]
v_mfma_f32_16x16x32_bf16 v[16:19], v[56:59], a[160:163], v[16:19]
v_mfma_f32_16x16x32_bf16 v[20:23], v[60:63], a[160:163], v[20:23]
v_mfma_f32_16x16x32_bf16 v[24:27], v[56:59], a[216:219], v[24:27]
v_mfma_f32_16x16x32_bf16 v[28:31], v[60:63], a[216:219], v[28:31]
v_mfma_f32_16x16x32_bf16 v[32:35], v[56:59], v[136:139], v[32:35]
v_mfma_f32_16x16x32_bf16 v[36:39], v[60:63], v[136:139], v[36:39]
v_mfma_f32_16x16x32_bf16 v[40:43], v[56:59], v[192:195], v[40:43]
v_mfma_f32_16x16x32_bf16 v[44:47], v[60:63], v[192:195], v[44:47]
v_mfma_f32_16x16x32_bf16 v[48:51], v[56:59], v[248:251], v[48:51]
v_mfma_f32_16x16x32_bf16 v[52:55], v[60:63], v[248:251], v[52:55]
s_waitcnt vmcnt(0)
v_mfma_f32_16x16x32_bf16 v[0:3], v[64:67], a[52:55], v[0:3]
v_mfma_f32_16x16x32_bf16 v[4:7], v[68:71], a[52:55], v[4:7]
v_mfma_f32_16x16x32_bf16 v[8:11], v[64:67], a[108:111], v[8:11]
v_mfma_f32_16x16x32_bf16 v[12:15], v[68:71], a[108:111], v[12:15]
v_mfma_f32_16x16x32_bf16 v[16:19], v[64:67], a[164:167], v[16:19]
v_mfma_f32_16x16x32_bf16 v[20:23], v[68:71], a[164:167], v[20:23]
v_mfma_f32_16x16x32_bf16 v[24:27], v[64:67], a[220:223], v[24:27]
v_mfma_f32_16x16x32_bf16 v[28:31], v[68:71], a[220:223], v[28:31]
v_mfma_f32_16x16x32_bf16 v[32:35], v[64:67], v[140:143], v[32:35]
v_mfma_f32_16x16x32_bf16 v[36:39], v[68:71], v[140:143], v[36:39]
v_mfma_f32_16x16x32_bf16 v[40:43], v[64:67], v[196:199], v[40:43]
v_mfma_f32_16x16x32_bf16 v[44:47], v[68:71], v[196:199], v[44:47]
v_mfma_f32_16x16x32_bf16 v[48:51], v[64:67], v[252:255], v[48:51]
v_mfma_f32_16x16x32_bf16 v[52:55], v[68:71], v[252:255], v[52:55]
s_add_u32 s11, s21, 0
buffer_load_dwordx4 v[56:59], v119, s[4:7], s11 offen offset:0
s_add_u32 s11, s21, 12288
buffer_load_dwordx4 v[60:63], v119, s[4:7], s11 offen offset:2048
s_add_u32 s11, s21, 0
buffer_load_dwordx4 v[64:67], v119, s[4:7], s11 offen offset:1024
s_add_u32 s11, s21, 12288
buffer_load_dwordx4 v[68:71], v119, s[4:7], s11 offen offset:3072
s_add_u32 s11, s21, 0
buffer_load_dwordx4 v[72:75], v119, s[4:7], s11 offen offset:2048
s_add_u32 s11, s21, 16384
buffer_load_dwordx4 v[76:79], v119, s[4:7], s11 offen offset:0
s_add_u32 s11, s21, 0
buffer_load_dwordx4 v[80:83], v119, s[4:7], s11 offen offset:3072
s_add_u32 s11, s21, 16384
buffer_load_dwordx4 v[84:87], v119, s[4:7], s11 offen offset:1024
WV_epi:
s_mul_i32 s15, s8, 458752
s_add_u32 s15, s15, s14
s_add_u32 s15, s15, 16777216
v_cvt_pk_bf16_f32 v88, v0, v1
v_cvt_pk_bf16_f32 v89, v2, v3
v_cvt_pk_bf16_f32 v90, v4, v5
v_cvt_pk_bf16_f32 v91, v6, v7
buffer_store_dwordx4 v[88:91], v117, s[4:7], s15 offen offset:0 sc1
v_cvt_pk_bf16_f32 v92, v8, v9
v_cvt_pk_bf16_f32 v93, v10, v11
v_cvt_pk_bf16_f32 v94, v12, v13
v_cvt_pk_bf16_f32 v95, v14, v15
buffer_store_dwordx4 v[92:95], v117, s[4:7], s15 offen offset:256 sc1
v_cvt_pk_bf16_f32 v88, v16, v17
v_cvt_pk_bf16_f32 v89, v18, v19
v_cvt_pk_bf16_f32 v90, v20, v21
v_cvt_pk_bf16_f32 v91, v22, v23
buffer_store_dwordx4 v[88:91], v117, s[4:7], s15 offen offset:512 sc1
v_cvt_pk_bf16_f32 v92, v24, v25
v_cvt_pk_bf16_f32 v93, v26, v27
v_cvt_pk_bf16_f32 v94, v28, v29
v_cvt_pk_bf16_f32 v95, v30, v31
buffer_store_dwordx4 v[92:95], v117, s[4:7], s15 offen offset:768 sc1
v_cvt_pk_bf16_f32 v88, v32, v33
v_cvt_pk_bf16_f32 v89, v34, v35
v_cvt_pk_bf16_f32 v90, v36, v37
v_cvt_pk_bf16_f32 v91, v38, v39
buffer_store_dwordx4 v[88:91], v117, s[4:7], s15 offen offset:1024 sc1
v_cvt_pk_bf16_f32 v92, v40, v41
v_cvt_pk_bf16_f32 v93, v42, v43
v_cvt_pk_bf16_f32 v94, v44, v45
v_cvt_pk_bf16_f32 v95, v46, v47
buffer_store_dwordx4 v[92:95], v117, s[4:7], s15 offen offset:1280 sc1
v_cvt_pk_bf16_f32 v88, v48, v49
v_cvt_pk_bf16_f32 v89, v50, v51
v_cvt_pk_bf16_f32 v90, v52, v53
v_cvt_pk_bf16_f32 v91, v54, v55
buffer_store_dwordx4 v[88:91], v117, s[4:7], s15 offen offset:1536 sc1
s_lshl_b32 s15, s8, 7
s_add_u32 s15, s15, 54722560
s_waitcnt vmcnt(0)
s_barrier
s_cmp_lg_u32 s9, 0
s_cbranch_scc1 WV_sig
v_mov_b32 v96, 1
s_mov_b64 exec, 1
buffer_atomic_add v96, off, s[4:7], s15 sc1
s_mov_b64 exec, -1
WV_sig:
s_mov_b32 s20, s21
s_add_u32 s8, s8, 4
s_cmp_lt_u32 s8, 64
s_cbranch_scc1 WV_loop
s_mov_b32 s8, s12
s_mul_i32 s14, s10, 7168
WV_mloop:
v_mov_b64 v[28:29], 0
v_mov_b64 v[30:31], 0
v_mov_b64 v[32:33], 0
v_mov_b64 v[34:35], 0
v_mov_b64 v[36:37], 0
v_mov_b64 v[38:39], 0
v_mov_b64 v[40:41], 0
v_mov_b64 v[42:43], 0
v_mov_b64 v[44:45], 0
v_mov_b64 v[46:47], 0
v_mov_b64 v[48:49], 0
v_mov_b64 v[50:51], 0
v_mov_b64 v[52:53], 0
v_mov_b64 v[54:55], 0
s_mul_i32 s15, s8, 7168
s_add_u32 s15, s15, 53477376
s_add_u32 s16, s15, 4096
s_mov_b32 s26, s15
s_mov_b32 s19, 262144
s_cmp_eq_u32 s8, 63
s_cselect_b32 s11, 7168, 0
s_sub_u32 s26, s26, s11
WV_mx_1:
buffer_load_dword v96, off, s[4:7], s26 sc1
s_sub_u32 s19, s19, 1
s_cbranch_scc1 M_exit
s_waitcnt vmcnt(0)
v_cmp_eq_u32 vcc, -1, v96
s_cbranch_vccnz WV_mx_1
WV_mx:
buffer_load_dwordx4 v[0:3], v119, s[4:7], s15 offen offset:0 sc1
buffer_load_dwordx4 v[4:7], v119, s[4:7], s15 offen offset:1024 sc1
buffer_load_dwordx4 v[8:11], v119, s[4:7], s15 offen offset:2048 sc1
buffer_load_dwordx4 v[12:15], v119, s[4:7], s15 offen offset:3072 sc1
buffer_load_dwordx4 v[16:19], v119, s[4:7], s16 offen offset:0 sc1
buffer_load_dwordx4 v[20:23], v119, s[4:7], s16 offen offset:1024 sc1
buffer_load_dwordx4 v[24:27], v119, s[4:7], s16 offen offset:2048 sc1
s_sub_u32 s19, s19, 1
s_cbranch_scc1 M_exit
s_waitcnt vmcnt(0)
v_max3_u32 v96, v0, v1, v2
v_max3_u32 v96, v96, v3, v4
v_max3_u32 v96, v96, v5, v6
v_max3_u32 v96, v96, v7, v8
v_max3_u32 v96, v96, v9, v10
v_max3_u32 v96, v96, v11, v12
v_max3_u32 v96, v96, v13, v14
v_max3_u32 v96, v96, v15, v16
v_max3_u32 v96, v96, v17, v18
v_max3_u32 v96, v96, v19, v20
v_max3_u32 v96, v96, v21, v22
v_max3_u32 v96, v96, v23, v24
v_max3_u32 v96, v96, v25, v26
v_max_u32 v96, v96, v27
v_cmp_eq_u32 vcc, -1, v96
s_cbranch_vccnz WV_mx
v_smfmac_f32_16x16x64_bf16 v[28:31], v[0:3], a[0:7], v118
v_smfmac_f32_16x16x64_bf16 v[28:31], v[4:7], a[8:15], v118
v_smfmac_f32_16x16x64_bf16 v[28:31], v[8:11], a[16:23], v118
v_smfmac_f32_16x16x64_bf16 v[28:31], v[12:15], a[24:31], v118
v_smfmac_f32_16x16x64_bf16 v[28:31], v[16:19], a[32:39], v118
v_smfmac_f32_16x16x64_bf16 v[28:31], v[20:23], a[40:47], v118
v_smfmac_f32_16x16x64_bf16 v[28:31], v[24:27], a[48:55], v118
v_smfmac_f32_16x16x64_bf16 v[32:35], v[0:3], a[56:63], v118
v_smfmac_f32_16x16x64_bf16 v[32:35], v[4:7], a[64:71], v118
v_smfmac_f32_16x16x64_bf16 v[32:35], v[8:11], a[72:79], v118
v_smfmac_f32_16x16x64_bf16 v[32:35], v[12:15], a[80:87], v118
v_smfmac_f32_16x16x64_bf16 v[32:35], v[16:19], a[88:95], v118
v_smfmac_f32_16x16x64_bf16 v[32:35], v[20:23], a[96:103], v118
v_smfmac_f32_16x16x64_bf16 v[32:35], v[24:27], a[104:111], v118
v_smfmac_f32_16x16x64_bf16 v[36:39], v[0:3], a[112:119], v118
v_smfmac_f32_16x16x64_bf16 v[36:39], v[4:7], a[120:127], v118
v_smfmac_f32_16x16x64_bf16 v[36:39], v[8:11], a[128:135], v118
v_smfmac_f32_16x16x64_bf16 v[36:39], v[12:15], a[136:143], v118
v_smfmac_f32_16x16x64_bf16 v[36:39], v[16:19], a[144:151], v118
v_smfmac_f32_16x16x64_bf16 v[36:39], v[20:23], a[152:159], v118
v_smfmac_f32_16x16x64_bf16 v[36:39], v[24:27], a[160:167], v118
v_smfmac_f32_16x16x64_bf16 v[40:43], v[0:3], a[168:175], v118
v_smfmac_f32_16x16x64_bf16 v[40:43], v[4:7], a[176:183], v118
v_smfmac_f32_16x16x64_bf16 v[40:43], v[8:11], a[184:191], v118
v_smfmac_f32_16x16x64_bf16 v[40:43], v[12:15], a[192:199], v118
v_smfmac_f32_16x16x64_bf16 v[40:43], v[16:19], a[200:207], v118
v_smfmac_f32_16x16x64_bf16 v[40:43], v[20:23], a[208:215], v118
v_smfmac_f32_16x16x64_bf16 v[40:43], v[24:27], a[216:223], v118
v_smfmac_f32_16x16x64_bf16 v[44:47], v[0:3], a[224:231], v118
v_smfmac_f32_16x16x64_bf16 v[44:47], v[4:7], a[232:239], v118
v_smfmac_f32_16x16x64_bf16 v[44:47], v[8:11], a[240:247], v118
v_smfmac_f32_16x16x64_bf16 v[44:47], v[12:15], a[248:255], v118
v_smfmac_f32_16x16x64_bf16 v[44:47], v[16:19], v[120:127], v118
v_smfmac_f32_16x16x64_bf16 v[44:47], v[20:23], v[128:135], v118
v_smfmac_f32_16x16x64_bf16 v[44:47], v[24:27], v[136:143], v118
v_smfmac_f32_16x16x64_bf16 v[48:51], v[0:3], v[144:151], v118
v_smfmac_f32_16x16x64_bf16 v[48:51], v[4:7], v[152:159], v118
v_smfmac_f32_16x16x64_bf16 v[48:51], v[8:11], v[160:167], v118
v_smfmac_f32_16x16x64_bf16 v[48:51], v[12:15], v[168:175], v118
v_smfmac_f32_16x16x64_bf16 v[48:51], v[16:19], v[176:183], v118
v_smfmac_f32_16x16x64_bf16 v[48:51], v[20:23], v[184:191], v118
v_smfmac_f32_16x16x64_bf16 v[48:51], v[24:27], v[192:199], v118
v_smfmac_f32_16x16x64_bf16 v[52:55], v[0:3], v[200:207], v118
v_smfmac_f32_16x16x64_bf16 v[52:55], v[4:7], v[208:215], v118
v_smfmac_f32_16x16x64_bf16 v[52:55], v[8:11], v[216:223], v118
v_smfmac_f32_16x16x64_bf16 v[52:55], v[12:15], v[224:231], v118
v_smfmac_f32_16x16x64_bf16 v[52:55], v[16:19], v[232:239], v118
v_smfmac_f32_16x16x64_bf16 v[52:55], v[20:23], v[240:247], v118
v_smfmac_f32_16x16x64_bf16 v[52:55], v[24:27], v[248:255], v118
s_mul_i32 s15, s8, 114688
s_add_u32 s15, s15, s14
s_add_u32 s15, s15, 46137344
v_add_f32 v28, v28, v30
v_add_f32 v29, v29, v31
v_cvt_pk_bf16_f32 v28, v28, v29
v_min_u32 v28, -2, v28
buffer_store_dword v28, v116, s[4:7], s15 offen offset:0 sc1
v_add_f32 v32, v32, v34
v_add_f32 v33, v33, v35
v_cvt_pk_bf16_f32 v32, v32, v33
v_min_u32 v32, -2, v32
buffer_store_dword v32, v116, s[4:7], s15 offen offset:256 sc1
v_add_f32 v36, v36, v38
v_add_f32 v37, v37, v39
v_cvt_pk_bf16_f32 v36, v36, v37
v_min_u32 v36, -2, v36
buffer_store_dword v36, v116, s[4:7], s15 offen offset:512 sc1
v_add_f32 v40, v40, v42
v_add_f32 v41, v41, v43
v_cvt_pk_bf16_f32 v40, v40, v41
v_min_u32 v40, -2, v40
buffer_store_dword v40, v116, s[4:7], s15 offen offset:768 sc1
v_add_f32 v44, v44, v46
v_add_f32 v45, v45, v47
v_cvt_pk_bf16_f32 v44, v44, v45
v_min_u32 v44, -2, v44
buffer_store_dword v44, v116, s[4:7], s15 offen offset:1024 sc1
v_add_f32 v48, v48, v50
v_add_f32 v49, v49, v51
v_cvt_pk_bf16_f32 v48, v48, v49
v_min_u32 v48, -2, v48
buffer_store_dword v48, v116, s[4:7], s15 offen offset:1280 sc1
v_add_f32 v52, v52, v54
v_add_f32 v53, v53, v55
v_cvt_pk_bf16_f32 v52, v52, v53
v_min_u32 v52, -2, v52
buffer_store_dword v52, v116, s[4:7], s15 offen offset:1536 sc1
s_lshl_b32 s15, s8, 7
s_add_u32 s15, s15, 54738944
s_waitcnt vmcnt(0)
s_barrier
s_cmp_lg_u32 s9, 0
s_cbranch_scc1 WV_sig2
v_mov_b32 v96, 1
s_mov_b64 exec, 1
buffer_atomic_add v96, off, s[4:7], s15 sc1
s_mov_b64 exec, -1
WV_sig2:
s_add_u32 s8, s8, 4
s_cmp_lt_u32 s8, 64
s_cbranch_scc1 WV_mloop
s_endpgm
M_Q:
v_and_b32 v0, 63, v0
v_lshlrev_b32 v119, 4, v0
v_lshlrev_b32 v29, 4, v0
v_mov_b32 v26, 1
v_and_b32 v27, s9, v26
v_lshlrev_b32 v28, 3, v27
v_add_u32 v118, v29, v28
v_lshrrev_b32 v24, 4, v0
v_lshrrev_b32 v25, 1, v24
v_lshlrev_b32 v26, 4, v25
v_and_b32 v22, 15, v0
v_and_b32 v23, 7, v22
v_lshrrev_b32 v24, 1, v23
v_lshlrev_b32 v25, 2, v24
v_add_u32 v27, v26, v25
v_and_b32 v24, 15, v0
v_and_b32 v26, 7, v24
v_and_b32 v25, 1, v26
v_add_u32 v29, v27, v25
v_lshlrev_b32 v28, 4, v29
v_lshrrev_b32 v27, 4, v0
v_and_b32 v25, 1, v27
v_lshlrev_b32 v29, 3, v25
v_add_u32 v117, v28, v29
v_lshrrev_b32 v23, 4, v0
v_lshrrev_b32 v24, 1, v23
v_lshlrev_b32 v26, 4, v24
v_and_b32 v21, 15, v0
v_and_b32 v22, 7, v21
v_lshrrev_b32 v23, 1, v22
v_lshlrev_b32 v24, 2, v23
v_add_u32 v27, v26, v24
v_and_b32 v23, 15, v0
v_and_b32 v26, 7, v23
v_and_b32 v24, 1, v26
v_add_u32 v25, v27, v24
v_lshlrev_b32 v28, 4, v25
v_lshrrev_b32 v27, 4, v0
v_and_b32 v24, 1, v27
v_lshlrev_b32 v25, 3, v24
v_add_u32 v29, v28, v25
v_mov_b32 v24, 1
v_and_b32 v28, s9, v24
v_lshlrev_b32 v25, 2, v28
v_add_u32 v116, v29, v25
v_mov_b32 v29, s9
v_mov_b32 v28, 0x1400
v_mul_lo_u32 v25, v29, v28
v_lshlrev_b32 v28, 4, v0
v_add_u32 v115, v25, v28
v_mov_b32 v25, s9
v_lshlrev_b32 v28, 10, v25
v_lshlrev_b32 v25, 4, v0
v_add_u32 v114, v28, v25
v_mov_b32 v29, s9
v_mov_b32 v24, 0x5000
v_mul_lo_u32 v28, v29, v24
v_mov_b32 v29, s10
v_lshlrev_b32 v24, 10, v29
v_add_u32 v25, v28, v24
v_lshlrev_b32 v24, 4, v0
v_add_u32 v113, v25, v24
v_mov_b32 v27, s9
v_mov_b32 v26, 0x5000
v_mul_lo_u32 v29, v27, v26
v_mov_b32 v22, s10
v_lshrrev_b32 v23, 2, v22
v_add_u32 v27, 16, v23
v_lshlrev_b32 v26, 10, v27
v_add_u32 v28, v29, v26
v_mov_b32 v22, 3
v_and_b32 v23, s10, v22
v_lshlrev_b32 v27, 4, v23
v_and_b32 v23, 15, v0
v_add_u32 v29, v27, v23
v_lshlrev_b32 v26, 4, v29
v_add_u32 v25, v28, v26
v_lshrrev_b32 v28, 4, v0
v_lshlrev_b32 v26, 3, v28
v_add_u32 v24, v25, v26
v_mov_b32 v26, 0x40000000
v_lshrrev_b32 v25, 4, v0
v_mov_b32 v28, 2
v_cmp_lt_u32 vcc, v25, v28
s_nop 1
v_cndmask_b32 v112, v26, v24, vcc
v_and_b32 v28, 15, v0
v_lshrrev_b32 v26, 4, v0
v_lshlrev_b32 v25, 2, v26
v_sub_u32 v111, v28, v25
s_lshr_b32 s11, s9, 1
s_mul_i32 s14, s11, 7
s_and_b32 s15, s9, 1
s_lshl_b32 s16, s15, 2
s_add_u32 s16, s16, s14
s_add_u32 s17, s16, 0
s_lshl_b32 s22, s17, 10
s_add_u32 s17, s16, 1
s_lshl_b32 s23, s17, 10
s_add_u32 s17, s16, 2
s_lshl_b32 s24, s17, 10
s_add_u32 s17, s14, 3
s_lshl_b32 s25, s17, 10
s_mul_i32 s13, s10, 401408
s_add_u32 s13, s13, 2097152
s_mul_i32 s15, s15, 14336
s_mul_i32 s20, s12, 28672
s_cmp_lg_u32 s9, 0
s_cbranch_scc1 WQ_wa_go
v_mov_b32 v10, s10
v_lshlrev_b32 v11, 7, v10
v_add_u32 v12, 0x3433000, v11
v_mov_b32 v11, 0x343e000
v_mov_b32 v10, 1
v_cmp_lt_u32 vcc, v0, v10
s_nop 1
v_cndmask_b32 v1, v11, v12, vcc
v_mov_b32 v10, 14
v_mov_b32 v11, 32
v_mov_b32 v12, 1
v_cmp_lt_u32 vcc, v0, v12
s_nop 1
v_cndmask_b32 v2, v11, v10, vcc
s_mov_b32 s19, 0x40000
WQ_wa:
buffer_load_dword v3, v1, s[4:7], 0 offen sc1
s_sub_u32 s19, s19, 1
s_cbranch_scc1 M_exit
s_waitcnt vmcnt(0)
v_cmp_gt_u32 vcc, v2, v3
s_cbranch_vccnz WQ_wa
WQ_wa_go:
s_barrier
s_mul_i32 s11, s22, 28
s_add_u32 s11, s11, s13
s_add_u32 s11, s11, 0
buffer_load_dwordx4 a[0:3], v119, s[4:7], s11 offen
s_mul_i32 s11, s22, 28
s_add_u32 s11, s11, s13
s_add_u32 s11, s11, 14336
buffer_load_dwordx4 a[56:59], v119, s[4:7], s11 offen
s_mul_i32 s11, s23, 28
s_add_u32 s11, s11, s13
s_add_u32 s11, s11, 0
buffer_load_dwordx4 a[112:115], v119, s[4:7], s11 offen
s_mul_i32 s11, s23, 28
s_add_u32 s11, s11, s13
s_add_u32 s11, s11, 14336
buffer_load_dwordx4 a[168:171], v119, s[4:7], s11 offen
s_mul_i32 s11, s24, 28
s_add_u32 s11, s11, s13
s_add_u32 s11, s11, 0
buffer_load_dwordx4 a[224:227], v119, s[4:7], s11 offen
s_mul_i32 s11, s24, 28
s_add_u32 s11, s11, s13
s_add_u32 s11, s11, 14336
buffer_load_dwordx4 v[144:147], v119, s[4:7], s11 offen
s_mul_i32 s11, s25, 28
s_add_u32 s11, s11, s13
s_add_u32 s11, s11, s15
s_add_u32 s11, s11, 0
buffer_load_dwordx4 v[200:203], v119, s[4:7], s11 offen
s_mul_i32 s11, s22, 28
s_add_u32 s11, s11, s13
s_add_u32 s11, s11, 1024
buffer_load_dwordx4 a[4:7], v119, s[4:7], s11 offen
s_mul_i32 s11, s22, 28
s_add_u32 s11, s11, s13
s_add_u32 s11, s11, 15360
buffer_load_dwordx4 a[60:63], v119, s[4:7], s11 offen
s_mul_i32 s11, s23, 28
s_add_u32 s11, s11, s13
s_add_u32 s11, s11, 1024
buffer_load_dwordx4 a[116:119], v119, s[4:7], s11 offen
s_mul_i32 s11, s23, 28
s_add_u32 s11, s11, s13
s_add_u32 s11, s11, 15360
buffer_load_dwordx4 a[172:175], v119, s[4:7], s11 offen
s_mul_i32 s11, s24, 28
s_add_u32 s11, s11, s13
s_add_u32 s11, s11, 1024
buffer_load_dwordx4 a[228:231], v119, s[4:7], s11 offen
s_mul_i32 s11, s24, 28
s_add_u32 s11, s11, s13
s_add_u32 s11, s11, 15360
buffer_load_dwordx4 v[148:151], v119, s[4:7], s11 offen
s_mul_i32 s11, s25, 28
s_add_u32 s11, s11, s13
s_add_u32 s11, s11, s15
s_add_u32 s11, s11, 1024
buffer_load_dwordx4 v[204:207], v119, s[4:7], s11 offen
s_mul_i32 s11, s22, 28
s_add_u32 s11, s11, s13
s_add_u32 s11, s11, 2048
buffer_load_dwordx4 a[8:11], v119, s[4:7], s11 offen
s_mul_i32 s11, s22, 28
s_add_u32 s11, s11, s13
s_add_u32 s11, s11, 16384
buffer_load_dwordx4 a[64:67], v119, s[4:7], s11 offen
s_mul_i32 s11, s23, 28
s_add_u32 s11, s11, s13
s_add_u32 s11, s11, 2048
buffer_load_dwordx4 a[120:123], v119, s[4:7], s11 offen
s_mul_i32 s11, s23, 28
s_add_u32 s11, s11, s13
s_add_u32 s11, s11, 16384
buffer_load_dwordx4 a[176:179], v119, s[4:7], s11 offen
s_mul_i32 s11, s24, 28
s_add_u32 s11, s11, s13
s_add_u32 s11, s11, 2048
buffer_load_dwordx4 a[232:235], v119, s[4:7], s11 offen
s_mul_i32 s11, s24, 28
s_add_u32 s11, s11, s13
s_add_u32 s11, s11, 16384
buffer_load_dwordx4 v[152:155], v119, s[4:7], s11 offen
s_mul_i32 s11, s25, 28
s_add_u32 s11, s11, s13
s_add_u32 s11, s11, s15
s_add_u32 s11, s11, 2048
buffer_load_dwordx4 v[208:211], v119, s[4:7], s11 offen
s_mul_i32 s11, s22, 28
s_add_u32 s11, s11, s13
s_add_u32 s11, s11, 3072
buffer_load_dwordx4 a[12:15], v119, s[4:7], s11 offen
s_mul_i32 s11, s22, 28
s_add_u32 s11, s11, s13
s_add_u32 s11, s11, 17408
buffer_load_dwordx4 a[68:71], v119, s[4:7], s11 offen
s_mul_i32 s11, s23, 28
s_add_u32 s11, s11, s13
s_add_u32 s11, s11, 3072
buffer_load_dwordx4 a[124:127], v119, s[4:7], s11 offen
s_mul_i32 s11, s23, 28
s_add_u32 s11, s11, s13
s_add_u32 s11, s11, 17408
buffer_load_dwordx4 a[180:183], v119, s[4:7], s11 offen
s_mul_i32 s11, s24, 28
s_add_u32 s11, s11, s13
s_add_u32 s11, s11, 3072
buffer_load_dwordx4 a[236:239], v119, s[4:7], s11 offen
s_mul_i32 s11, s24, 28
s_add_u32 s11, s11, s13
s_add_u32 s11, s11, 17408
buffer_load_dwordx4 v[156:159], v119, s[4:7], s11 offen
s_mul_i32 s11, s25, 28
s_add_u32 s11, s11, s13
s_add_u32 s11, s11, s15
s_add_u32 s11, s11, 3072
buffer_load_dwordx4 v[212:215], v119, s[4:7], s11 offen
s_mul_i32 s11, s22, 28
s_add_u32 s11, s11, s13
s_add_u32 s11, s11, 4096
buffer_load_dwordx4 a[16:19], v119, s[4:7], s11 offen
s_mul_i32 s11, s22, 28
s_add_u32 s11, s11, s13
s_add_u32 s11, s11, 18432
buffer_load_dwordx4 a[72:75], v119, s[4:7], s11 offen
s_mul_i32 s11, s23, 28
s_add_u32 s11, s11, s13
s_add_u32 s11, s11, 4096
buffer_load_dwordx4 a[128:131], v119, s[4:7], s11 offen
s_mul_i32 s11, s23, 28
s_add_u32 s11, s11, s13
s_add_u32 s11, s11, 18432
buffer_load_dwordx4 a[184:187], v119, s[4:7], s11 offen
s_mul_i32 s11, s24, 28
s_add_u32 s11, s11, s13
s_add_u32 s11, s11, 4096
buffer_load_dwordx4 a[240:243], v119, s[4:7], s11 offen
s_mul_i32 s11, s24, 28
s_add_u32 s11, s11, s13
s_add_u32 s11, s11, 18432
buffer_load_dwordx4 v[160:163], v119, s[4:7], s11 offen
s_mul_i32 s11, s25, 28
s_add_u32 s11, s11, s13
s_add_u32 s11, s11, s15
s_add_u32 s11, s11, 4096
buffer_load_dwordx4 v[216:219], v119, s[4:7], s11 offen
s_mul_i32 s11, s22, 28
s_add_u32 s11, s11, s13
s_add_u32 s11, s11, 5120
buffer_load_dwordx4 a[20:23], v119, s[4:7], s11 offen
s_mul_i32 s11, s22, 28
s_add_u32 s11, s11, s13
s_add_u32 s11, s11, 19456
buffer_load_dwordx4 a[76:79], v119, s[4:7], s11 offen
s_mul_i32 s11, s23, 28
s_add_u32 s11, s11, s13
s_add_u32 s11, s11, 5120
buffer_load_dwordx4 a[132:135], v119, s[4:7], s11 offen
s_mul_i32 s11, s23, 28
s_add_u32 s11, s11, s13
s_add_u32 s11, s11, 19456
buffer_load_dwordx4 a[188:191], v119, s[4:7], s11 offen
s_mul_i32 s11, s24, 28
s_add_u32 s11, s11, s13
s_add_u32 s11, s11, 5120
buffer_load_dwordx4 a[244:247], v119, s[4:7], s11 offen
s_mul_i32 s11, s24, 28
s_add_u32 s11, s11, s13
s_add_u32 s11, s11, 19456
buffer_load_dwordx4 v[164:167], v119, s[4:7], s11 offen
s_mul_i32 s11, s25, 28
s_add_u32 s11, s11, s13
s_add_u32 s11, s11, s15
s_add_u32 s11, s11, 5120
buffer_load_dwordx4 v[220:223], v119, s[4:7], s11 offen
s_mul_i32 s11, s22, 28
s_add_u32 s11, s11, s13
s_add_u32 s11, s11, 6144
buffer_load_dwordx4 a[24:27], v119, s[4:7], s11 offen
s_mul_i32 s11, s22, 28
s_add_u32 s11, s11, s13
s_add_u32 s11, s11, 20480
buffer_load_dwordx4 a[80:83], v119, s[4:7], s11 offen
s_mul_i32 s11, s23, 28
s_add_u32 s11, s11, s13
s_add_u32 s11, s11, 6144
buffer_load_dwordx4 a[136:139], v119, s[4:7], s11 offen
s_mul_i32 s11, s23, 28
s_add_u32 s11, s11, s13
s_add_u32 s11, s11, 20480
buffer_load_dwordx4 a[192:195], v119, s[4:7], s11 offen
s_mul_i32 s11, s24, 28
s_add_u32 s11, s11, s13
s_add_u32 s11, s11, 6144
buffer_load_dwordx4 a[248:251], v119, s[4:7], s11 offen
s_mul_i32 s11, s24, 28
s_add_u32 s11, s11, s13
s_add_u32 s11, s11, 20480
buffer_load_dwordx4 v[168:171], v119, s[4:7], s11 offen
s_mul_i32 s11, s25, 28
s_add_u32 s11, s11, s13
s_add_u32 s11, s11, s15
s_add_u32 s11, s11, 6144
buffer_load_dwordx4 v[224:227], v119, s[4:7], s11 offen
s_mul_i32 s11, s22, 28
s_add_u32 s11, s11, s13
s_add_u32 s11, s11, 7168
buffer_load_dwordx4 a[28:31], v119, s[4:7], s11 offen
s_mul_i32 s11, s22, 28
s_add_u32 s11, s11, s13
s_add_u32 s11, s11, 21504
buffer_load_dwordx4 a[84:87], v119, s[4:7], s11 offen
s_mul_i32 s11, s23, 28
s_add_u32 s11, s11, s13
s_add_u32 s11, s11, 7168
buffer_load_dwordx4 a[140:143], v119, s[4:7], s11 offen
s_mul_i32 s11, s23, 28
s_add_u32 s11, s11, s13
s_add_u32 s11, s11, 21504
buffer_load_dwordx4 a[196:199], v119, s[4:7], s11 offen
s_mul_i32 s11, s24, 28
s_add_u32 s11, s11, s13
s_add_u32 s11, s11, 7168
buffer_load_dwordx4 a[252:255], v119, s[4:7], s11 offen
s_mul_i32 s11, s24, 28
s_add_u32 s11, s11, s13
s_add_u32 s11, s11, 21504
buffer_load_dwordx4 v[172:175], v119, s[4:7], s11 offen
s_mul_i32 s11, s25, 28
s_add_u32 s11, s11, s13
s_add_u32 s11, s11, s15
s_add_u32 s11, s11, 7168
buffer_load_dwordx4 v[228:231], v119, s[4:7], s11 offen
s_waitcnt vmcnt(32)
s_mul_i32 s11, s22, 28
s_add_u32 s11, s11, s13
s_add_u32 s11, s11, 8192
buffer_load_dwordx4 a[32:35], v119, s[4:7], s11 offen
s_mul_i32 s11, s22, 28
s_add_u32 s11, s11, s13
s_add_u32 s11, s11, 22528
buffer_load_dwordx4 a[88:91], v119, s[4:7], s11 offen
s_mul_i32 s11, s23, 28
s_add_u32 s11, s11, s13
s_add_u32 s11, s11, 8192
buffer_load_dwordx4 a[144:147], v119, s[4:7], s11 offen
s_mul_i32 s11, s23, 28
s_add_u32 s11, s11, s13
s_add_u32 s11, s11, 22528
buffer_load_dwordx4 a[200:203], v119, s[4:7], s11 offen
s_mul_i32 s11, s24, 28
s_add_u32 s11, s11, s13
s_add_u32 s11, s11, 8192
buffer_load_dwordx4 v[120:123], v119, s[4:7], s11 offen
s_mul_i32 s11, s24, 28
s_add_u32 s11, s11, s13
s_add_u32 s11, s11, 22528
buffer_load_dwordx4 v[176:179], v119, s[4:7], s11 offen
s_mul_i32 s11, s25, 28
s_add_u32 s11, s11, s13
s_add_u32 s11, s11, s15
s_add_u32 s11, s11, 8192
buffer_load_dwordx4 v[232:235], v119, s[4:7], s11 offen
s_mul_i32 s11, s22, 28
s_add_u32 s11, s11, s13
s_add_u32 s11, s11, 9216
buffer_load_dwordx4 a[36:39], v119, s[4:7], s11 offen
s_mul_i32 s11, s22, 28
s_add_u32 s11, s11, s13
s_add_u32 s11, s11, 23552
buffer_load_dwordx4 a[92:95], v119, s[4:7], s11 offen
s_mul_i32 s11, s23, 28
s_add_u32 s11, s11, s13
s_add_u32 s11, s11, 9216
buffer_load_dwordx4 a[148:151], v119, s[4:7], s11 offen
s_mul_i32 s11, s23, 28
s_add_u32 s11, s11, s13
s_add_u32 s11, s11, 23552
buffer_load_dwordx4 a[204:207], v119, s[4:7], s11 offen
s_mul_i32 s11, s24, 28
s_add_u32 s11, s11, s13
s_add_u32 s11, s11, 9216
buffer_load_dwordx4 v[124:127], v119, s[4:7], s11 offen
s_mul_i32 s11, s24, 28
s_add_u32 s11, s11, s13
s_add_u32 s11, s11, 23552
buffer_load_dwordx4 v[180:183], v119, s[4:7], s11 offen
s_mul_i32 s11, s25, 28
s_add_u32 s11, s11, s13
s_add_u32 s11, s11, s15
s_add_u32 s11, s11, 9216
buffer_load_dwordx4 v[236:239], v119, s[4:7], s11 offen
s_waitcnt vmcnt(32)
s_mul_i32 s11, s22, 28
s_add_u32 s11, s11, s13
s_add_u32 s11, s11, 10240
buffer_load_dwordx4 a[40:43], v119, s[4:7], s11 offen
s_mul_i32 s11, s22, 28
s_add_u32 s11, s11, s13
s_add_u32 s11, s11, 24576
buffer_load_dwordx4 a[96:99], v119, s[4:7], s11 offen
s_mul_i32 s11, s23, 28
s_add_u32 s11, s11, s13
s_add_u32 s11, s11, 10240
buffer_load_dwordx4 a[152:155], v119, s[4:7], s11 offen
s_mul_i32 s11, s23, 28
s_add_u32 s11, s11, s13
s_add_u32 s11, s11, 24576
buffer_load_dwordx4 a[208:211], v119, s[4:7], s11 offen
s_mul_i32 s11, s24, 28
s_add_u32 s11, s11, s13
s_add_u32 s11, s11, 10240
buffer_load_dwordx4 v[128:131], v119, s[4:7], s11 offen
s_mul_i32 s11, s24, 28
s_add_u32 s11, s11, s13
s_add_u32 s11, s11, 24576
buffer_load_dwordx4 v[184:187], v119, s[4:7], s11 offen
s_mul_i32 s11, s25, 28
s_add_u32 s11, s11, s13
s_add_u32 s11, s11, s15
s_add_u32 s11, s11, 10240
buffer_load_dwordx4 v[240:243], v119, s[4:7], s11 offen
s_mul_i32 s11, s22, 28
s_add_u32 s11, s11, s13
s_add_u32 s11, s11, 11264
buffer_load_dwordx4 a[44:47], v119, s[4:7], s11 offen
s_mul_i32 s11, s22, 28
s_add_u32 s11, s11, s13
s_add_u32 s11, s11, 25600
buffer_load_dwordx4 a[100:103], v119, s[4:7], s11 offen
s_mul_i32 s11, s23, 28
s_add_u32 s11, s11, s13
s_add_u32 s11, s11, 11264
buffer_load_dwordx4 a[156:159], v119, s[4:7], s11 offen
s_mul_i32 s11, s23, 28
s_add_u32 s11, s11, s13
s_add_u32 s11, s11, 25600
buffer_load_dwordx4 a[212:215], v119, s[4:7], s11 offen
s_mul_i32 s11, s24, 28
s_add_u32 s11, s11, s13
s_add_u32 s11, s11, 11264
buffer_load_dwordx4 v[132:135], v119, s[4:7], s11 offen
s_mul_i32 s11, s24, 28
s_add_u32 s11, s11, s13
s_add_u32 s11, s11, 25600
buffer_load_dwordx4 v[188:191], v119, s[4:7], s11 offen
s_mul_i32 s11, s25, 28
s_add_u32 s11, s11, s13
s_add_u32 s11, s11, s15
s_add_u32 s11, s11, 11264
buffer_load_dwordx4 v[244:247], v119, s[4:7], s11 offen
s_waitcnt vmcnt(32)
s_mul_i32 s11, s22, 28
s_add_u32 s11, s11, s13
s_add_u32 s11, s11, 12288
buffer_load_dwordx4 a[48:51], v119, s[4:7], s11 offen
s_mul_i32 s11, s22, 28
s_add_u32 s11, s11, s13
s_add_u32 s11, s11, 26624
buffer_load_dwordx4 a[104:107], v119, s[4:7], s11 offen
s_mul_i32 s11, s23, 28
s_add_u32 s11, s11, s13
s_add_u32 s11, s11, 12288
buffer_load_dwordx4 a[160:163], v119, s[4:7], s11 offen
s_mul_i32 s11, s23, 28
s_add_u32 s11, s11, s13
s_add_u32 s11, s11, 26624
buffer_load_dwordx4 a[216:219], v119, s[4:7], s11 offen
s_mul_i32 s11, s24, 28
s_add_u32 s11, s11, s13
s_add_u32 s11, s11, 12288
buffer_load_dwordx4 v[136:139], v119, s[4:7], s11 offen
s_mul_i32 s11, s24, 28
s_add_u32 s11, s11, s13
s_add_u32 s11, s11, 26624
buffer_load_dwordx4 v[192:195], v119, s[4:7], s11 offen
s_mul_i32 s11, s25, 28
s_add_u32 s11, s11, s13
s_add_u32 s11, s11, s15
s_add_u32 s11, s11, 12288
buffer_load_dwordx4 v[248:251], v119, s[4:7], s11 offen
s_mul_i32 s11, s22, 28
s_add_u32 s11, s11, s13
s_add_u32 s11, s11, 13312
buffer_load_dwordx4 a[52:55], v119, s[4:7], s11 offen
s_mul_i32 s11, s22, 28
s_add_u32 s11, s11, s13
s_add_u32 s11, s11, 27648
buffer_load_dwordx4 a[108:111], v119, s[4:7], s11 offen
s_mul_i32 s11, s23, 28
s_add_u32 s11, s11, s13
s_add_u32 s11, s11, 13312
buffer_load_dwordx4 a[164:167], v119, s[4:7], s11 offen
s_mul_i32 s11, s23, 28
s_add_u32 s11, s11, s13
s_add_u32 s11, s11, 27648
buffer_load_dwordx4 a[220:223], v119, s[4:7], s11 offen
s_mul_i32 s11, s24, 28
s_add_u32 s11, s11, s13
s_add_u32 s11, s11, 13312
buffer_load_dwordx4 v[140:143], v119, s[4:7], s11 offen
s_mul_i32 s11, s24, 28
s_add_u32 s11, s11, s13
s_add_u32 s11, s11, 27648
buffer_load_dwordx4 v[196:199], v119, s[4:7], s11 offen
s_mul_i32 s11, s25, 28
s_add_u32 s11, s11, s13
s_add_u32 s11, s11, s15
s_add_u32 s11, s11, 13312
buffer_load_dwordx4 v[252:255], v119, s[4:7], s11 offen
s_waitcnt vmcnt(32)
s_add_u32 s11, s20, 0
buffer_load_dwordx4 v[56:59], v119, s[4:7], s11 offen offset:0
s_add_u32 s11, s20, 12288
buffer_load_dwordx4 v[60:63], v119, s[4:7], s11 offen offset:2048
s_add_u32 s11, s20, 0
buffer_load_dwordx4 v[64:67], v119, s[4:7], s11 offen offset:1024
s_add_u32 s11, s20, 12288
buffer_load_dwordx4 v[68:71], v119, s[4:7], s11 offen offset:3072
s_add_u32 s11, s20, 0
buffer_load_dwordx4 v[72:75], v119, s[4:7], s11 offen offset:2048
s_add_u32 s11, s20, 16384
buffer_load_dwordx4 v[76:79], v119, s[4:7], s11 offen offset:0
s_add_u32 s11, s20, 0
buffer_load_dwordx4 v[80:83], v119, s[4:7], s11 offen offset:3072
s_add_u32 s11, s20, 16384
buffer_load_dwordx4 v[84:87], v119, s[4:7], s11 offen offset:1024
s_mov_b32 s8, s12
WQ_loop:
s_add_u32 s21, s20, 114688
s_waitcnt vmcnt(6)
v_mfma_f32_16x16x32_bf16 v[0:3], a[0:3], v[56:59], 0
v_mfma_f32_16x16x32_bf16 v[4:7], a[0:3], v[60:63], 0
v_mfma_f32_16x16x32_bf16 v[8:11], a[56:59], v[56:59], 0
v_mfma_f32_16x16x32_bf16 v[12:15], a[56:59], v[60:63], 0
v_mfma_f32_16x16x32_bf16 v[16:19], a[112:115], v[56:59], 0
v_mfma_f32_16x16x32_bf16 v[20:23], a[112:115], v[60:63], 0
v_mfma_f32_16x16x32_bf16 v[24:27], a[168:171], v[56:59], 0
v_mfma_f32_16x16x32_bf16 v[28:31], a[168:171], v[60:63], 0
v_mfma_f32_16x16x32_bf16 v[32:35], a[224:227], v[56:59], 0
v_mfma_f32_16x16x32_bf16 v[36:39], a[224:227], v[60:63], 0
v_mfma_f32_16x16x32_bf16 v[40:43], v[144:147], v[56:59], 0
v_mfma_f32_16x16x32_bf16 v[44:47], v[144:147], v[60:63], 0
v_mfma_f32_16x16x32_bf16 v[48:51], v[200:203], v[56:59], 0
v_mfma_f32_16x16x32_bf16 v[52:55], v[200:203], v[60:63], 0
s_add_u32 s11, s20, 4096
buffer_load_dwordx4 v[56:59], v119, s[4:7], s11 offen offset:0
s_add_u32 s11, s20, 16384
buffer_load_dwordx4 v[60:63], v119, s[4:7], s11 offen offset:2048
s_waitcnt vmcnt(6)
v_mfma_f32_16x16x32_bf16 v[0:3], a[4:7], v[64:67], v[0:3]
v_mfma_f32_16x16x32_bf16 v[4:7], a[4:7], v[68:71], v[4:7]
v_mfma_f32_16x16x32_bf16 v[8:11], a[60:63], v[64:67], v[8:11]
v_mfma_f32_16x16x32_bf16 v[12:15], a[60:63], v[68:71], v[12:15]
v_mfma_f32_16x16x32_bf16 v[16:19], a[116:119], v[64:67], v[16:19]
v_mfma_f32_16x16x32_bf16 v[20:23], a[116:119], v[68:71], v[20:23]
v_mfma_f32_16x16x32_bf16 v[24:27], a[172:175], v[64:67], v[24:27]
v_mfma_f32_16x16x32_bf16 v[28:31], a[172:175], v[68:71], v[28:31]
v_mfma_f32_16x16x32_bf16 v[32:35], a[228:231], v[64:67], v[32:35]
v_mfma_f32_16x16x32_bf16 v[36:39], a[228:231], v[68:71], v[36:39]
v_mfma_f32_16x16x32_bf16 v[40:43], v[148:151], v[64:67], v[40:43]
v_mfma_f32_16x16x32_bf16 v[44:47], v[148:151], v[68:71], v[44:47]
v_mfma_f32_16x16x32_bf16 v[48:51], v[204:207], v[64:67], v[48:51]
v_mfma_f32_16x16x32_bf16 v[52:55], v[204:207], v[68:71], v[52:55]
s_add_u32 s11, s20, 4096
buffer_load_dwordx4 v[64:67], v119, s[4:7], s11 offen offset:1024
s_add_u32 s11, s20, 16384
buffer_load_dwordx4 v[68:71], v119, s[4:7], s11 offen offset:3072
s_waitcnt vmcnt(6)
v_mfma_f32_16x16x32_bf16 v[0:3], a[8:11], v[72:75], v[0:3]
v_mfma_f32_16x16x32_bf16 v[4:7], a[8:11], v[76:79], v[4:7]
v_mfma_f32_16x16x32_bf16 v[8:11], a[64:67], v[72:75], v[8:11]
v_mfma_f32_16x16x32_bf16 v[12:15], a[64:67], v[76:79], v[12:15]
v_mfma_f32_16x16x32_bf16 v[16:19], a[120:123], v[72:75], v[16:19]
v_mfma_f32_16x16x32_bf16 v[20:23], a[120:123], v[76:79], v[20:23]
v_mfma_f32_16x16x32_bf16 v[24:27], a[176:179], v[72:75], v[24:27]
v_mfma_f32_16x16x32_bf16 v[28:31], a[176:179], v[76:79], v[28:31]
v_mfma_f32_16x16x32_bf16 v[32:35], a[232:235], v[72:75], v[32:35]
v_mfma_f32_16x16x32_bf16 v[36:39], a[232:235], v[76:79], v[36:39]
v_mfma_f32_16x16x32_bf16 v[40:43], v[152:155], v[72:75], v[40:43]
v_mfma_f32_16x16x32_bf16 v[44:47], v[152:155], v[76:79], v[44:47]
v_mfma_f32_16x16x32_bf16 v[48:51], v[208:211], v[72:75], v[48:51]
v_mfma_f32_16x16x32_bf16 v[52:55], v[208:211], v[76:79], v[52:55]
s_add_u32 s11, s20, 4096
buffer_load_dwordx4 v[72:75], v119, s[4:7], s11 offen offset:2048
s_add_u32 s11, s20, 20480
buffer_load_dwordx4 v[76:79], v119, s[4:7], s11 offen offset:0
s_waitcnt vmcnt(6)
v_mfma_f32_16x16x32_bf16 v[0:3], a[12:15], v[80:83], v[0:3]
v_mfma_f32_16x16x32_bf16 v[4:7], a[12:15], v[84:87], v[4:7]
v_mfma_f32_16x16x32_bf16 v[8:11], a[68:71], v[80:83], v[8:11]
v_mfma_f32_16x16x32_bf16 v[12:15], a[68:71], v[84:87], v[12:15]
v_mfma_f32_16x16x32_bf16 v[16:19], a[124:127], v[80:83], v[16:19]
v_mfma_f32_16x16x32_bf16 v[20:23], a[124:127], v[84:87], v[20:23]
v_mfma_f32_16x16x32_bf16 v[24:27], a[180:183], v[80:83], v[24:27]
v_mfma_f32_16x16x32_bf16 v[28:31], a[180:183], v[84:87], v[28:31]
v_mfma_f32_16x16x32_bf16 v[32:35], a[236:239], v[80:83], v[32:35]
v_mfma_f32_16x16x32_bf16 v[36:39], a[236:239], v[84:87], v[36:39]
v_mfma_f32_16x16x32_bf16 v[40:43], v[156:159], v[80:83], v[40:43]
v_mfma_f32_16x16x32_bf16 v[44:47], v[156:159], v[84:87], v[44:47]
v_mfma_f32_16x16x32_bf16 v[48:51], v[212:215], v[80:83], v[48:51]
v_mfma_f32_16x16x32_bf16 v[52:55], v[212:215], v[84:87], v[52:55]
s_add_u32 s11, s20, 4096
buffer_load_dwordx4 v[80:83], v119, s[4:7], s11 offen offset:3072
s_add_u32 s11, s20, 20480
buffer_load_dwordx4 v[84:87], v119, s[4:7], s11 offen offset:1024
s_waitcnt vmcnt(6)
v_mfma_f32_16x16x32_bf16 v[0:3], a[16:19], v[56:59], v[0:3]
v_mfma_f32_16x16x32_bf16 v[4:7], a[16:19], v[60:63], v[4:7]
v_mfma_f32_16x16x32_bf16 v[8:11], a[72:75], v[56:59], v[8:11]
v_mfma_f32_16x16x32_bf16 v[12:15], a[72:75], v[60:63], v[12:15]
v_mfma_f32_16x16x32_bf16 v[16:19], a[128:131], v[56:59], v[16:19]
v_mfma_f32_16x16x32_bf16 v[20:23], a[128:131], v[60:63], v[20:23]
v_mfma_f32_16x16x32_bf16 v[24:27], a[184:187], v[56:59], v[24:27]
v_mfma_f32_16x16x32_bf16 v[28:31], a[184:187], v[60:63], v[28:31]
v_mfma_f32_16x16x32_bf16 v[32:35], a[240:243], v[56:59], v[32:35]
v_mfma_f32_16x16x32_bf16 v[36:39], a[240:243], v[60:63], v[36:39]
v_mfma_f32_16x16x32_bf16 v[40:43], v[160:163], v[56:59], v[40:43]
v_mfma_f32_16x16x32_bf16 v[44:47], v[160:163], v[60:63], v[44:47]
v_mfma_f32_16x16x32_bf16 v[48:51], v[216:219], v[56:59], v[48:51]
v_mfma_f32_16x16x32_bf16 v[52:55], v[216:219], v[60:63], v[52:55]
s_add_u32 s11, s20, 8192
buffer_load_dwordx4 v[56:59], v119, s[4:7], s11 offen offset:0
s_add_u32 s11, s20, 20480
buffer_load_dwordx4 v[60:63], v119, s[4:7], s11 offen offset:2048
s_waitcnt vmcnt(6)
v_mfma_f32_16x16x32_bf16 v[0:3], a[20:23], v[64:67], v[0:3]
v_mfma_f32_16x16x32_bf16 v[4:7], a[20:23], v[68:71], v[4:7]
v_mfma_f32_16x16x32_bf16 v[8:11], a[76:79], v[64:67], v[8:11]
v_mfma_f32_16x16x32_bf16 v[12:15], a[76:79], v[68:71], v[12:15]
v_mfma_f32_16x16x32_bf16 v[16:19], a[132:135], v[64:67], v[16:19]
v_mfma_f32_16x16x32_bf16 v[20:23], a[132:135], v[68:71], v[20:23]
v_mfma_f32_16x16x32_bf16 v[24:27], a[188:191], v[64:67], v[24:27]
v_mfma_f32_16x16x32_bf16 v[28:31], a[188:191], v[68:71], v[28:31]
v_mfma_f32_16x16x32_bf16 v[32:35], a[244:247], v[64:67], v[32:35]
v_mfma_f32_16x16x32_bf16 v[36:39], a[244:247], v[68:71], v[36:39]
v_mfma_f32_16x16x32_bf16 v[40:43], v[164:167], v[64:67], v[40:43]
v_mfma_f32_16x16x32_bf16 v[44:47], v[164:167], v[68:71], v[44:47]
v_mfma_f32_16x16x32_bf16 v[48:51], v[220:223], v[64:67], v[48:51]
v_mfma_f32_16x16x32_bf16 v[52:55], v[220:223], v[68:71], v[52:55]
s_add_u32 s11, s20, 8192
buffer_load_dwordx4 v[64:67], v119, s[4:7], s11 offen offset:1024
s_add_u32 s11, s20, 20480
buffer_load_dwordx4 v[68:71], v119, s[4:7], s11 offen offset:3072
s_waitcnt vmcnt(6)
v_mfma_f32_16x16x32_bf16 v[0:3], a[24:27], v[72:75], v[0:3]
v_mfma_f32_16x16x32_bf16 v[4:7], a[24:27], v[76:79], v[4:7]
v_mfma_f32_16x16x32_bf16 v[8:11], a[80:83], v[72:75], v[8:11]
v_mfma_f32_16x16x32_bf16 v[12:15], a[80:83], v[76:79], v[12:15]
v_mfma_f32_16x16x32_bf16 v[16:19], a[136:139], v[72:75], v[16:19]
v_mfma_f32_16x16x32_bf16 v[20:23], a[136:139], v[76:79], v[20:23]
v_mfma_f32_16x16x32_bf16 v[24:27], a[192:195], v[72:75], v[24:27]
v_mfma_f32_16x16x32_bf16 v[28:31], a[192:195], v[76:79], v[28:31]
v_mfma_f32_16x16x32_bf16 v[32:35], a[248:251], v[72:75], v[32:35]
v_mfma_f32_16x16x32_bf16 v[36:39], a[248:251], v[76:79], v[36:39]
v_mfma_f32_16x16x32_bf16 v[40:43], v[168:171], v[72:75], v[40:43]
v_mfma_f32_16x16x32_bf16 v[44:47], v[168:171], v[76:79], v[44:47]
v_mfma_f32_16x16x32_bf16 v[48:51], v[224:227], v[72:75], v[48:51]
v_mfma_f32_16x16x32_bf16 v[52:55], v[224:227], v[76:79], v[52:55]
s_add_u32 s11, s20, 8192
buffer_load_dwordx4 v[72:75], v119, s[4:7], s11 offen offset:2048
s_add_u32 s11, s20, 24576
buffer_load_dwordx4 v[76:79], v119, s[4:7], s11 offen offset:0
s_waitcnt vmcnt(6)
v_mfma_f32_16x16x32_bf16 v[0:3], a[28:31], v[80:83], v[0:3]
v_mfma_f32_16x16x32_bf16 v[4:7], a[28:31], v[84:87], v[4:7]
v_mfma_f32_16x16x32_bf16 v[8:11], a[84:87], v[80:83], v[8:11]
v_mfma_f32_16x16x32_bf16 v[12:15], a[84:87], v[84:87], v[12:15]
v_mfma_f32_16x16x32_bf16 v[16:19], a[140:143], v[80:83], v[16:19]
v_mfma_f32_16x16x32_bf16 v[20:23], a[140:143], v[84:87], v[20:23]
v_mfma_f32_16x16x32_bf16 v[24:27], a[196:199], v[80:83], v[24:27]
v_mfma_f32_16x16x32_bf16 v[28:31], a[196:199], v[84:87], v[28:31]
v_mfma_f32_16x16x32_bf16 v[32:35], a[252:255], v[80:83], v[32:35]
v_mfma_f32_16x16x32_bf16 v[36:39], a[252:255], v[84:87], v[36:39]
v_mfma_f32_16x16x32_bf16 v[40:43], v[172:175], v[80:83], v[40:43]
v_mfma_f32_16x16x32_bf16 v[44:47], v[172:175], v[84:87], v[44:47]
v_mfma_f32_16x16x32_bf16 v[48:51], v[228:231], v[80:83], v[48:51]
v_mfma_f32_16x16x32_bf16 v[52:55], v[228:231], v[84:87], v[52:55]
s_add_u32 s11, s20, 8192
buffer_load_dwordx4 v[80:83], v119, s[4:7], s11 offen offset:3072
s_add_u32 s11, s20, 24576
buffer_load_dwordx4 v[84:87], v119, s[4:7], s11 offen offset:1024
s_waitcnt vmcnt(6)
v_mfma_f32_16x16x32_bf16 v[0:3], a[32:35], v[56:59], v[0:3]
v_mfma_f32_16x16x32_bf16 v[4:7], a[32:35], v[60:63], v[4:7]
v_mfma_f32_16x16x32_bf16 v[8:11], a[88:91], v[56:59], v[8:11]
v_mfma_f32_16x16x32_bf16 v[12:15], a[88:91], v[60:63], v[12:15]
v_mfma_f32_16x16x32_bf16 v[16:19], a[144:147], v[56:59], v[16:19]
v_mfma_f32_16x16x32_bf16 v[20:23], a[144:147], v[60:63], v[20:23]
v_mfma_f32_16x16x32_bf16 v[24:27], a[200:203], v[56:59], v[24:27]
v_mfma_f32_16x16x32_bf16 v[28:31], a[200:203], v[60:63], v[28:31]
v_mfma_f32_16x16x32_bf16 v[32:35], v[120:123], v[56:59], v[32:35]
v_mfma_f32_16x16x32_bf16 v[36:39], v[120:123], v[60:63], v[36:39]
v_mfma_f32_16x16x32_bf16 v[40:43], v[176:179], v[56:59], v[40:43]
v_mfma_f32_16x16x32_bf16 v[44:47], v[176:179], v[60:63], v[44:47]
v_mfma_f32_16x16x32_bf16 v[48:51], v[232:235], v[56:59], v[48:51]
v_mfma_f32_16x16x32_bf16 v[52:55], v[232:235], v[60:63], v[52:55]
s_add_u32 s11, s20, 12288
buffer_load_dwordx4 v[56:59], v119, s[4:7], s11 offen offset:0
s_add_u32 s11, s20, 24576
buffer_load_dwordx4 v[60:63], v119, s[4:7], s11 offen offset:2048
s_waitcnt vmcnt(6)
v_mfma_f32_16x16x32_bf16 v[0:3], a[36:39], v[64:67], v[0:3]
v_mfma_f32_16x16x32_bf16 v[4:7], a[36:39], v[68:71], v[4:7]
v_mfma_f32_16x16x32_bf16 v[8:11], a[92:95], v[64:67], v[8:11]
v_mfma_f32_16x16x32_bf16 v[12:15], a[92:95], v[68:71], v[12:15]
v_mfma_f32_16x16x32_bf16 v[16:19], a[148:151], v[64:67], v[16:19]
v_mfma_f32_16x16x32_bf16 v[20:23], a[148:151], v[68:71], v[20:23]
v_mfma_f32_16x16x32_bf16 v[24:27], a[204:207], v[64:67], v[24:27]
v_mfma_f32_16x16x32_bf16 v[28:31], a[204:207], v[68:71], v[28:31]
v_mfma_f32_16x16x32_bf16 v[32:35], v[124:127], v[64:67], v[32:35]
v_mfma_f32_16x16x32_bf16 v[36:39], v[124:127], v[68:71], v[36:39]
v_mfma_f32_16x16x32_bf16 v[40:43], v[180:183], v[64:67], v[40:43]
v_mfma_f32_16x16x32_bf16 v[44:47], v[180:183], v[68:71], v[44:47]
v_mfma_f32_16x16x32_bf16 v[48:51], v[236:239], v[64:67], v[48:51]
v_mfma_f32_16x16x32_bf16 v[52:55], v[236:239], v[68:71], v[52:55]
s_add_u32 s11, s20, 12288
buffer_load_dwordx4 v[64:67], v119, s[4:7], s11 offen offset:1024
s_add_u32 s11, s20, 24576
buffer_load_dwordx4 v[68:71], v119, s[4:7], s11 offen offset:3072
s_waitcnt vmcnt(6)
v_mfma_f32_16x16x32_bf16 v[0:3], a[40:43], v[72:75], v[0:3]
v_mfma_f32_16x16x32_bf16 v[4:7], a[40:43], v[76:79], v[4:7]
v_mfma_f32_16x16x32_bf16 v[8:11], a[96:99], v[72:75], v[8:11]
v_mfma_f32_16x16x32_bf16 v[12:15], a[96:99], v[76:79], v[12:15]
v_mfma_f32_16x16x32_bf16 v[16:19], a[152:155], v[72:75], v[16:19]
v_mfma_f32_16x16x32_bf16 v[20:23], a[152:155], v[76:79], v[20:23]
v_mfma_f32_16x16x32_bf16 v[24:27], a[208:211], v[72:75], v[24:27]
v_mfma_f32_16x16x32_bf16 v[28:31], a[208:211], v[76:79], v[28:31]
v_mfma_f32_16x16x32_bf16 v[32:35], v[128:131], v[72:75], v[32:35]
v_mfma_f32_16x16x32_bf16 v[36:39], v[128:131], v[76:79], v[36:39]
v_mfma_f32_16x16x32_bf16 v[40:43], v[184:187], v[72:75], v[40:43]
v_mfma_f32_16x16x32_bf16 v[44:47], v[184:187], v[76:79], v[44:47]
v_mfma_f32_16x16x32_bf16 v[48:51], v[240:243], v[72:75], v[48:51]
v_mfma_f32_16x16x32_bf16 v[52:55], v[240:243], v[76:79], v[52:55]
s_waitcnt vmcnt(4)
v_mfma_f32_16x16x32_bf16 v[0:3], a[44:47], v[80:83], v[0:3]
v_mfma_f32_16x16x32_bf16 v[4:7], a[44:47], v[84:87], v[4:7]
v_mfma_f32_16x16x32_bf16 v[8:11], a[100:103], v[80:83], v[8:11]
v_mfma_f32_16x16x32_bf16 v[12:15], a[100:103], v[84:87], v[12:15]
v_mfma_f32_16x16x32_bf16 v[16:19], a[156:159], v[80:83], v[16:19]
v_mfma_f32_16x16x32_bf16 v[20:23], a[156:159], v[84:87], v[20:23]
v_mfma_f32_16x16x32_bf16 v[24:27], a[212:215], v[80:83], v[24:27]
v_mfma_f32_16x16x32_bf16 v[28:31], a[212:215], v[84:87], v[28:31]
v_mfma_f32_16x16x32_bf16 v[32:35], v[132:135], v[80:83], v[32:35]
v_mfma_f32_16x16x32_bf16 v[36:39], v[132:135], v[84:87], v[36:39]
v_mfma_f32_16x16x32_bf16 v[40:43], v[188:191], v[80:83], v[40:43]
v_mfma_f32_16x16x32_bf16 v[44:47], v[188:191], v[84:87], v[44:47]
v_mfma_f32_16x16x32_bf16 v[48:51], v[244:247], v[80:83], v[48:51]
v_mfma_f32_16x16x32_bf16 v[52:55], v[244:247], v[84:87], v[52:55]
s_waitcnt vmcnt(2)
v_mfma_f32_16x16x32_bf16 v[0:3], a[48:51], v[56:59], v[0:3]
v_mfma_f32_16x16x32_bf16 v[4:7], a[48:51], v[60:63], v[4:7]
v_mfma_f32_16x16x32_bf16 v[8:11], a[104:107], v[56:59], v[8:11]
v_mfma_f32_16x16x32_bf16 v[12:15], a[104:107], v[60:63], v[12:15]
v_mfma_f32_16x16x32_bf16 v[16:19], a[160:163], v[56:59], v[16:19]
v_mfma_f32_16x16x32_bf16 v[20:23], a[160:163], v[60:63], v[20:23]
v_mfma_f32_16x16x32_bf16 v[24:27], a[216:219], v[56:59], v[24:27]
v_mfma_f32_16x16x32_bf16 v[28:31], a[216:219], v[60:63], v[28:31]
v_mfma_f32_16x16x32_bf16 v[32:35], v[136:139], v[56:59], v[32:35]
v_mfma_f32_16x16x32_bf16 v[36:39], v[136:139], v[60:63], v[36:39]
v_mfma_f32_16x16x32_bf16 v[40:43], v[192:195], v[56:59], v[40:43]
v_mfma_f32_16x16x32_bf16 v[44:47], v[192:195], v[60:63], v[44:47]
v_mfma_f32_16x16x32_bf16 v[48:51], v[248:251], v[56:59], v[48:51]
v_mfma_f32_16x16x32_bf16 v[52:55], v[248:251], v[60:63], v[52:55]
s_waitcnt vmcnt(0)
v_mfma_f32_16x16x32_bf16 v[0:3], a[52:55], v[64:67], v[0:3]
v_mfma_f32_16x16x32_bf16 v[4:7], a[52:55], v[68:71], v[4:7]
v_mfma_f32_16x16x32_bf16 v[8:11], a[108:111], v[64:67], v[8:11]
v_mfma_f32_16x16x32_bf16 v[12:15], a[108:111], v[68:71], v[12:15]
v_mfma_f32_16x16x32_bf16 v[16:19], a[164:167], v[64:67], v[16:19]
v_mfma_f32_16x16x32_bf16 v[20:23], a[164:167], v[68:71], v[20:23]
v_mfma_f32_16x16x32_bf16 v[24:27], a[220:223], v[64:67], v[24:27]
v_mfma_f32_16x16x32_bf16 v[28:31], a[220:223], v[68:71], v[28:31]
v_mfma_f32_16x16x32_bf16 v[32:35], v[140:143], v[64:67], v[32:35]
v_mfma_f32_16x16x32_bf16 v[36:39], v[140:143], v[68:71], v[36:39]
v_mfma_f32_16x16x32_bf16 v[40:43], v[196:199], v[64:67], v[40:43]
v_mfma_f32_16x16x32_bf16 v[44:47], v[196:199], v[68:71], v[44:47]
v_mfma_f32_16x16x32_bf16 v[48:51], v[252:255], v[64:67], v[48:51]
v_mfma_f32_16x16x32_bf16 v[52:55], v[252:255], v[68:71], v[52:55]
s_add_u32 s11, s21, 0
buffer_load_dwordx4 v[56:59], v119, s[4:7], s11 offen offset:0
s_add_u32 s11, s21, 12288
buffer_load_dwordx4 v[60:63], v119, s[4:7], s11 offen offset:2048
s_add_u32 s11, s21, 0
buffer_load_dwordx4 v[64:67], v119, s[4:7], s11 offen offset:1024
s_add_u32 s11, s21, 12288
buffer_load_dwordx4 v[68:71], v119, s[4:7], s11 offen offset:3072
s_add_u32 s11, s21, 0
buffer_load_dwordx4 v[72:75], v119, s[4:7], s11 offen offset:2048
s_add_u32 s11, s21, 16384
buffer_load_dwordx4 v[76:79], v119, s[4:7], s11 offen offset:0
s_add_u32 s11, s21, 0
buffer_load_dwordx4 v[80:83], v119, s[4:7], s11 offen offset:3072
s_add_u32 s11, s21, 16384
buffer_load_dwordx4 v[84:87], v119, s[4:7], s11 offen offset:1024
v_cvt_pk_bf16_f32 v88, v0, v1
v_cvt_pk_bf16_f32 v89, v2, v3
v_cvt_pk_bf16_f32 v90, v8, v9
v_cvt_pk_bf16_f32 v91, v10, v11
v_cvt_pk_bf16_f32 v92, v4, v5
v_cvt_pk_bf16_f32 v93, v6, v7
v_cvt_pk_bf16_f32 v94, v12, v13
v_cvt_pk_bf16_f32 v95, v14, v15
v_mov_b64 v[0:1], v[88:89]
v_mov_b64 v[2:3], v[90:91]
v_mov_b64 v[4:5], v[92:93]
v_mov_b64 v[6:7], v[94:95]
v_cvt_pk_bf16_f32 v88, v16, v17
v_cvt_pk_bf16_f32 v89, v18, v19
v_cvt_pk_bf16_f32 v90, v24, v25
v_cvt_pk_bf16_f32 v91, v26, v27
v_cvt_pk_bf16_f32 v92, v20, v21
v_cvt_pk_bf16_f32 v93, v22, v23
v_cvt_pk_bf16_f32 v94, v28, v29
v_cvt_pk_bf16_f32 v95, v30, v31
v_mov_b64 v[16:17], v[88:89]
v_mov_b64 v[18:19], v[90:91]
v_mov_b64 v[20:21], v[92:93]
v_mov_b64 v[22:23], v[94:95]
v_cvt_pk_bf16_f32 v88, v32, v33
v_cvt_pk_bf16_f32 v89, v34, v35
v_cvt_pk_bf16_f32 v90, v40, v41
v_cvt_pk_bf16_f32 v91, v42, v43
v_cvt_pk_bf16_f32 v92, v36, v37
v_cvt_pk_bf16_f32 v93, v38, v39
v_cvt_pk_bf16_f32 v94, v44, v45
v_cvt_pk_bf16_f32 v95, v46, v47
v_mov_b64 v[32:33], v[88:89]
v_mov_b64 v[34:35], v[90:91]
v_mov_b64 v[36:37], v[92:93]
v_mov_b64 v[38:39], v[94:95]
v_cvt_pk_bf16_f32 v88, v48, v49
v_cvt_pk_bf16_f32 v89, v50, v51
v_cvt_pk_bf16_f32 v92, v52, v53
v_cvt_pk_bf16_f32 v93, v54, v55
v_mov_b64 v[48:49], v[88:89]
v_mov_b64 v[52:53], v[92:93]
s_add_u32 s11, s20, s22
buffer_load_dwordx4 v[8:11], v119, s[4:7], s11 offen
s_add_u32 s11, s20, s22
s_add_u32 s11, s11, 14336
buffer_load_dwordx4 v[12:15], v119, s[4:7], s11 offen
s_add_u32 s11, s20, s23
buffer_load_dwordx4 v[24:27], v119, s[4:7], s11 offen
s_add_u32 s11, s20, s23
s_add_u32 s11, s11, 14336
buffer_load_dwordx4 v[28:31], v119, s[4:7], s11 offen
s_add_u32 s11, s20, s24
buffer_load_dwordx4 v[40:43], v119, s[4:7], s11 offen
s_add_u32 s11, s20, s24
s_add_u32 s11, s11, 14336
buffer_load_dwordx4 v[44:47], v119, s[4:7], s11 offen
s_add_u32 s11, s20, s25
buffer_load_dwordx2 v[88:89], v118, s[4:7], s11 offen
s_add_u32 s11, s20, s25
s_add_u32 s11, s11, 14336
buffer_load_dwordx2 v[90:91], v118, s[4:7], s11 offen
s_waitcnt vmcnt(0)
v_mfma_f32_16x16x32_bf16 v[92:95], v[8:11], v[0:3], 0
v_mfma_f32_16x16x32_bf16 v[92:95], v[24:27], v[16:19], v[92:95]
v_mfma_f32_16x16x32_bf16 v[92:95], v[40:43], v[32:35], v[92:95]
s_nop 5
v_mfma_f32_16x16x16_bf16 v[92:95], v[88:89], v[48:49], v[92:95]
v_mfma_f32_16x16x32_bf16 v[96:99], v[8:11], v[4:7], 0
v_mfma_f32_16x16x32_bf16 v[96:99], v[24:27], v[20:23], v[96:99]
v_mfma_f32_16x16x32_bf16 v[96:99], v[40:43], v[36:39], v[96:99]
s_nop 5
v_mfma_f32_16x16x16_bf16 v[96:99], v[88:89], v[52:53], v[96:99]
v_mfma_f32_16x16x32_bf16 v[100:103], v[12:15], v[4:7], 0
v_mfma_f32_16x16x32_bf16 v[100:103], v[28:31], v[20:23], v[100:103]
v_mfma_f32_16x16x32_bf16 v[100:103], v[44:47], v[36:39], v[100:103]
s_nop 5
v_mfma_f32_16x16x16_bf16 v[100:103], v[90:91], v[52:53], v[100:103]
ds_write_b128 v115, v[92:95] offset:2048
ds_write_b128 v115, v[96:99] offset:3072
s_nop 5
ds_write_b128 v115, v[100:103] offset:4096
s_waitcnt lgkmcnt(0)
s_barrier
s_cmp_ge_u32 s9, 2
s_cbranch_scc1 WQ_nored
ds_read_b128 v[92:95], v114 offset:2048
ds_read_b128 v[8:11], v114 offset:7168
ds_read_b128 v[24:27], v114 offset:12288
ds_read_b128 v[40:43], v114 offset:17408
s_waitcnt lgkmcnt(0)
v_pk_add_f32 v[92:93], v[92:93], v[8:9]
v_pk_add_f32 v[94:95], v[94:95], v[10:11]
v_pk_add_f32 v[92:93], v[92:93], v[24:25]
v_pk_add_f32 v[94:95], v[94:95], v[26:27]
v_pk_add_f32 v[92:93], v[92:93], v[40:41]
v_pk_add_f32 v[94:95], v[94:95], v[42:43]
ds_read_b128 v[96:99], v114 offset:3072
ds_read_b128 v[8:11], v114 offset:8192
ds_read_b128 v[24:27], v114 offset:13312
ds_read_b128 v[40:43], v114 offset:18432
s_waitcnt lgkmcnt(0)
v_pk_add_f32 v[96:97], v[96:97], v[8:9]
v_pk_add_f32 v[98:99], v[98:99], v[10:11]
v_pk_add_f32 v[96:97], v[96:97], v[24:25]
v_pk_add_f32 v[98:99], v[98:99], v[26:27]
v_pk_add_f32 v[96:97], v[96:97], v[40:41]
v_pk_add_f32 v[98:99], v[98:99], v[42:43]
v_mov_b32 v104, 0xff800000
s_cmp_eq_u32 s9, 0
s_cbranch_scc0 WQ_t1
v_cmp_le_i32 vcc, 0, v111
s_nop 1
v_cndmask_b32 v92, v104, v92, vcc
v_mov_b32 v96, v104
v_cmp_le_i32 vcc, 1, v111
s_nop 1
v_cndmask_b32 v93, v104, v93, vcc
v_mov_b32 v97, v104
v_cmp_le_i32 vcc, 2, v111
s_nop 1
v_cndmask_b32 v94, v104, v94, vcc
v_mov_b32 v98, v104
v_cmp_le_i32 vcc, 3, v111
s_nop 1
v_cndmask_b32 v95, v104, v95, vcc
v_mov_b32 v99, v104
s_branch WQ_nored
WQ_t1:
v_cmp_le_i32 vcc, 0, v111
s_nop 1
v_cndmask_b32 v96, v104, v96, vcc
v_cmp_le_i32 vcc, 1, v111
s_nop 1
v_cndmask_b32 v97, v104, v97, vcc
v_cmp_le_i32 vcc, 2, v111
s_nop 1
v_cndmask_b32 v98, v104, v98, vcc
v_cmp_le_i32 vcc, 3, v111
s_nop 1
v_cndmask_b32 v99, v104, v99, vcc
WQ_nored:
s_mul_i32 s15, s8, 7168
s_add_u32 s15, s15, 53477376
s_mov_b32 s26, s15
s_mov_b32 s19, 262144
s_cmp_eq_u32 s8, 63
s_cselect_b32 s11, 7168, 0
s_sub_u32 s26, s26, s11
WQ_mx_1:
buffer_load_dword v105, off, s[4:7], s26 sc1
s_sub_u32 s19, s19, 1
s_cbranch_scc1 M_exit
s_waitcnt vmcnt(0)
v_cmp_eq_u32 vcc, -1, v105
s_cbranch_vccnz WQ_mx_1
WQ_mx:
s_lshr_b32 s11, s22, 1
s_add_u32 s11, s11, s15
buffer_load_dwordx2 v[8:9], v117, s[4:7], s11 offen sc1
buffer_load_dwordx2 v[10:11], v117, s[4:7], s11 offen offset:32 sc1
s_lshr_b32 s11, s23, 1
s_add_u32 s11, s11, s15
buffer_load_dwordx2 v[24:25], v117, s[4:7], s11 offen sc1
buffer_load_dwordx2 v[26:27], v117, s[4:7], s11 offen offset:32 sc1
s_lshr_b32 s11, s24, 1
s_add_u32 s11, s11, s15
buffer_load_dwordx2 v[40:41], v117, s[4:7], s11 offen sc1
buffer_load_dwordx2 v[42:43], v117, s[4:7], s11 offen offset:32 sc1
s_lshr_b32 s11, s25, 1
s_add_u32 s11, s11, s15
buffer_load_dword v88, v116, s[4:7], s11 offen sc1
buffer_load_dword v89, v116, s[4:7], s11 offen offset:32 sc1
s_sub_u32 s19, s19, 1
s_cbranch_scc1 M_exit
s_waitcnt vmcnt(0)
v_max3_u32 v105, v8, v9, v10
v_max3_u32 v105, v105, v11, v24
v_max3_u32 v105, v105, v25, v26
v_max3_u32 v105, v105, v27, v40
v_max3_u32 v105, v105, v41, v42
v_max3_u32 v105, v105, v43, v88
v_max_u32 v105, v105, v89
v_cmp_eq_u32 vcc, -1, v105
s_cbranch_vccnz WQ_mx
v_swap_b32 v9, v10
v_swap_b32 v25, v26
v_swap_b32 v41, v42
v_mfma_f32_16x16x32_bf16 v[12:15], v[8:11], v[0:3], 0
v_mfma_f32_16x16x32_bf16 v[12:15], v[24:27], v[16:19], v[12:15]
v_mfma_f32_16x16x32_bf16 v[12:15], v[40:43], v[32:35], v[12:15]
s_nop 5
v_mfma_f32_16x16x16_bf16 v[12:15], v[88:89], v[48:49], v[12:15]
v_mfma_f32_16x16x32_bf16 v[28:31], v[8:11], v[4:7], 0
v_mfma_f32_16x16x32_bf16 v[28:31], v[24:27], v[20:23], v[28:31]
v_mfma_f32_16x16x32_bf16 v[28:31], v[40:43], v[36:39], v[28:31]
s_nop 5
v_mfma_f32_16x16x16_bf16 v[28:31], v[88:89], v[52:53], v[28:31]
ds_write_b128 v115, v[12:15] offset:0
s_nop 6
ds_write_b128 v115, v[28:31] offset:1024
s_waitcnt lgkmcnt(0)
s_barrier
s_cmp_ge_u32 s9, 2
s_cbranch_scc1 WQ_nosm
ds_read_b128 v[100:103], v114 offset:0
ds_read_b128 v[8:11], v114 offset:5120
ds_read_b128 v[24:27], v114 offset:10240
ds_read_b128 v[40:43], v114 offset:15360
s_waitcnt lgkmcnt(0)
v_pk_add_f32 v[100:101], v[100:101], v[8:9]
v_pk_add_f32 v[102:103], v[102:103], v[10:11]
v_pk_add_f32 v[100:101], v[100:101], v[24:25]
v_pk_add_f32 v[102:103], v[102:103], v[26:27]
v_pk_add_f32 v[100:101], v[100:101], v[40:41]
v_pk_add_f32 v[102:103], v[102:103], v[42:43]
s_mov_b32 vcc_lo, -1
s_mov_b32 vcc_hi, 0
v_cndmask_b32 v100, v104, v100, vcc
v_cndmask_b32 v101, v104, v101, vcc
v_cndmask_b32 v102, v104, v102, vcc
v_cndmask_b32 v103, v104, v103, vcc
v_max3_f32 v8, v92, v93, v94
v_max3_f32 v8, v8, v95, v96
v_max3_f32 v8, v8, v97, v98
v_max3_f32 v8, v8, v99, v100
v_max3_f32 v8, v8, v101, v102
v_max_f32 v8, v8, v103
v_mov_b32 v9, v8
s_nop 1
v_permlane16_swap_b32 v8, v9
v_max_f32 v8, v8, v9
v_mov_b32 v9, v8
s_nop 1
v_permlane32_swap_b32 v8, v9
v_max_f32 v8, v8, v9
v_pk_add_f32 v[92:93], v[92:93], v[8:9] op_sel_hi:[1,0] neg_lo:[0,1] neg_hi:[0,1]
v_pk_add_f32 v[94:95], v[94:95], v[8:9] op_sel_hi:[1,0] neg_lo:[0,1] neg_hi:[0,1]
v_pk_add_f32 v[96:97], v[96:97], v[8:9] op_sel_hi:[1,0] neg_lo:[0,1] neg_hi:[0,1]
v_pk_add_f32 v[98:99], v[98:99], v[8:9] op_sel_hi:[1,0] neg_lo:[0,1] neg_hi:[0,1]
v_pk_add_f32 v[100:101], v[100:101], v[8:9] op_sel_hi:[1,0] neg_lo:[0,1] neg_hi:[0,1]
v_pk_add_f32 v[102:103], v[102:103], v[8:9] op_sel_hi:[1,0] neg_lo:[0,1] neg_hi:[0,1]
v_exp_f32 v92, v92
v_exp_f32 v93, v93
v_exp_f32 v94, v94
v_exp_f32 v95, v95
v_exp_f32 v96, v96
v_exp_f32 v97, v97
v_exp_f32 v98, v98
v_exp_f32 v99, v99
v_exp_f32 v100, v100
v_exp_f32 v101, v101
v_exp_f32 v102, v102
v_exp_f32 v103, v103
v_pk_add_f32 v[8:9], v[92:93], v[94:95]
v_pk_add_f32 v[8:9], v[8:9], v[96:97]
v_pk_add_f32 v[8:9], v[8:9], v[98:99]
v_pk_add_f32 v[8:9], v[8:9], v[100:101]
v_pk_add_f32 v[8:9], v[8:9], v[102:103]
v_add_f32 v8, v8, v9
v_mov_b32 v9, v8
s_nop 1
v_permlane16_swap_b32 v8, v9
v_add_f32 v8, v8, v9
v_mov_b32 v9, v8
s_nop 1
v_permlane32_swap_b32 v8, v9
v_add_f32 v8, v8, v9
v_rcp_f32 v8, v8
s_nop 0
v_pk_mul_f32 v[92:93], v[92:93], v[8:9] op_sel_hi:[1,0]
v_pk_mul_f32 v[94:95], v[94:95], v[8:9] op_sel_hi:[1,0]
v_pk_mul_f32 v[96:97], v[96:97], v[8:9] op_sel_hi:[1,0]
v_pk_mul_f32 v[98:99], v[98:99], v[8:9] op_sel_hi:[1,0]
v_pk_mul_f32 v[100:101], v[100:101], v[8:9] op_sel_hi:[1,0]
v_pk_mul_f32 v[102:103], v[102:103], v[8:9] op_sel_hi:[1,0]
v_cvt_pk_bf16_f32 v12, v92, v93
v_min_u32 v12, -2, v12
v_cvt_pk_bf16_f32 v13, v94, v95
v_min_u32 v13, -2, v13
v_cvt_pk_bf16_f32 v14, v96, v97
v_min_u32 v14, -2, v14
v_cvt_pk_bf16_f32 v15, v98, v99
v_min_u32 v15, -2, v15
v_cvt_pk_bf16_f32 v16, v100, v101
v_min_u32 v16, -2, v16
v_cvt_pk_bf16_f32 v17, v102, v103
v_min_u32 v17, -2, v17
s_mul_i32 s15, s8, 40960
s_add_u32 s15, s15, 55574528
buffer_store_dwordx4 v[12:15], v113, s[4:7], s15 offen sc1
buffer_store_dwordx2 v[16:17], v112, s[4:7], s15 offen sc1
WQ_nosm:
s_lshl_b32 s15, s8, 7
s_add_u32 s15, s15, 54755328
s_waitcnt vmcnt(0)
s_barrier
s_cmp_lg_u32 s9, 0
s_cbranch_scc1 WQ_sig
v_mov_b32 v105, 1
s_mov_b64 exec, 1
buffer_atomic_add v105, off, s[4:7], s15 sc1
s_mov_b64 exec, -1
WQ_sig:
s_mov_b32 s20, s21
s_add_u32 s8, s8, 4
s_cmp_lt_u32 s8, 64
s_cbranch_scc1 WQ_loop
s_endpgm
M_T:
s_load_dwordx2 s[28:29], s[0:1], 64
s_load_dwordx2 s[30:31], s[0:1], 80
v_and_b32 v0, 63, v0
s_and_b32 s12, s10, 15
s_lshl_b32 s12, s12, 2
s_add_u32 s12, s12, s9
s_waitcnt lgkmcnt(0)
s_cmp_lt_u32 s10, 16
s_cselect_b32 s20, s28, s30
s_cselect_b32 s21, s29, s31
s_mov_b32 s22, 1605632
s_mov_b32 s23, 0x20000
s_movk_i32 s13, 896
s_cselect_b32 s13, 3584, s13
s_cselect_b32 s14, 28, 7
s_movk_i32 s15, 9363
s_cselect_b32 s15, 2341, s15
s_cselect_b32 s16, 14, 56
s_mov_b32 s17, 60817408
s_cselect_b32 s17, 58720256, s17
s_mul_i32 s18, s9, 28672
v_lshrrev_b32 v28, 3, v0
v_mov_b32 v27, s13
v_mul_lo_u32 v29, v28, v27
v_and_b32 v28, 7, v0
v_lshlrev_b32 v27, 4, v28
v_add_u32 v1, v29, v27
v_lshrrev_b32 v25, 4, v0
v_lshlrev_b32 v26, 3, v25
v_lshrrev_b32 v24, 2, v0
v_and_b32 v25, 3, v24
v_add_u32 v28, v26, v25
v_lshlrev_b32 v29, 7, v28
v_add_u32 v27, s18, v29
v_and_b32 v28, 3, v0
v_lshlrev_b32 v29, 4, v28
v_add_u32 v2, v27, v29
v_lshlrev_b32 v3, 4, v0
s_lshl_b32 s24, s13, 3
s_add_u32 s25, s12, 0
s_mul_i32 s26, s25, s15
s_lshr_b32 s26, s26, 16
s_mul_i32 s27, s26, s14
s_sub_u32 s27, s25, s27
s_lshl_b32 s40, s27, 2
s_mul_i32 s40, s40, s16
s_add_u32 s40, s40, s26
s_lshl_b32 s40, s40, 10
s_add_u32 s40, s40, s17
s_cmp_lt_u32 s25, 392
s_cselect_b32 s40, s40, 1073741824
s_lshl_b32 s26, s26, 5
s_mul_i32 s26, s26, s13
s_lshl_b32 s27, s27, 7
s_add_u32 s26, s26, s27
s_add_u32 m0, s18, 0
s_nop 0
buffer_load_dwordx4 v1, s[20:23], s26 offen lds
s_add_u32 s26, s26, s24
s_add_u32 m0, s18, 1024
s_nop 0
buffer_load_dwordx4 v1, s[20:23], s26 offen lds
s_add_u32 s26, s26, s24
s_add_u32 m0, s18, 2048
s_nop 0
buffer_load_dwordx4 v1, s[20:23], s26 offen lds
s_add_u32 s26, s26, s24
s_add_u32 m0, s18, 3072
s_nop 0
buffer_load_dwordx4 v1, s[20:23], s26 offen lds
s_add_u32 s25, s12, 64
s_mul_i32 s26, s25, s15
s_lshr_b32 s26, s26, 16
s_mul_i32 s27, s26, s14
s_sub_u32 s27, s25, s27
s_lshl_b32 s41, s27, 2
s_mul_i32 s41, s41, s16
s_add_u32 s41, s41, s26
s_lshl_b32 s41, s41, 10
s_add_u32 s41, s41, s17
s_cmp_lt_u32 s25, 392
s_cselect_b32 s41, s41, 1073741824
s_lshl_b32 s26, s26, 5
s_mul_i32 s26, s26, s13
s_lshl_b32 s27, s27, 7
s_add_u32 s26, s26, s27
s_add_u32 m0, s18, 4096
s_nop 0
buffer_load_dwordx4 v1, s[20:23], s26 offen lds
s_add_u32 s26, s26, s24
s_add_u32 m0, s18, 5120
s_nop 0
buffer_load_dwordx4 v1, s[20:23], s26 offen lds
s_add_u32 s26, s26, s24
s_add_u32 m0, s18, 6144
s_nop 0
buffer_load_dwordx4 v1, s[20:23], s26 offen lds
s_add_u32 s26, s26, s24
s_add_u32 m0, s18, 7168
s_nop 0
buffer_load_dwordx4 v1, s[20:23], s26 offen lds
s_add_u32 s25, s12, 128
s_mul_i32 s26, s25, s15
s_lshr_b32 s26, s26, 16
s_mul_i32 s27, s26, s14
s_sub_u32 s27, s25, s27
s_lshl_b32 s42, s27, 2
s_mul_i32 s42, s42, s16
s_add_u32 s42, s42, s26
s_lshl_b32 s42, s42, 10
s_add_u32 s42, s42, s17
s_cmp_lt_u32 s25, 392
s_cselect_b32 s42, s42, 1073741824
s_lshl_b32 s26, s26, 5
s_mul_i32 s26, s26, s13
s_lshl_b32 s27, s27, 7
s_add_u32 s26, s26, s27
s_add_u32 m0, s18, 8192
s_nop 0
buffer_load_dwordx4 v1, s[20:23], s26 offen lds
s_add_u32 s26, s26, s24
s_add_u32 m0, s18, 9216
s_nop 0
buffer_load_dwordx4 v1, s[20:23], s26 offen lds
s_add_u32 s26, s26, s24
s_add_u32 m0, s18, 10240
s_nop 0
buffer_load_dwordx4 v1, s[20:23], s26 offen lds
s_add_u32 s26, s26, s24
s_add_u32 m0, s18, 11264
s_nop 0
buffer_load_dwordx4 v1, s[20:23], s26 offen lds
s_add_u32 s25, s12, 192
s_mul_i32 s26, s25, s15
s_lshr_b32 s26, s26, 16
s_mul_i32 s27, s26, s14
s_sub_u32 s27, s25, s27
s_lshl_b32 s43, s27, 2
s_mul_i32 s43, s43, s16
s_add_u32 s43, s43, s26
s_lshl_b32 s43, s43, 10
s_add_u32 s43, s43, s17
s_cmp_lt_u32 s25, 392
s_cselect_b32 s43, s43, 1073741824
s_lshl_b32 s26, s26, 5
s_mul_i32 s26, s26, s13
s_lshl_b32 s27, s27, 7
s_add_u32 s26, s26, s27
s_add_u32 m0, s18, 12288
s_nop 0
buffer_load_dwordx4 v1, s[20:23], s26 offen lds
s_add_u32 s26, s26, s24
s_add_u32 m0, s18, 13312
s_nop 0
buffer_load_dwordx4 v1, s[20:23], s26 offen lds
s_add_u32 s26, s26, s24
s_add_u32 m0, s18, 14336
s_nop 0
buffer_load_dwordx4 v1, s[20:23], s26 offen lds
s_add_u32 s26, s26, s24
s_add_u32 m0, s18, 15360
s_nop 0
buffer_load_dwordx4 v1, s[20:23], s26 offen lds
s_add_u32 s25, s12, 256
s_mul_i32 s26, s25, s15
s_lshr_b32 s26, s26, 16
s_mul_i32 s27, s26, s14
s_sub_u32 s27, s25, s27
s_lshl_b32 s44, s27, 2
s_mul_i32 s44, s44, s16
s_add_u32 s44, s44, s26
s_lshl_b32 s44, s44, 10
s_add_u32 s44, s44, s17
s_cmp_lt_u32 s25, 392
s_cselect_b32 s44, s44, 1073741824
s_lshl_b32 s26, s26, 5
s_mul_i32 s26, s26, s13
s_lshl_b32 s27, s27, 7
s_add_u32 s26, s26, s27
s_add_u32 m0, s18, 16384
s_nop 0
buffer_load_dwordx4 v1, s[20:23], s26 offen lds
s_add_u32 s26, s26, s24
s_add_u32 m0, s18, 17408
s_nop 0
buffer_load_dwordx4 v1, s[20:23], s26 offen lds
s_add_u32 s26, s26, s24
s_add_u32 m0, s18, 18432
s_nop 0
buffer_load_dwordx4 v1, s[20:23], s26 offen lds
s_add_u32 s26, s26, s24
s_add_u32 m0, s18, 19456
s_nop 0
buffer_load_dwordx4 v1, s[20:23], s26 offen lds
s_add_u32 s25, s12, 320
s_mul_i32 s26, s25, s15
s_lshr_b32 s26, s26, 16
s_mul_i32 s27, s26, s14
s_sub_u32 s27, s25, s27
s_lshl_b32 s45, s27, 2
s_mul_i32 s45, s45, s16
s_add_u32 s45, s45, s26
s_lshl_b32 s45, s45, 10
s_add_u32 s45, s45, s17
s_cmp_lt_u32 s25, 392
s_cselect_b32 s45, s45, 1073741824
s_lshl_b32 s26, s26, 5
s_mul_i32 s26, s26, s13
s_lshl_b32 s27, s27, 7
s_add_u32 s26, s26, s27
s_add_u32 m0, s18, 20480
s_nop 0
buffer_load_dwordx4 v1, s[20:23], s26 offen lds
s_add_u32 s26, s26, s24
s_add_u32 m0, s18, 21504
s_nop 0
buffer_load_dwordx4 v1, s[20:23], s26 offen lds
s_add_u32 s26, s26, s24
s_add_u32 m0, s18, 22528
s_nop 0
buffer_load_dwordx4 v1, s[20:23], s26 offen lds
s_add_u32 s26, s26, s24
s_add_u32 m0, s18, 23552
s_nop 0
buffer_load_dwordx4 v1, s[20:23], s26 offen lds
s_add_u32 s25, s12, 384
s_mul_i32 s26, s25, s15
s_lshr_b32 s26, s26, 16
s_mul_i32 s27, s26, s14
s_sub_u32 s27, s25, s27
s_lshl_b32 s46, s27, 2
s_mul_i32 s46, s46, s16
s_add_u32 s46, s46, s26
s_lshl_b32 s46, s46, 10
s_add_u32 s46, s46, s17
s_cmp_lt_u32 s25, 392
s_cselect_b32 s46, s46, 1073741824
s_lshl_b32 s26, s26, 5
s_mul_i32 s26, s26, s13
s_lshl_b32 s27, s27, 7
s_add_u32 s26, s26, s27
s_add_u32 m0, s18, 24576
s_nop 0
buffer_load_dwordx4 v1, s[20:23], s26 offen lds
s_add_u32 s26, s26, s24
s_add_u32 m0, s18, 25600
s_nop 0
buffer_load_dwordx4 v1, s[20:23], s26 offen lds
s_add_u32 s26, s26, s24
s_add_u32 m0, s18, 26624
s_nop 0
buffer_load_dwordx4 v1, s[20:23], s26 offen lds
s_add_u32 s26, s26, s24
s_add_u32 m0, s18, 27648
s_nop 0
buffer_load_dwordx4 v1, s[20:23], s26 offen lds
s_lshl_b32 s24, s16, 10
s_waitcnt vmcnt(24)
ds_read_b64_tr_b16 v[8:9], v2 offset:0
ds_read_b64_tr_b16 v[10:11], v2 offset:512
ds_read_b64_tr_b16 v[12:13], v2 offset:8
ds_read_b64_tr_b16 v[14:15], v2 offset:520
ds_read_b64_tr_b16 v[16:17], v2 offset:64
ds_read_b64_tr_b16 v[18:19], v2 offset:576
ds_read_b64_tr_b16 v[20:21], v2 offset:72
ds_read_b64_tr_b16 v[22:23], v2 offset:584
s_waitcnt lgkmcnt(0)
buffer_store_dwordx4 v[8:11], v3, s[4:7], s40 offen sc1
s_add_u32 s40, s40, s24
buffer_store_dwordx4 v[12:15], v3, s[4:7], s40 offen sc1
s_add_u32 s40, s40, s24
buffer_store_dwordx4 v[16:19], v3, s[4:7], s40 offen sc1
s_add_u32 s40, s40, s24
buffer_store_dwordx4 v[20:23], v3, s[4:7], s40 offen sc1
s_waitcnt vmcnt(24)
ds_read_b64_tr_b16 v[24:25], v2 offset:4096
ds_read_b64_tr_b16 v[26:27], v2 offset:4608
ds_read_b64_tr_b16 v[28:29], v2 offset:4104
ds_read_b64_tr_b16 v[30:31], v2 offset:4616
ds_read_b64_tr_b16 v[32:33], v2 offset:4160
ds_read_b64_tr_b16 v[34:35], v2 offset:4672
ds_read_b64_tr_b16 v[36:37], v2 offset:4168
ds_read_b64_tr_b16 v[38:39], v2 offset:4680
s_waitcnt lgkmcnt(0)
buffer_store_dwordx4 v[24:27], v3, s[4:7], s41 offen sc1
s_add_u32 s41, s41, s24
buffer_store_dwordx4 v[28:31], v3, s[4:7], s41 offen sc1
s_add_u32 s41, s41, s24
buffer_store_dwordx4 v[32:35], v3, s[4:7], s41 offen sc1
s_add_u32 s41, s41, s24
buffer_store_dwordx4 v[36:39], v3, s[4:7], s41 offen sc1
s_waitcnt vmcnt(24)
ds_read_b64_tr_b16 v[8:9], v2 offset:8192
ds_read_b64_tr_b16 v[10:11], v2 offset:8704
ds_read_b64_tr_b16 v[12:13], v2 offset:8200
ds_read_b64_tr_b16 v[14:15], v2 offset:8712
ds_read_b64_tr_b16 v[16:17], v2 offset:8256
ds_read_b64_tr_b16 v[18:19], v2 offset:8768
ds_read_b64_tr_b16 v[20:21], v2 offset:8264
ds_read_b64_tr_b16 v[22:23], v2 offset:8776
s_waitcnt lgkmcnt(0)
buffer_store_dwordx4 v[8:11], v3, s[4:7], s42 offen sc1
s_add_u32 s42, s42, s24
buffer_store_dwordx4 v[12:15], v3, s[4:7], s42 offen sc1
s_add_u32 s42, s42, s24
buffer_store_dwordx4 v[16:19], v3, s[4:7], s42 offen sc1
s_add_u32 s42, s42, s24
buffer_store_dwordx4 v[20:23], v3, s[4:7], s42 offen sc1
s_waitcnt vmcnt(24)
ds_read_b64_tr_b16 v[24:25], v2 offset:12288
ds_read_b64_tr_b16 v[26:27], v2 offset:12800
ds_read_b64_tr_b16 v[28:29], v2 offset:12296
ds_read_b64_tr_b16 v[30:31], v2 offset:12808
ds_read_b64_tr_b16 v[32:33], v2 offset:12352
ds_read_b64_tr_b16 v[34:35], v2 offset:12864
ds_read_b64_tr_b16 v[36:37], v2 offset:12360
ds_read_b64_tr_b16 v[38:39], v2 offset:12872
s_waitcnt lgkmcnt(0)
buffer_store_dwordx4 v[24:27], v3, s[4:7], s43 offen sc1
s_add_u32 s43, s43, s24
buffer_store_dwordx4 v[28:31], v3, s[4:7], s43 offen sc1
s_add_u32 s43, s43, s24
buffer_store_dwordx4 v[32:35], v3, s[4:7], s43 offen sc1
s_add_u32 s43, s43, s24
buffer_store_dwordx4 v[36:39], v3, s[4:7], s43 offen sc1
s_waitcnt vmcnt(24)
ds_read_b64_tr_b16 v[8:9], v2 offset:16384
ds_read_b64_tr_b16 v[10:11], v2 offset:16896
ds_read_b64_tr_b16 v[12:13], v2 offset:16392
ds_read_b64_tr_b16 v[14:15], v2 offset:16904
ds_read_b64_tr_b16 v[16:17], v2 offset:16448
ds_read_b64_tr_b16 v[18:19], v2 offset:16960
ds_read_b64_tr_b16 v[20:21], v2 offset:16456
ds_read_b64_tr_b16 v[22:23], v2 offset:16968
s_waitcnt lgkmcnt(0)
buffer_store_dwordx4 v[8:11], v3, s[4:7], s44 offen sc1
s_add_u32 s44, s44, s24
buffer_store_dwordx4 v[12:15], v3, s[4:7], s44 offen sc1
s_add_u32 s44, s44, s24
buffer_store_dwordx4 v[16:19], v3, s[4:7], s44 offen sc1
s_add_u32 s44, s44, s24
buffer_store_dwordx4 v[20:23], v3, s[4:7], s44 offen sc1
s_waitcnt vmcnt(24)
ds_read_b64_tr_b16 v[24:25], v2 offset:20480
ds_read_b64_tr_b16 v[26:27], v2 offset:20992
ds_read_b64_tr_b16 v[28:29], v2 offset:20488
ds_read_b64_tr_b16 v[30:31], v2 offset:21000
ds_read_b64_tr_b16 v[32:33], v2 offset:20544
ds_read_b64_tr_b16 v[34:35], v2 offset:21056
ds_read_b64_tr_b16 v[36:37], v2 offset:20552
ds_read_b64_tr_b16 v[38:39], v2 offset:21064
s_waitcnt lgkmcnt(0)
buffer_store_dwordx4 v[24:27], v3, s[4:7], s45 offen sc1
s_add_u32 s45, s45, s24
buffer_store_dwordx4 v[28:31], v3, s[4:7], s45 offen sc1
s_add_u32 s45, s45, s24
buffer_store_dwordx4 v[32:35], v3, s[4:7], s45 offen sc1
s_add_u32 s45, s45, s24
buffer_store_dwordx4 v[36:39], v3, s[4:7], s45 offen sc1
s_waitcnt vmcnt(24)
ds_read_b64_tr_b16 v[8:9], v2 offset:24576
ds_read_b64_tr_b16 v[10:11], v2 offset:25088
ds_read_b64_tr_b16 v[12:13], v2 offset:24584
ds_read_b64_tr_b16 v[14:15], v2 offset:25096
ds_read_b64_tr_b16 v[16:17], v2 offset:24640
ds_read_b64_tr_b16 v[18:19], v2 offset:25152
ds_read_b64_tr_b16 v[20:21], v2 offset:24648
ds_read_b64_tr_b16 v[22:23], v2 offset:25160
s_waitcnt lgkmcnt(0)
buffer_store_dwordx4 v[8:11], v3, s[4:7], s46 offen sc1
s_add_u32 s46, s46, s24
buffer_store_dwordx4 v[12:15], v3, s[4:7], s46 offen sc1
s_add_u32 s46, s46, s24
buffer_store_dwordx4 v[16:19], v3, s[4:7], s46 offen sc1
s_add_u32 s46, s46, s24
buffer_store_dwordx4 v[20:23], v3, s[4:7], s46 offen sc1
s_mov_b32 s15, 54784000
s_waitcnt vmcnt(0)
s_barrier
s_cmp_lg_u32 s9, 0
s_cbranch_scc1 WT_sig
v_mov_b32 v4, 1
s_mov_b64 exec, 1
buffer_atomic_add v4, off, s[4:7], s15 sc1
s_mov_b64 exec, -1
WT_sig:
s_barrier
s_mov_b32 s11, 1
s_branch M_noT
M_F:
s_load_dwordx2 s[28:29], s[0:1], 72
s_load_dwordx2 s[30:31], s[0:1], 88
s_load_dwordx2 s[32:33], s[0:1], 0
s_load_dwordx2 s[34:35], s[0:1], 96
s_cmp_lg_u32 s9, 0
s_cbranch_scc1 WF_wx_go
v_mov_b32 v11, 0
v_mul_lo_u32 v12, v0, v11
v_add_u32 v1, 0x343e000, v12
v_mov_b32 v11, 0
v_mul_lo_u32 v12, v0, v11
v_add_u32 v2, 32, v12
s_mov_b32 s19, 0x40000
WF_wx:
buffer_load_dword v3, v1, s[4:7], 0 offen sc1
s_sub_u32 s19, s19, 1
s_cbranch_scc1 M_exit
s_waitcnt vmcnt(0)
v_cmp_gt_u32 vcc, v2, v3
s_cbranch_vccnz WF_wx
WF_wx_go:
s_barrier
v_lshlrev_b32 v1, 4, v0
v_lshrrev_b32 v29, 4, v0
v_lshlrev_b32 v3, 4, v29
s_waitcnt lgkmcnt(0)
s_mov_b32 s36, s28
s_mov_b32 s37, s29
s_mov_b32 s38, 3584
s_mov_b32 s39, 0x20000
s_mov_b32 s40, s30
s_mov_b32 s41, s31
s_mov_b32 s42, 896
s_mov_b32 s43, 0x20000
s_mov_b32 s44, s32
s_mov_b32 s45, s33
s_mov_b32 s46, 1835008
s_mov_b32 s47, 0x20000
s_mov_b32 s48, s34
s_mov_b32 s49, s35
s_mov_b32 s50, 1835008
s_mov_b32 s51, 0x20000
s_mul_i32 s12, s10, 28672
s_add_u32 s11, s12, 0
buffer_load_dwordx4 a[0:3], v1, s[4:7], s11 offen offset:0
buffer_load_dwordx4 a[4:7], v1, s[4:7], s11 offen offset:1024
buffer_load_dwordx4 a[8:11], v1, s[4:7], s11 offen offset:2048
buffer_load_dwordx4 a[12:15], v1, s[4:7], s11 offen offset:3072
s_add_u32 s11, s12, 4096
buffer_load_dwordx4 a[16:19], v1, s[4:7], s11 offen offset:0
buffer_load_dwordx4 a[20:23], v1, s[4:7], s11 offen offset:1024
buffer_load_dwordx4 a[24:27], v1, s[4:7], s11 offen offset:2048
buffer_load_dwordx4 a[28:31], v1, s[4:7], s11 offen offset:3072
s_add_u32 s11, s12, 8192
buffer_load_dwordx4 a[32:35], v1, s[4:7], s11 offen offset:0
buffer_load_dwordx4 a[36:39], v1, s[4:7], s11 offen offset:1024
buffer_load_dwordx4 a[40:43], v1, s[4:7], s11 offen offset:2048
buffer_load_dwordx4 a[44:47], v1, s[4:7], s11 offen offset:3072
s_add_u32 s11, s12, 12288
buffer_load_dwordx4 a[48:51], v1, s[4:7], s11 offen offset:0
buffer_load_dwordx4 a[52:55], v1, s[4:7], s11 offen offset:1024
buffer_load_dwordx4 a[56:59], v1, s[4:7], s11 offen offset:2048
buffer_load_dwordx4 a[60:63], v1, s[4:7], s11 offen offset:3072
s_add_u32 s11, s12, 16384
buffer_load_dwordx4 a[64:67], v1, s[4:7], s11 offen offset:0
buffer_load_dwordx4 a[68:71], v1, s[4:7], s11 offen offset:1024
buffer_load_dwordx4 a[72:75], v1, s[4:7], s11 offen offset:2048
buffer_load_dwordx4 a[76:79], v1, s[4:7], s11 offen offset:3072
s_add_u32 s11, s12, 20480
buffer_load_dwordx4 a[80:83], v1, s[4:7], s11 offen offset:0
buffer_load_dwordx4 a[84:87], v1, s[4:7], s11 offen offset:1024
buffer_load_dwordx4 a[88:91], v1, s[4:7], s11 offen offset:2048
buffer_load_dwordx4 a[92:95], v1, s[4:7], s11 offen offset:3072
s_add_u32 s11, s12, 24576
buffer_load_dwordx4 a[96:99], v1, s[4:7], s11 offen offset:0
buffer_load_dwordx4 a[100:103], v1, s[4:7], s11 offen offset:1024
buffer_load_dwordx4 a[104:107], v1, s[4:7], s11 offen offset:2048
buffer_load_dwordx4 a[108:111], v1, s[4:7], s11 offen offset:3072
s_mov_b32 s15, 54784000
s_cmp_lg_u32 s9, 0
s_cbranch_scc1 WF_fw_go
s_mov_b32 s19, 262144
WF_fw:
buffer_load_dword v2, off, s[4:7], s15 sc1
s_sub_u32 s19, s19, 1
s_cbranch_scc1 M_exit
s_waitcnt vmcnt(0)
v_cmp_gt_u32 vcc, 32, v2
s_cbranch_vccnz WF_fw
WF_fw_go:
s_barrier
s_mul_i32 s13, s9, 401408
s_add_u32 s13, s13, 58720256
s_mul_i32 s14, s9, 896
v_mov_b32 v28, s9
v_mov_b32 v27, 0x7000
v_mul_lo_u32 v29, v28, v27
v_lshlrev_b32 v27, 4, v0
v_add_u32 v4, v29, v27
buffer_load_dwordx4 v[24:27], v3, s[36:39], s14 offen
s_add_u32 s11, s13, 0
buffer_load_dwordx4 v[32:35], v1, s[4:7], s11 offen offset:0 sc1
buffer_load_dwordx4 v[36:39], v1, s[4:7], s11 offen offset:1024 sc1
buffer_load_dwordx4 v[40:43], v1, s[4:7], s11 offen offset:2048 sc1
buffer_load_dwordx4 v[44:47], v1, s[4:7], s11 offen offset:3072 sc1
s_add_u32 s11, s13, 4096
buffer_load_dwordx4 v[48:51], v1, s[4:7], s11 offen offset:0 sc1
buffer_load_dwordx4 v[52:55], v1, s[4:7], s11 offen offset:1024 sc1
buffer_load_dwordx4 v[56:59], v1, s[4:7], s11 offen offset:2048 sc1
buffer_load_dwordx4 v[60:63], v1, s[4:7], s11 offen offset:3072 sc1
s_add_u32 s11, s13, 8192
buffer_load_dwordx4 v[64:67], v1, s[4:7], s11 offen offset:0 sc1
buffer_load_dwordx4 v[68:71], v1, s[4:7], s11 offen offset:1024 sc1
buffer_load_dwordx4 v[72:75], v1, s[4:7], s11 offen offset:2048 sc1
buffer_load_dwordx4 v[76:79], v1, s[4:7], s11 offen offset:3072 sc1
s_add_u32 s11, s13, 12288
buffer_load_dwordx4 v[80:83], v1, s[4:7], s11 offen offset:0 sc1
buffer_load_dwordx4 v[84:87], v1, s[4:7], s11 offen offset:1024 sc1
buffer_load_dwordx4 v[88:91], v1, s[4:7], s11 offen offset:2048 sc1
buffer_load_dwordx4 v[92:95], v1, s[4:7], s11 offen offset:3072 sc1
s_add_u32 s11, s13, 16384
buffer_load_dwordx4 v[96:99], v1, s[4:7], s11 offen offset:0 sc1
buffer_load_dwordx4 v[100:103], v1, s[4:7], s11 offen offset:1024 sc1
buffer_load_dwordx4 v[104:107], v1, s[4:7], s11 offen offset:2048 sc1
buffer_load_dwordx4 v[108:111], v1, s[4:7], s11 offen offset:3072 sc1
s_add_u32 s11, s13, 20480
buffer_load_dwordx4 v[112:115], v1, s[4:7], s11 offen offset:0 sc1
buffer_load_dwordx4 v[116:119], v1, s[4:7], s11 offen offset:1024 sc1
buffer_load_dwordx4 v[120:123], v1, s[4:7], s11 offen offset:2048 sc1
buffer_load_dwordx4 v[124:127], v1, s[4:7], s11 offen offset:3072 sc1
s_add_u32 s11, s13, 24576
buffer_load_dwordx4 v[128:131], v1, s[4:7], s11 offen offset:0 sc1
buffer_load_dwordx4 v[132:135], v1, s[4:7], s11 offen offset:1024 sc1
buffer_load_dwordx4 v[136:139], v1, s[4:7], s11 offen offset:2048 sc1
buffer_load_dwordx4 v[140:143], v1, s[4:7], s11 offen offset:3072 sc1
s_mov_b32 s8, 0
WF_l1:
s_add_u32 s13, s13, 28672
s_add_u32 s14, s14, 64
buffer_load_dwordx4 v[28:31], v3, s[36:39], s14 offen
s_waitcnt vmcnt(28)
v_mfma_f32_16x16x32_bf16 v[8:11], v[32:35], a[0:3], 0
v_mfma_f32_16x16x32_bf16 v[12:15], v[32:35], a[56:59], 0
s_waitcnt vmcnt(14)
v_mfma_f32_16x16x32_bf16 v[16:19], v[88:91], a[0:3], 0
v_mfma_f32_16x16x32_bf16 v[20:23], v[88:91], a[56:59], 0
s_add_u32 s11, s13, 0
buffer_load_dwordx4 v[144:147], v1, s[4:7], s11 offen offset:0 sc1
buffer_load_dwordx4 v[148:151], v1, s[4:7], s11 offen offset:1024 sc1
v_mfma_f32_16x16x32_bf16 v[8:11], v[36:39], a[4:7], v[8:11]
v_mfma_f32_16x16x32_bf16 v[12:15], v[36:39], a[60:63], v[12:15]
s_waitcnt vmcnt(15)
v_mfma_f32_16x16x32_bf16 v[16:19], v[92:95], a[4:7], v[16:19]
v_mfma_f32_16x16x32_bf16 v[20:23], v[92:95], a[60:63], v[20:23]
buffer_load_dwordx4 v[152:155], v1, s[4:7], s11 offen offset:2048 sc1
buffer_load_dwordx4 v[156:159], v1, s[4:7], s11 offen offset:3072 sc1
v_mfma_f32_16x16x32_bf16 v[8:11], v[40:43], a[8:11], v[8:11]
v_mfma_f32_16x16x32_bf16 v[12:15], v[40:43], a[64:67], v[12:15]
s_waitcnt vmcnt(16)
v_mfma_f32_16x16x32_bf16 v[16:19], v[96:99], a[8:11], v[16:19]
v_mfma_f32_16x16x32_bf16 v[20:23], v[96:99], a[64:67], v[20:23]
s_add_u32 s11, s13, 4096
buffer_load_dwordx4 v[160:163], v1, s[4:7], s11 offen offset:0 sc1
buffer_load_dwordx4 v[164:167], v1, s[4:7], s11 offen offset:1024 sc1
v_mfma_f32_16x16x32_bf16 v[8:11], v[44:47], a[12:15], v[8:11]
v_mfma_f32_16x16x32_bf16 v[12:15], v[44:47], a[68:71], v[12:15]
s_waitcnt vmcnt(17)
v_mfma_f32_16x16x32_bf16 v[16:19], v[100:103], a[12:15], v[16:19]
v_mfma_f32_16x16x32_bf16 v[20:23], v[100:103], a[68:71], v[20:23]
buffer_load_dwordx4 v[168:171], v1, s[4:7], s11 offen offset:2048 sc1
buffer_load_dwordx4 v[172:175], v1, s[4:7], s11 offen offset:3072 sc1
v_mfma_f32_16x16x32_bf16 v[8:11], v[48:51], a[16:19], v[8:11]
v_mfma_f32_16x16x32_bf16 v[12:15], v[48:51], a[72:75], v[12:15]
s_waitcnt vmcnt(18)
v_mfma_f32_16x16x32_bf16 v[16:19], v[104:107], a[16:19], v[16:19]
v_mfma_f32_16x16x32_bf16 v[20:23], v[104:107], a[72:75], v[20:23]
s_add_u32 s11, s13, 8192
buffer_load_dwordx4 v[176:179], v1, s[4:7], s11 offen offset:0 sc1
buffer_load_dwordx4 v[180:183], v1, s[4:7], s11 offen offset:1024 sc1
v_mfma_f32_16x16x32_bf16 v[8:11], v[52:55], a[20:23], v[8:11]
v_mfma_f32_16x16x32_bf16 v[12:15], v[52:55], a[76:79], v[12:15]
s_waitcnt vmcnt(19)
v_mfma_f32_16x16x32_bf16 v[16:19], v[108:111], a[20:23], v[16:19]
v_mfma_f32_16x16x32_bf16 v[20:23], v[108:111], a[76:79], v[20:23]
buffer_load_dwordx4 v[184:187], v1, s[4:7], s11 offen offset:2048 sc1
buffer_load_dwordx4 v[188:191], v1, s[4:7], s11 offen offset:3072 sc1
v_mfma_f32_16x16x32_bf16 v[8:11], v[56:59], a[24:27], v[8:11]
v_mfma_f32_16x16x32_bf16 v[12:15], v[56:59], a[80:83], v[12:15]
s_waitcnt vmcnt(20)
v_mfma_f32_16x16x32_bf16 v[16:19], v[112:115], a[24:27], v[16:19]
v_mfma_f32_16x16x32_bf16 v[20:23], v[112:115], a[80:83], v[20:23]
s_add_u32 s11, s13, 12288
buffer_load_dwordx4 v[192:195], v1, s[4:7], s11 offen offset:0 sc1
buffer_load_dwordx4 v[196:199], v1, s[4:7], s11 offen offset:1024 sc1
v_mfma_f32_16x16x32_bf16 v[8:11], v[60:63], a[28:31], v[8:11]
v_mfma_f32_16x16x32_bf16 v[12:15], v[60:63], a[84:87], v[12:15]
s_waitcnt vmcnt(21)
v_mfma_f32_16x16x32_bf16 v[16:19], v[116:119], a[28:31], v[16:19]
v_mfma_f32_16x16x32_bf16 v[20:23], v[116:119], a[84:87], v[20:23]
buffer_load_dwordx4 v[200:203], v1, s[4:7], s11 offen offset:2048 sc1
buffer_load_dwordx4 v[204:207], v1, s[4:7], s11 offen offset:3072 sc1
v_mfma_f32_16x16x32_bf16 v[8:11], v[64:67], a[32:35], v[8:11]
v_mfma_f32_16x16x32_bf16 v[12:15], v[64:67], a[88:91], v[12:15]
s_waitcnt vmcnt(22)
v_mfma_f32_16x16x32_bf16 v[16:19], v[120:123], a[32:35], v[16:19]
v_mfma_f32_16x16x32_bf16 v[20:23], v[120:123], a[88:91], v[20:23]
s_add_u32 s11, s13, 16384
buffer_load_dwordx4 v[208:211], v1, s[4:7], s11 offen offset:0 sc1
buffer_load_dwordx4 v[212:215], v1, s[4:7], s11 offen offset:1024 sc1
v_mfma_f32_16x16x32_bf16 v[8:11], v[68:71], a[36:39], v[8:11]
v_mfma_f32_16x16x32_bf16 v[12:15], v[68:71], a[92:95], v[12:15]
s_waitcnt vmcnt(23)
v_mfma_f32_16x16x32_bf16 v[16:19], v[124:127], a[36:39], v[16:19]
v_mfma_f32_16x16x32_bf16 v[20:23], v[124:127], a[92:95], v[20:23]
buffer_load_dwordx4 v[216:219], v1, s[4:7], s11 offen offset:2048 sc1
buffer_load_dwordx4 v[220:223], v1, s[4:7], s11 offen offset:3072 sc1
v_mfma_f32_16x16x32_bf16 v[8:11], v[72:75], a[40:43], v[8:11]
v_mfma_f32_16x16x32_bf16 v[12:15], v[72:75], a[96:99], v[12:15]
s_waitcnt vmcnt(24)
v_mfma_f32_16x16x32_bf16 v[16:19], v[128:131], a[40:43], v[16:19]
v_mfma_f32_16x16x32_bf16 v[20:23], v[128:131], a[96:99], v[20:23]
s_add_u32 s11, s13, 20480
buffer_load_dwordx4 v[224:227], v1, s[4:7], s11 offen offset:0 sc1
buffer_load_dwordx4 v[228:231], v1, s[4:7], s11 offen offset:1024 sc1
v_mfma_f32_16x16x32_bf16 v[8:11], v[76:79], a[44:47], v[8:11]
v_mfma_f32_16x16x32_bf16 v[12:15], v[76:79], a[100:103], v[12:15]
s_waitcnt vmcnt(25)
v_mfma_f32_16x16x32_bf16 v[16:19], v[132:135], a[44:47], v[16:19]
v_mfma_f32_16x16x32_bf16 v[20:23], v[132:135], a[100:103], v[20:23]
buffer_load_dwordx4 v[232:235], v1, s[4:7], s11 offen offset:2048 sc1
buffer_load_dwordx4 v[236:239], v1, s[4:7], s11 offen offset:3072 sc1
v_mfma_f32_16x16x32_bf16 v[8:11], v[80:83], a[48:51], v[8:11]
v_mfma_f32_16x16x32_bf16 v[12:15], v[80:83], a[104:107], v[12:15]
s_waitcnt vmcnt(26)
v_mfma_f32_16x16x32_bf16 v[16:19], v[136:139], a[48:51], v[16:19]
v_mfma_f32_16x16x32_bf16 v[20:23], v[136:139], a[104:107], v[20:23]
s_add_u32 s11, s13, 24576
buffer_load_dwordx4 v[240:243], v1, s[4:7], s11 offen offset:0 sc1
buffer_load_dwordx4 v[244:247], v1, s[4:7], s11 offen offset:1024 sc1
v_mfma_f32_16x16x32_bf16 v[8:11], v[84:87], a[52:55], v[8:11]
v_mfma_f32_16x16x32_bf16 v[12:15], v[84:87], a[108:111], v[12:15]
s_waitcnt vmcnt(27)
v_mfma_f32_16x16x32_bf16 v[16:19], v[140:143], a[52:55], v[16:19]
v_mfma_f32_16x16x32_bf16 v[20:23], v[140:143], a[108:111], v[20:23]
buffer_load_dwordx4 v[248:251], v1, s[4:7], s11 offen offset:2048 sc1
buffer_load_dwordx4 v[252:255], v1, s[4:7], s11 offen offset:3072 sc1
v_lshlrev_b32 v6, 16, v24
v_and_b32 v7, 0xffff0000, v24
v_pk_add_f32 v[8:9], v[8:9], v[6:7]
v_max_f32 v8, 0, v8
v_max_f32 v9, 0, v9
v_pk_mul_f32 v[8:9], v[8:9], v[8:9]
v_cvt_pk_bf16_f32 v8, v8, v9
v_lshlrev_b32 v6, 16, v25
v_and_b32 v7, 0xffff0000, v25
v_pk_add_f32 v[10:11], v[10:11], v[6:7]
v_max_f32 v10, 0, v10
v_max_f32 v11, 0, v11
v_pk_mul_f32 v[10:11], v[10:11], v[10:11]
v_cvt_pk_bf16_f32 v9, v10, v11
v_lshlrev_b32 v6, 16, v26
v_and_b32 v7, 0xffff0000, v26
v_pk_add_f32 v[16:17], v[16:17], v[6:7]
v_max_f32 v16, 0, v16
v_max_f32 v17, 0, v17
v_pk_mul_f32 v[16:17], v[16:17], v[16:17]
v_cvt_pk_bf16_f32 v16, v16, v17
v_lshlrev_b32 v6, 16, v27
v_and_b32 v7, 0xffff0000, v27
v_pk_add_f32 v[18:19], v[18:19], v[6:7]
v_max_f32 v18, 0, v18
v_max_f32 v19, 0, v19
v_pk_mul_f32 v[18:19], v[18:19], v[18:19]
v_cvt_pk_bf16_f32 v17, v18, v19
v_mov_b64 v[10:11], v[16:17]
ds_write_b128 v4, v[8:11] offset:0
v_lshlrev_b32 v6, 16, v24
v_and_b32 v7, 0xffff0000, v24
v_pk_add_f32 v[12:13], v[12:13], v[6:7]
v_max_f32 v12, 0, v12
v_max_f32 v13, 0, v13
v_pk_mul_f32 v[12:13], v[12:13], v[12:13]
v_cvt_pk_bf16_f32 v12, v12, v13
v_lshlrev_b32 v6, 16, v25
v_and_b32 v7, 0xffff0000, v25
v_pk_add_f32 v[14:15], v[14:15], v[6:7]
v_max_f32 v14, 0, v14
v_max_f32 v15, 0, v15
v_pk_mul_f32 v[14:15], v[14:15], v[14:15]
v_cvt_pk_bf16_f32 v13, v14, v15
v_lshlrev_b32 v6, 16, v26
v_and_b32 v7, 0xffff0000, v26
v_pk_add_f32 v[20:21], v[20:21], v[6:7]
v_max_f32 v20, 0, v20
v_max_f32 v21, 0, v21
v_pk_mul_f32 v[20:21], v[20:21], v[20:21]
v_cvt_pk_bf16_f32 v20, v20, v21
v_lshlrev_b32 v6, 16, v27
v_and_b32 v7, 0xffff0000, v27
v_pk_add_f32 v[22:23], v[22:23], v[6:7]
v_max_f32 v22, 0, v22
v_max_f32 v23, 0, v23
v_pk_mul_f32 v[22:23], v[22:23], v[22:23]
v_cvt_pk_bf16_f32 v21, v22, v23
v_mov_b64 v[14:15], v[20:21]
ds_write_b128 v4, v[12:15] offset:1024
s_add_u32 s13, s13, 28672
s_add_u32 s14, s14, 64
buffer_load_dwordx4 v[24:27], v3, s[36:39], s14 offen
s_waitcnt vmcnt(28)
v_mfma_f32_16x16x32_bf16 v[8:11], v[144:147], a[0:3], 0
v_mfma_f32_16x16x32_bf16 v[12:15], v[144:147], a[56:59], 0
s_waitcnt vmcnt(14)
v_mfma_f32_16x16x32_bf16 v[16:19], v[200:203], a[0:3], 0
v_mfma_f32_16x16x32_bf16 v[20:23], v[200:203], a[56:59], 0
s_add_u32 s11, s13, 0
buffer_load_dwordx4 v[32:35], v1, s[4:7], s11 offen offset:0 sc1
buffer_load_dwordx4 v[36:39], v1, s[4:7], s11 offen offset:1024 sc1
v_mfma_f32_16x16x32_bf16 v[8:11], v[148:151], a[4:7], v[8:11]
v_mfma_f32_16x16x32_bf16 v[12:15], v[148:151], a[60:63], v[12:15]
s_waitcnt vmcnt(15)
v_mfma_f32_16x16x32_bf16 v[16:19], v[204:207], a[4:7], v[16:19]
v_mfma_f32_16x16x32_bf16 v[20:23], v[204:207], a[60:63], v[20:23]
buffer_load_dwordx4 v[40:43], v1, s[4:7], s11 offen offset:2048 sc1
buffer_load_dwordx4 v[44:47], v1, s[4:7], s11 offen offset:3072 sc1
v_mfma_f32_16x16x32_bf16 v[8:11], v[152:155], a[8:11], v[8:11]
v_mfma_f32_16x16x32_bf16 v[12:15], v[152:155], a[64:67], v[12:15]
s_waitcnt vmcnt(16)
v_mfma_f32_16x16x32_bf16 v[16:19], v[208:211], a[8:11], v[16:19]
v_mfma_f32_16x16x32_bf16 v[20:23], v[208:211], a[64:67], v[20:23]
s_add_u32 s11, s13, 4096
buffer_load_dwordx4 v[48:51], v1, s[4:7], s11 offen offset:0 sc1
buffer_load_dwordx4 v[52:55], v1, s[4:7], s11 offen offset:1024 sc1
v_mfma_f32_16x16x32_bf16 v[8:11], v[156:159], a[12:15], v[8:11]
v_mfma_f32_16x16x32_bf16 v[12:15], v[156:159], a[68:71], v[12:15]
s_waitcnt vmcnt(17)
v_mfma_f32_16x16x32_bf16 v[16:19], v[212:215], a[12:15], v[16:19]
v_mfma_f32_16x16x32_bf16 v[20:23], v[212:215], a[68:71], v[20:23]
buffer_load_dwordx4 v[56:59], v1, s[4:7], s11 offen offset:2048 sc1
buffer_load_dwordx4 v[60:63], v1, s[4:7], s11 offen offset:3072 sc1
v_mfma_f32_16x16x32_bf16 v[8:11], v[160:163], a[16:19], v[8:11]
v_mfma_f32_16x16x32_bf16 v[12:15], v[160:163], a[72:75], v[12:15]
s_waitcnt vmcnt(18)
v_mfma_f32_16x16x32_bf16 v[16:19], v[216:219], a[16:19], v[16:19]
v_mfma_f32_16x16x32_bf16 v[20:23], v[216:219], a[72:75], v[20:23]
s_add_u32 s11, s13, 8192
buffer_load_dwordx4 v[64:67], v1, s[4:7], s11 offen offset:0 sc1
buffer_load_dwordx4 v[68:71], v1, s[4:7], s11 offen offset:1024 sc1
v_mfma_f32_16x16x32_bf16 v[8:11], v[164:167], a[20:23], v[8:11]
v_mfma_f32_16x16x32_bf16 v[12:15], v[164:167], a[76:79], v[12:15]
s_waitcnt vmcnt(19)
v_mfma_f32_16x16x32_bf16 v[16:19], v[220:223], a[20:23], v[16:19]
v_mfma_f32_16x16x32_bf16 v[20:23], v[220:223], a[76:79], v[20:23]
buffer_load_dwordx4 v[72:75], v1, s[4:7], s11 offen offset:2048 sc1
buffer_load_dwordx4 v[76:79], v1, s[4:7], s11 offen offset:3072 sc1
v_mfma_f32_16x16x32_bf16 v[8:11], v[168:171], a[24:27], v[8:11]
v_mfma_f32_16x16x32_bf16 v[12:15], v[168:171], a[80:83], v[12:15]
s_waitcnt vmcnt(20)
v_mfma_f32_16x16x32_bf16 v[16:19], v[224:227], a[24:27], v[16:19]
v_mfma_f32_16x16x32_bf16 v[20:23], v[224:227], a[80:83], v[20:23]
s_add_u32 s11, s13, 12288
buffer_load_dwordx4 v[80:83], v1, s[4:7], s11 offen offset:0 sc1
buffer_load_dwordx4 v[84:87], v1, s[4:7], s11 offen offset:1024 sc1
v_mfma_f32_16x16x32_bf16 v[8:11], v[172:175], a[28:31], v[8:11]
v_mfma_f32_16x16x32_bf16 v[12:15], v[172:175], a[84:87], v[12:15]
s_waitcnt vmcnt(21)
v_mfma_f32_16x16x32_bf16 v[16:19], v[228:231], a[28:31], v[16:19]
v_mfma_f32_16x16x32_bf16 v[20:23], v[228:231], a[84:87], v[20:23]
buffer_load_dwordx4 v[88:91], v1, s[4:7], s11 offen offset:2048 sc1
buffer_load_dwordx4 v[92:95], v1, s[4:7], s11 offen offset:3072 sc1
v_mfma_f32_16x16x32_bf16 v[8:11], v[176:179], a[32:35], v[8:11]
v_mfma_f32_16x16x32_bf16 v[12:15], v[176:179], a[88:91], v[12:15]
s_waitcnt vmcnt(22)
v_mfma_f32_16x16x32_bf16 v[16:19], v[232:235], a[32:35], v[16:19]
v_mfma_f32_16x16x32_bf16 v[20:23], v[232:235], a[88:91], v[20:23]
s_add_u32 s11, s13, 16384
buffer_load_dwordx4 v[96:99], v1, s[4:7], s11 offen offset:0 sc1
buffer_load_dwordx4 v[100:103], v1, s[4:7], s11 offen offset:1024 sc1
v_mfma_f32_16x16x32_bf16 v[8:11], v[180:183], a[36:39], v[8:11]
v_mfma_f32_16x16x32_bf16 v[12:15], v[180:183], a[92:95], v[12:15]
s_waitcnt vmcnt(23)
v_mfma_f32_16x16x32_bf16 v[16:19], v[236:239], a[36:39], v[16:19]
v_mfma_f32_16x16x32_bf16 v[20:23], v[236:239], a[92:95], v[20:23]
buffer_load_dwordx4 v[104:107], v1, s[4:7], s11 offen offset:2048 sc1
buffer_load_dwordx4 v[108:111], v1, s[4:7], s11 offen offset:3072 sc1
v_mfma_f32_16x16x32_bf16 v[8:11], v[184:187], a[40:43], v[8:11]
v_mfma_f32_16x16x32_bf16 v[12:15], v[184:187], a[96:99], v[12:15]
s_waitcnt vmcnt(24)
v_mfma_f32_16x16x32_bf16 v[16:19], v[240:243], a[40:43], v[16:19]
v_mfma_f32_16x16x32_bf16 v[20:23], v[240:243], a[96:99], v[20:23]
s_add_u32 s11, s13, 20480
buffer_load_dwordx4 v[112:115], v1, s[4:7], s11 offen offset:0 sc1
buffer_load_dwordx4 v[116:119], v1, s[4:7], s11 offen offset:1024 sc1
v_mfma_f32_16x16x32_bf16 v[8:11], v[188:191], a[44:47], v[8:11]
v_mfma_f32_16x16x32_bf16 v[12:15], v[188:191], a[100:103], v[12:15]
s_waitcnt vmcnt(25)
v_mfma_f32_16x16x32_bf16 v[16:19], v[244:247], a[44:47], v[16:19]
v_mfma_f32_16x16x32_bf16 v[20:23], v[244:247], a[100:103], v[20:23]
buffer_load_dwordx4 v[120:123], v1, s[4:7], s11 offen offset:2048 sc1
buffer_load_dwordx4 v[124:127], v1, s[4:7], s11 offen offset:3072 sc1
v_mfma_f32_16x16x32_bf16 v[8:11], v[192:195], a[48:51], v[8:11]
v_mfma_f32_16x16x32_bf16 v[12:15], v[192:195], a[104:107], v[12:15]
s_waitcnt vmcnt(26)
v_mfma_f32_16x16x32_bf16 v[16:19], v[248:251], a[48:51], v[16:19]
v_mfma_f32_16x16x32_bf16 v[20:23], v[248:251], a[104:107], v[20:23]
s_add_u32 s11, s13, 24576
buffer_load_dwordx4 v[128:131], v1, s[4:7], s11 offen offset:0 sc1
buffer_load_dwordx4 v[132:135], v1, s[4:7], s11 offen offset:1024 sc1
v_mfma_f32_16x16x32_bf16 v[8:11], v[196:199], a[52:55], v[8:11]
v_mfma_f32_16x16x32_bf16 v[12:15], v[196:199], a[108:111], v[12:15]
s_waitcnt vmcnt(27)
v_mfma_f32_16x16x32_bf16 v[16:19], v[252:255], a[52:55], v[16:19]
v_mfma_f32_16x16x32_bf16 v[20:23], v[252:255], a[108:111], v[20:23]
buffer_load_dwordx4 v[136:139], v1, s[4:7], s11 offen offset:2048 sc1
buffer_load_dwordx4 v[140:143], v1, s[4:7], s11 offen offset:3072 sc1
v_lshlrev_b32 v6, 16, v28
v_and_b32 v7, 0xffff0000, v28
v_pk_add_f32 v[8:9], v[8:9], v[6:7]
v_max_f32 v8, 0, v8
v_max_f32 v9, 0, v9
v_pk_mul_f32 v[8:9], v[8:9], v[8:9]
v_cvt_pk_bf16_f32 v8, v8, v9
v_lshlrev_b32 v6, 16, v29
v_and_b32 v7, 0xffff0000, v29
v_pk_add_f32 v[10:11], v[10:11], v[6:7]
v_max_f32 v10, 0, v10
v_max_f32 v11, 0, v11
v_pk_mul_f32 v[10:11], v[10:11], v[10:11]
v_cvt_pk_bf16_f32 v9, v10, v11
v_lshlrev_b32 v6, 16, v30
v_and_b32 v7, 0xffff0000, v30
v_pk_add_f32 v[16:17], v[16:17], v[6:7]
v_max_f32 v16, 0, v16
v_max_f32 v17, 0, v17
v_pk_mul_f32 v[16:17], v[16:17], v[16:17]
v_cvt_pk_bf16_f32 v16, v16, v17
v_lshlrev_b32 v6, 16, v31
v_and_b32 v7, 0xffff0000, v31
v_pk_add_f32 v[18:19], v[18:19], v[6:7]
v_max_f32 v18, 0, v18
v_max_f32 v19, 0, v19
v_pk_mul_f32 v[18:19], v[18:19], v[18:19]
v_cvt_pk_bf16_f32 v17, v18, v19
v_mov_b64 v[10:11], v[16:17]
ds_write_b128 v4, v[8:11] offset:2048
v_lshlrev_b32 v6, 16, v28
v_and_b32 v7, 0xffff0000, v28
v_pk_add_f32 v[12:13], v[12:13], v[6:7]
v_max_f32 v12, 0, v12
v_max_f32 v13, 0, v13
v_pk_mul_f32 v[12:13], v[12:13], v[12:13]
v_cvt_pk_bf16_f32 v12, v12, v13
v_lshlrev_b32 v6, 16, v29
v_and_b32 v7, 0xffff0000, v29
v_pk_add_f32 v[14:15], v[14:15], v[6:7]
v_max_f32 v14, 0, v14
v_max_f32 v15, 0, v15
v_pk_mul_f32 v[14:15], v[14:15], v[14:15]
v_cvt_pk_bf16_f32 v13, v14, v15
v_lshlrev_b32 v6, 16, v30
v_and_b32 v7, 0xffff0000, v30
v_pk_add_f32 v[20:21], v[20:21], v[6:7]
v_max_f32 v20, 0, v20
v_max_f32 v21, 0, v21
v_pk_mul_f32 v[20:21], v[20:21], v[20:21]
v_cvt_pk_bf16_f32 v20, v20, v21
v_lshlrev_b32 v6, 16, v31
v_and_b32 v7, 0xffff0000, v31
v_pk_add_f32 v[22:23], v[22:23], v[6:7]
v_max_f32 v22, 0, v22
v_max_f32 v23, 0, v23
v_pk_mul_f32 v[22:23], v[22:23], v[22:23]
v_cvt_pk_bf16_f32 v21, v22, v23
v_mov_b64 v[14:15], v[20:21]
ds_write_b128 v4, v[12:15] offset:3072
v_add_u32 v4, 4096, v4
s_add_u32 s8, s8, 1
s_cmp_lt_u32 s8, 7
s_cbranch_scc1 WF_l1
s_lshl_b32 s16, s9, 2
s_cmp_eq_u32 s9, 3
s_cselect_b32 s16, 11, s16
s_mul_i32 s13, s16, 114688
s_add_u32 s13, s13, 60817408
s_add_u32 s52, s13, 0
s_add_u32 s53, s13, 57344
s_add_u32 s54, s13, 114688
s_add_u32 s55, s13, 172032
s_add_u32 s56, s13, 229376
s_add_u32 s57, s13, 286720
s_add_u32 s58, s13, 344064
s_add_u32 s59, s13, 401408
s_cmp_ge_u32 s9, 2
s_cselect_b32 s58, 1073741824, s58
s_cselect_b32 s59, 1073741824, s59
s_waitcnt vmcnt(0) lgkmcnt(0)
s_barrier
v_accvgpr_write_b32 a0, 0
v_accvgpr_write_b32 a1, 0
v_accvgpr_write_b32 a2, 0
v_accvgpr_write_b32 a3, 0
v_accvgpr_write_b32 a4, 0
v_accvgpr_write_b32 a5, 0
v_accvgpr_write_b32 a6, 0
v_accvgpr_write_b32 a7, 0
v_accvgpr_write_b32 a8, 0
v_accvgpr_write_b32 a9, 0
v_accvgpr_write_b32 a10, 0
v_accvgpr_write_b32 a11, 0
v_accvgpr_write_b32 a12, 0
v_accvgpr_write_b32 a13, 0
v_accvgpr_write_b32 a14, 0
v_accvgpr_write_b32 a15, 0
v_accvgpr_write_b32 a16, 0
v_accvgpr_write_b32 a17, 0
v_accvgpr_write_b32 a18, 0
v_accvgpr_write_b32 a19, 0
v_accvgpr_write_b32 a20, 0
v_accvgpr_write_b32 a21, 0
v_accvgpr_write_b32 a22, 0
v_accvgpr_write_b32 a23, 0
v_accvgpr_write_b32 a24, 0
v_accvgpr_write_b32 a25, 0
v_accvgpr_write_b32 a26, 0
v_accvgpr_write_b32 a27, 0
v_accvgpr_write_b32 a28, 0
v_accvgpr_write_b32 a29, 0
v_accvgpr_write_b32 a30, 0
v_accvgpr_write_b32 a31, 0
v_accvgpr_write_b32 a32, 0
v_accvgpr_write_b32 a33, 0
v_accvgpr_write_b32 a34, 0
v_accvgpr_write_b32 a35, 0
v_accvgpr_write_b32 a36, 0
v_accvgpr_write_b32 a37, 0
v_accvgpr_write_b32 a38, 0
v_accvgpr_write_b32 a39, 0
v_accvgpr_write_b32 a40, 0
v_accvgpr_write_b32 a41, 0
v_accvgpr_write_b32 a42, 0
v_accvgpr_write_b32 a43, 0
v_accvgpr_write_b32 a44, 0
v_accvgpr_write_b32 a45, 0
v_accvgpr_write_b32 a46, 0
v_accvgpr_write_b32 a47, 0
v_accvgpr_write_b32 a48, 0
v_accvgpr_write_b32 a49, 0
v_accvgpr_write_b32 a50, 0
v_accvgpr_write_b32 a51, 0
v_accvgpr_write_b32 a52, 0
v_accvgpr_write_b32 a53, 0
v_accvgpr_write_b32 a54, 0
v_accvgpr_write_b32 a55, 0
v_accvgpr_write_b32 a56, 0
v_accvgpr_write_b32 a57, 0
v_accvgpr_write_b32 a58, 0
v_accvgpr_write_b32 a59, 0
v_accvgpr_write_b32 a60, 0
v_accvgpr_write_b32 a61, 0
v_accvgpr_write_b32 a62, 0
v_accvgpr_write_b32 a63, 0
v_mov_b32 v4, v1
v_mov_b32 v5, v1
buffer_load_dwordx4 v[32:35], v5, s[4:7], s52 offen offset:0 sc1
buffer_load_dwordx4 v[36:39], v5, s[4:7], s53 offen offset:0 sc1
buffer_load_dwordx4 v[40:43], v5, s[4:7], s54 offen offset:0 sc1
buffer_load_dwordx4 v[44:47], v5, s[4:7], s55 offen offset:0 sc1
buffer_load_dwordx4 v[48:51], v5, s[4:7], s56 offen offset:0 sc1
buffer_load_dwordx4 v[52:55], v5, s[4:7], s57 offen offset:0 sc1
buffer_load_dwordx4 v[56:59], v5, s[4:7], s58 offen offset:0 sc1
buffer_load_dwordx4 v[60:63], v5, s[4:7], s59 offen offset:0 sc1
buffer_load_dwordx4 v[64:67], v5, s[4:7], s52 offen offset:1024 sc1
buffer_load_dwordx4 v[68:71], v5, s[4:7], s53 offen offset:1024 sc1
buffer_load_dwordx4 v[72:75], v5, s[4:7], s54 offen offset:1024 sc1
buffer_load_dwordx4 v[76:79], v5, s[4:7], s55 offen offset:1024 sc1
buffer_load_dwordx4 v[80:83], v5, s[4:7], s56 offen offset:1024 sc1
buffer_load_dwordx4 v[84:87], v5, s[4:7], s57 offen offset:1024 sc1
buffer_load_dwordx4 v[88:91], v5, s[4:7], s58 offen offset:1024 sc1
buffer_load_dwordx4 v[92:95], v5, s[4:7], s59 offen offset:1024 sc1
buffer_load_dwordx4 v[96:99], v5, s[4:7], s52 offen offset:2048 sc1
buffer_load_dwordx4 v[100:103], v5, s[4:7], s53 offen offset:2048 sc1
buffer_load_dwordx4 v[104:107], v5, s[4:7], s54 offen offset:2048 sc1
buffer_load_dwordx4 v[108:111], v5, s[4:7], s55 offen offset:2048 sc1
buffer_load_dwordx4 v[112:115], v5, s[4:7], s56 offen offset:2048 sc1
buffer_load_dwordx4 v[116:119], v5, s[4:7], s57 offen offset:2048 sc1
buffer_load_dwordx4 v[120:123], v5, s[4:7], s58 offen offset:2048 sc1
buffer_load_dwordx4 v[124:127], v5, s[4:7], s59 offen offset:2048 sc1
ds_read_b128 v[8:11], v4 offset:0
ds_read_b128 v[12:15], v4 offset:1024
v_add_u32 v5, 3072, v5
s_mov_b32 s8, 0
WF_l2:
buffer_load_dwordx4 v[128:131], v5, s[4:7], s52 offen offset:0 sc1
buffer_load_dwordx4 v[132:135], v5, s[4:7], s53 offen offset:0 sc1
buffer_load_dwordx4 v[136:139], v5, s[4:7], s54 offen offset:0 sc1
buffer_load_dwordx4 v[140:143], v5, s[4:7], s55 offen offset:0 sc1
buffer_load_dwordx4 v[144:147], v5, s[4:7], s56 offen offset:0 sc1
buffer_load_dwordx4 v[148:151], v5, s[4:7], s57 offen offset:0 sc1
buffer_load_dwordx4 v[152:155], v5, s[4:7], s58 offen offset:0 sc1
buffer_load_dwordx4 v[156:159], v5, s[4:7], s59 offen offset:0 sc1
ds_read_b128 v[16:19], v4 offset:2048
ds_read_b128 v[20:23], v4 offset:3072
s_waitcnt vmcnt(24) lgkmcnt(2)
v_mfma_f32_16x16x32_bf16 a[0:3], v[32:35], v[8:11], a[0:3]
v_mfma_f32_16x16x32_bf16 a[4:7], v[32:35], v[12:15], a[4:7]
v_mfma_f32_16x16x32_bf16 a[8:11], v[36:39], v[8:11], a[8:11]
v_mfma_f32_16x16x32_bf16 a[12:15], v[36:39], v[12:15], a[12:15]
v_mfma_f32_16x16x32_bf16 a[16:19], v[40:43], v[8:11], a[16:19]
v_mfma_f32_16x16x32_bf16 a[20:23], v[40:43], v[12:15], a[20:23]
v_mfma_f32_16x16x32_bf16 a[24:27], v[44:47], v[8:11], a[24:27]
v_mfma_f32_16x16x32_bf16 a[28:31], v[44:47], v[12:15], a[28:31]
v_mfma_f32_16x16x32_bf16 a[32:35], v[48:51], v[8:11], a[32:35]
v_mfma_f32_16x16x32_bf16 a[36:39], v[48:51], v[12:15], a[36:39]
v_mfma_f32_16x16x32_bf16 a[40:43], v[52:55], v[8:11], a[40:43]
v_mfma_f32_16x16x32_bf16 a[44:47], v[52:55], v[12:15], a[44:47]
v_mfma_f32_16x16x32_bf16 a[48:51], v[56:59], v[8:11], a[48:51]
v_mfma_f32_16x16x32_bf16 a[52:55], v[56:59], v[12:15], a[52:55]
v_mfma_f32_16x16x32_bf16 a[56:59], v[60:63], v[8:11], a[56:59]
v_mfma_f32_16x16x32_bf16 a[60:63], v[60:63], v[12:15], a[60:63]
buffer_load_dwordx4 v[32:35], v5, s[4:7], s52 offen offset:1024 sc1
buffer_load_dwordx4 v[36:39], v5, s[4:7], s53 offen offset:1024 sc1
buffer_load_dwordx4 v[40:43], v5, s[4:7], s54 offen offset:1024 sc1
buffer_load_dwordx4 v[44:47], v5, s[4:7], s55 offen offset:1024 sc1
buffer_load_dwordx4 v[48:51], v5, s[4:7], s56 offen offset:1024 sc1
buffer_load_dwordx4 v[52:55], v5, s[4:7], s57 offen offset:1024 sc1
buffer_load_dwordx4 v[56:59], v5, s[4:7], s58 offen offset:1024 sc1
buffer_load_dwordx4 v[60:63], v5, s[4:7], s59 offen offset:1024 sc1
ds_read_b128 v[8:11], v4 offset:4096
ds_read_b128 v[12:15], v4 offset:5120
s_waitcnt vmcnt(24) lgkmcnt(2)
v_mfma_f32_16x16x32_bf16 a[0:3], v[64:67], v[16:19], a[0:3]
v_mfma_f32_16x16x32_bf16 a[4:7], v[64:67], v[20:23], a[4:7]
v_mfma_f32_16x16x32_bf16 a[8:11], v[68:71], v[16:19], a[8:11]
v_mfma_f32_16x16x32_bf16 a[12:15], v[68:71], v[20:23], a[12:15]
v_mfma_f32_16x16x32_bf16 a[16:19], v[72:75], v[16:19], a[16:19]
v_mfma_f32_16x16x32_bf16 a[20:23], v[72:75], v[20:23], a[20:23]
v_mfma_f32_16x16x32_bf16 a[24:27], v[76:79], v[16:19], a[24:27]
v_mfma_f32_16x16x32_bf16 a[28:31], v[76:79], v[20:23], a[28:31]
v_mfma_f32_16x16x32_bf16 a[32:35], v[80:83], v[16:19], a[32:35]
v_mfma_f32_16x16x32_bf16 a[36:39], v[80:83], v[20:23], a[36:39]
v_mfma_f32_16x16x32_bf16 a[40:43], v[84:87], v[16:19], a[40:43]
v_mfma_f32_16x16x32_bf16 a[44:47], v[84:87], v[20:23], a[44:47]
v_mfma_f32_16x16x32_bf16 a[48:51], v[88:91], v[16:19], a[48:51]
v_mfma_f32_16x16x32_bf16 a[52:55], v[88:91], v[20:23], a[52:55]
v_mfma_f32_16x16x32_bf16 a[56:59], v[92:95], v[16:19], a[56:59]
v_mfma_f32_16x16x32_bf16 a[60:63], v[92:95], v[20:23], a[60:63]
buffer_load_dwordx4 v[64:67], v5, s[4:7], s52 offen offset:2048 sc1
buffer_load_dwordx4 v[68:71], v5, s[4:7], s53 offen offset:2048 sc1
buffer_load_dwordx4 v[72:75], v5, s[4:7], s54 offen offset:2048 sc1
buffer_load_dwordx4 v[76:79], v5, s[4:7], s55 offen offset:2048 sc1
buffer_load_dwordx4 v[80:83], v5, s[4:7], s56 offen offset:2048 sc1
buffer_load_dwordx4 v[84:87], v5, s[4:7], s57 offen offset:2048 sc1
buffer_load_dwordx4 v[88:91], v5, s[4:7], s58 offen offset:2048 sc1
buffer_load_dwordx4 v[92:95], v5, s[4:7], s59 offen offset:2048 sc1
ds_read_b128 v[16:19], v4 offset:6144
ds_read_b128 v[20:23], v4 offset:7168
s_waitcnt vmcnt(24) lgkmcnt(2)
v_mfma_f32_16x16x32_bf16 a[0:3], v[96:99], v[8:11], a[0:3]
v_mfma_f32_16x16x32_bf16 a[4:7], v[96:99], v[12:15], a[4:7]
v_mfma_f32_16x16x32_bf16 a[8:11], v[100:103], v[8:11], a[8:11]
v_mfma_f32_16x16x32_bf16 a[12:15], v[100:103], v[12:15], a[12:15]
v_mfma_f32_16x16x32_bf16 a[16:19], v[104:107], v[8:11], a[16:19]
v_mfma_f32_16x16x32_bf16 a[20:23], v[104:107], v[12:15], a[20:23]
v_mfma_f32_16x16x32_bf16 a[24:27], v[108:111], v[8:11], a[24:27]
v_mfma_f32_16x16x32_bf16 a[28:31], v[108:111], v[12:15], a[28:31]
v_mfma_f32_16x16x32_bf16 a[32:35], v[112:115], v[8:11], a[32:35]
v_mfma_f32_16x16x32_bf16 a[36:39], v[112:115], v[12:15], a[36:39]
v_mfma_f32_16x16x32_bf16 a[40:43], v[116:119], v[8:11], a[40:43]
v_mfma_f32_16x16x32_bf16 a[44:47], v[116:119], v[12:15], a[44:47]
v_mfma_f32_16x16x32_bf16 a[48:51], v[120:123], v[8:11], a[48:51]
v_mfma_f32_16x16x32_bf16 a[52:55], v[120:123], v[12:15], a[52:55]
v_mfma_f32_16x16x32_bf16 a[56:59], v[124:127], v[8:11], a[56:59]
v_mfma_f32_16x16x32_bf16 a[60:63], v[124:127], v[12:15], a[60:63]
buffer_load_dwordx4 v[96:99], v5, s[4:7], s52 offen offset:3072 sc1
buffer_load_dwordx4 v[100:103], v5, s[4:7], s53 offen offset:3072 sc1
buffer_load_dwordx4 v[104:107], v5, s[4:7], s54 offen offset:3072 sc1
buffer_load_dwordx4 v[108:111], v5, s[4:7], s55 offen offset:3072 sc1
buffer_load_dwordx4 v[112:115], v5, s[4:7], s56 offen offset:3072 sc1
buffer_load_dwordx4 v[116:119], v5, s[4:7], s57 offen offset:3072 sc1
buffer_load_dwordx4 v[120:123], v5, s[4:7], s58 offen offset:3072 sc1
buffer_load_dwordx4 v[124:127], v5, s[4:7], s59 offen offset:3072 sc1
ds_read_b128 v[8:11], v4 offset:8192
ds_read_b128 v[12:15], v4 offset:9216
s_waitcnt vmcnt(24) lgkmcnt(2)
v_mfma_f32_16x16x32_bf16 a[0:3], v[128:131], v[16:19], a[0:3]
v_mfma_f32_16x16x32_bf16 a[4:7], v[128:131], v[20:23], a[4:7]
v_mfma_f32_16x16x32_bf16 a[8:11], v[132:135], v[16:19], a[8:11]
v_mfma_f32_16x16x32_bf16 a[12:15], v[132:135], v[20:23], a[12:15]
v_mfma_f32_16x16x32_bf16 a[16:19], v[136:139], v[16:19], a[16:19]
v_mfma_f32_16x16x32_bf16 a[20:23], v[136:139], v[20:23], a[20:23]
v_mfma_f32_16x16x32_bf16 a[24:27], v[140:143], v[16:19], a[24:27]
v_mfma_f32_16x16x32_bf16 a[28:31], v[140:143], v[20:23], a[28:31]
v_mfma_f32_16x16x32_bf16 a[32:35], v[144:147], v[16:19], a[32:35]
v_mfma_f32_16x16x32_bf16 a[36:39], v[144:147], v[20:23], a[36:39]
v_mfma_f32_16x16x32_bf16 a[40:43], v[148:151], v[16:19], a[40:43]
v_mfma_f32_16x16x32_bf16 a[44:47], v[148:151], v[20:23], a[44:47]
v_mfma_f32_16x16x32_bf16 a[48:51], v[152:155], v[16:19], a[48:51]
v_mfma_f32_16x16x32_bf16 a[52:55], v[152:155], v[20:23], a[52:55]
v_mfma_f32_16x16x32_bf16 a[56:59], v[156:159], v[16:19], a[56:59]
v_mfma_f32_16x16x32_bf16 a[60:63], v[156:159], v[20:23], a[60:63]
v_add_u32 v5, 4096, v5
v_add_u32 v4, 8192, v4
s_add_u32 s8, s8, 1
s_cmp_lt_u32 s8, 14
s_cbranch_scc1 WF_l2
s_waitcnt vmcnt(0) lgkmcnt(0)
s_lshl_b32 s14, s16, 6
buffer_load_dwordx4 v[32:35], v3, s[40:43], s14 offen offset:0
buffer_load_dwordx4 v[36:39], v3, s[40:43], s14 offen offset:64
buffer_load_dwordx4 v[40:43], v3, s[40:43], s14 offen offset:128
buffer_load_dwordx4 v[44:47], v3, s[40:43], s14 offen offset:192
s_lshl_b32 s14, s16, 10
s_add_u32 s14, s14, s12
s_add_u32 s14, s14, 62914560
s_add_u32 s15, s14, 14336
s_waitcnt vmcnt(0)
v_accvgpr_read_b32 v48, a0
v_accvgpr_read_b32 v49, a1
v_accvgpr_read_b32 v50, a2
v_accvgpr_read_b32 v51, a3
v_accvgpr_read_b32 v52, a8
v_accvgpr_read_b32 v53, a9
v_accvgpr_read_b32 v54, a10
v_accvgpr_read_b32 v55, a11
v_lshlrev_b32 v6, 16, v32
v_and_b32 v7, 0xffff0000, v32
v_pk_add_f32 v[48:49], v[48:49], v[6:7]
v_lshlrev_b32 v6, 16, v33
v_and_b32 v7, 0xffff0000, v33
v_pk_add_f32 v[50:51], v[50:51], v[6:7]
v_lshlrev_b32 v6, 16, v34
v_and_b32 v7, 0xffff0000, v34
v_pk_add_f32 v[52:53], v[52:53], v[6:7]
v_lshlrev_b32 v6, 16, v35
v_and_b32 v7, 0xffff0000, v35
v_pk_add_f32 v[54:55], v[54:55], v[6:7]
v_mul_f32 v56, 0xbfb8aa3b, v48
v_mul_f32 v57, 0xbfb8aa3b, v49
v_mul_f32 v58, 0xbfb8aa3b, v50
v_mul_f32 v59, 0xbfb8aa3b, v51
v_mul_f32 v60, 0xbfb8aa3b, v52
v_mul_f32 v61, 0xbfb8aa3b, v53
v_mul_f32 v62, 0xbfb8aa3b, v54
v_mul_f32 v63, 0xbfb8aa3b, v55
v_exp_f32 v56, v56
v_exp_f32 v57, v57
v_exp_f32 v58, v58
v_exp_f32 v59, v59
v_exp_f32 v60, v60
v_exp_f32 v61, v61
v_exp_f32 v62, v62
v_exp_f32 v63, v63
v_add_f32 v56, 1.0, v56
v_add_f32 v57, 1.0, v57
v_add_f32 v58, 1.0, v58
v_add_f32 v59, 1.0, v59
v_add_f32 v60, 1.0, v60
v_add_f32 v61, 1.0, v61
v_add_f32 v62, 1.0, v62
v_add_f32 v63, 1.0, v63
v_rcp_f32 v56, v56
v_rcp_f32 v57, v57
v_rcp_f32 v58, v58
v_rcp_f32 v59, v59
v_rcp_f32 v60, v60
v_rcp_f32 v61, v61
v_rcp_f32 v62, v62
v_rcp_f32 v63, v63
v_pk_mul_f32 v[48:49], v[48:49], v[56:57]
v_cvt_pk_bf16_f32 v64, v48, v49
v_pk_mul_f32 v[50:51], v[50:51], v[58:59]
v_cvt_pk_bf16_f32 v65, v50, v51
v_pk_mul_f32 v[52:53], v[52:53], v[60:61]
v_cvt_pk_bf16_f32 v66, v52, v53
v_pk_mul_f32 v[54:55], v[54:55], v[62:63]
v_cvt_pk_bf16_f32 v67, v54, v55
buffer_store_dwordx4 v[64:67], v1, s[4:7], s14 offen offset:0 sc1
v_accvgpr_read_b32 v48, a4
v_accvgpr_read_b32 v49, a5
v_accvgpr_read_b32 v50, a6
v_accvgpr_read_b32 v51, a7
v_accvgpr_read_b32 v52, a12
v_accvgpr_read_b32 v53, a13
v_accvgpr_read_b32 v54, a14
v_accvgpr_read_b32 v55, a15
v_lshlrev_b32 v6, 16, v32
v_and_b32 v7, 0xffff0000, v32
v_pk_add_f32 v[48:49], v[48:49], v[6:7]
v_lshlrev_b32 v6, 16, v33
v_and_b32 v7, 0xffff0000, v33
v_pk_add_f32 v[50:51], v[50:51], v[6:7]
v_lshlrev_b32 v6, 16, v34
v_and_b32 v7, 0xffff0000, v34
v_pk_add_f32 v[52:53], v[52:53], v[6:7]
v_lshlrev_b32 v6, 16, v35
v_and_b32 v7, 0xffff0000, v35
v_pk_add_f32 v[54:55], v[54:55], v[6:7]
v_mul_f32 v56, 0xbfb8aa3b, v48
v_mul_f32 v57, 0xbfb8aa3b, v49
v_mul_f32 v58, 0xbfb8aa3b, v50
v_mul_f32 v59, 0xbfb8aa3b, v51
v_mul_f32 v60, 0xbfb8aa3b, v52
v_mul_f32 v61, 0xbfb8aa3b, v53
v_mul_f32 v62, 0xbfb8aa3b, v54
v_mul_f32 v63, 0xbfb8aa3b, v55
v_exp_f32 v56, v56
v_exp_f32 v57, v57
v_exp_f32 v58, v58
v_exp_f32 v59, v59
v_exp_f32 v60, v60
v_exp_f32 v61, v61
v_exp_f32 v62, v62
v_exp_f32 v63, v63
v_add_f32 v56, 1.0, v56
v_add_f32 v57, 1.0, v57
v_add_f32 v58, 1.0, v58
v_add_f32 v59, 1.0, v59
v_add_f32 v60, 1.0, v60
v_add_f32 v61, 1.0, v61
v_add_f32 v62, 1.0, v62
v_add_f32 v63, 1.0, v63
v_rcp_f32 v56, v56
v_rcp_f32 v57, v57
v_rcp_f32 v58, v58
v_rcp_f32 v59, v59
v_rcp_f32 v60, v60
v_rcp_f32 v61, v61
v_rcp_f32 v62, v62
v_rcp_f32 v63, v63
v_pk_mul_f32 v[48:49], v[48:49], v[56:57]
v_cvt_pk_bf16_f32 v68, v48, v49
v_pk_mul_f32 v[50:51], v[50:51], v[58:59]
v_cvt_pk_bf16_f32 v69, v50, v51
v_pk_mul_f32 v[52:53], v[52:53], v[60:61]
v_cvt_pk_bf16_f32 v70, v52, v53
v_pk_mul_f32 v[54:55], v[54:55], v[62:63]
v_cvt_pk_bf16_f32 v71, v54, v55
buffer_store_dwordx4 v[68:71], v1, s[4:7], s15 offen offset:0 sc1
v_accvgpr_read_b32 v48, a16
v_accvgpr_read_b32 v49, a17
v_accvgpr_read_b32 v50, a18
v_accvgpr_read_b32 v51, a19
v_accvgpr_read_b32 v52, a24
v_accvgpr_read_b32 v53, a25
v_accvgpr_read_b32 v54, a26
v_accvgpr_read_b32 v55, a27
v_lshlrev_b32 v6, 16, v36
v_and_b32 v7, 0xffff0000, v36
v_pk_add_f32 v[48:49], v[48:49], v[6:7]
v_lshlrev_b32 v6, 16, v37
v_and_b32 v7, 0xffff0000, v37
v_pk_add_f32 v[50:51], v[50:51], v[6:7]
v_lshlrev_b32 v6, 16, v38
v_and_b32 v7, 0xffff0000, v38
v_pk_add_f32 v[52:53], v[52:53], v[6:7]
v_lshlrev_b32 v6, 16, v39
v_and_b32 v7, 0xffff0000, v39
v_pk_add_f32 v[54:55], v[54:55], v[6:7]
v_mul_f32 v56, 0xbfb8aa3b, v48
v_mul_f32 v57, 0xbfb8aa3b, v49
v_mul_f32 v58, 0xbfb8aa3b, v50
v_mul_f32 v59, 0xbfb8aa3b, v51
v_mul_f32 v60, 0xbfb8aa3b, v52
v_mul_f32 v61, 0xbfb8aa3b, v53
v_mul_f32 v62, 0xbfb8aa3b, v54
v_mul_f32 v63, 0xbfb8aa3b, v55
v_exp_f32 v56, v56
v_exp_f32 v57, v57
v_exp_f32 v58, v58
v_exp_f32 v59, v59
v_exp_f32 v60, v60
v_exp_f32 v61, v61
v_exp_f32 v62, v62
v_exp_f32 v63, v63
v_add_f32 v56, 1.0, v56
v_add_f32 v57, 1.0, v57
v_add_f32 v58, 1.0, v58
v_add_f32 v59, 1.0, v59
v_add_f32 v60, 1.0, v60
v_add_f32 v61, 1.0, v61
v_add_f32 v62, 1.0, v62
v_add_f32 v63, 1.0, v63
v_rcp_f32 v56, v56
v_rcp_f32 v57, v57
v_rcp_f32 v58, v58
v_rcp_f32 v59, v59
v_rcp_f32 v60, v60
v_rcp_f32 v61, v61
v_rcp_f32 v62, v62
v_rcp_f32 v63, v63
v_pk_mul_f32 v[48:49], v[48:49], v[56:57]
v_cvt_pk_bf16_f32 v64, v48, v49
v_pk_mul_f32 v[50:51], v[50:51], v[58:59]
v_cvt_pk_bf16_f32 v65, v50, v51
v_pk_mul_f32 v[52:53], v[52:53], v[60:61]
v_cvt_pk_bf16_f32 v66, v52, v53
v_pk_mul_f32 v[54:55], v[54:55], v[62:63]
v_cvt_pk_bf16_f32 v67, v54, v55
buffer_store_dwordx4 v[64:67], v1, s[4:7], s14 offen offset:1024 sc1
v_accvgpr_read_b32 v48, a20
v_accvgpr_read_b32 v49, a21
v_accvgpr_read_b32 v50, a22
v_accvgpr_read_b32 v51, a23
v_accvgpr_read_b32 v52, a28
v_accvgpr_read_b32 v53, a29
v_accvgpr_read_b32 v54, a30
v_accvgpr_read_b32 v55, a31
v_lshlrev_b32 v6, 16, v36
v_and_b32 v7, 0xffff0000, v36
v_pk_add_f32 v[48:49], v[48:49], v[6:7]
v_lshlrev_b32 v6, 16, v37
v_and_b32 v7, 0xffff0000, v37
v_pk_add_f32 v[50:51], v[50:51], v[6:7]
v_lshlrev_b32 v6, 16, v38
v_and_b32 v7, 0xffff0000, v38
v_pk_add_f32 v[52:53], v[52:53], v[6:7]
v_lshlrev_b32 v6, 16, v39
v_and_b32 v7, 0xffff0000, v39
v_pk_add_f32 v[54:55], v[54:55], v[6:7]
v_mul_f32 v56, 0xbfb8aa3b, v48
v_mul_f32 v57, 0xbfb8aa3b, v49
v_mul_f32 v58, 0xbfb8aa3b, v50
v_mul_f32 v59, 0xbfb8aa3b, v51
v_mul_f32 v60, 0xbfb8aa3b, v52
v_mul_f32 v61, 0xbfb8aa3b, v53
v_mul_f32 v62, 0xbfb8aa3b, v54
v_mul_f32 v63, 0xbfb8aa3b, v55
v_exp_f32 v56, v56
v_exp_f32 v57, v57
v_exp_f32 v58, v58
v_exp_f32 v59, v59
v_exp_f32 v60, v60
v_exp_f32 v61, v61
v_exp_f32 v62, v62
v_exp_f32 v63, v63
v_add_f32 v56, 1.0, v56
v_add_f32 v57, 1.0, v57
v_add_f32 v58, 1.0, v58
v_add_f32 v59, 1.0, v59
v_add_f32 v60, 1.0, v60
v_add_f32 v61, 1.0, v61
v_add_f32 v62, 1.0, v62
v_add_f32 v63, 1.0, v63
v_rcp_f32 v56, v56
v_rcp_f32 v57, v57
v_rcp_f32 v58, v58
v_rcp_f32 v59, v59
v_rcp_f32 v60, v60
v_rcp_f32 v61, v61
v_rcp_f32 v62, v62
v_rcp_f32 v63, v63
v_pk_mul_f32 v[48:49], v[48:49], v[56:57]
v_cvt_pk_bf16_f32 v68, v48, v49
v_pk_mul_f32 v[50:51], v[50:51], v[58:59]
v_cvt_pk_bf16_f32 v69, v50, v51
v_pk_mul_f32 v[52:53], v[52:53], v[60:61]
v_cvt_pk_bf16_f32 v70, v52, v53
v_pk_mul_f32 v[54:55], v[54:55], v[62:63]
v_cvt_pk_bf16_f32 v71, v54, v55
buffer_store_dwordx4 v[68:71], v1, s[4:7], s15 offen offset:1024 sc1
v_accvgpr_read_b32 v48, a32
v_accvgpr_read_b32 v49, a33
v_accvgpr_read_b32 v50, a34
v_accvgpr_read_b32 v51, a35
v_accvgpr_read_b32 v52, a40
v_accvgpr_read_b32 v53, a41
v_accvgpr_read_b32 v54, a42
v_accvgpr_read_b32 v55, a43
v_lshlrev_b32 v6, 16, v40
v_and_b32 v7, 0xffff0000, v40
v_pk_add_f32 v[48:49], v[48:49], v[6:7]
v_lshlrev_b32 v6, 16, v41
v_and_b32 v7, 0xffff0000, v41
v_pk_add_f32 v[50:51], v[50:51], v[6:7]
v_lshlrev_b32 v6, 16, v42
v_and_b32 v7, 0xffff0000, v42
v_pk_add_f32 v[52:53], v[52:53], v[6:7]
v_lshlrev_b32 v6, 16, v43
v_and_b32 v7, 0xffff0000, v43
v_pk_add_f32 v[54:55], v[54:55], v[6:7]
v_mul_f32 v56, 0xbfb8aa3b, v48
v_mul_f32 v57, 0xbfb8aa3b, v49
v_mul_f32 v58, 0xbfb8aa3b, v50
v_mul_f32 v59, 0xbfb8aa3b, v51
v_mul_f32 v60, 0xbfb8aa3b, v52
v_mul_f32 v61, 0xbfb8aa3b, v53
v_mul_f32 v62, 0xbfb8aa3b, v54
v_mul_f32 v63, 0xbfb8aa3b, v55
v_exp_f32 v56, v56
v_exp_f32 v57, v57
v_exp_f32 v58, v58
v_exp_f32 v59, v59
v_exp_f32 v60, v60
v_exp_f32 v61, v61
v_exp_f32 v62, v62
v_exp_f32 v63, v63
v_add_f32 v56, 1.0, v56
v_add_f32 v57, 1.0, v57
v_add_f32 v58, 1.0, v58
v_add_f32 v59, 1.0, v59
v_add_f32 v60, 1.0, v60
v_add_f32 v61, 1.0, v61
v_add_f32 v62, 1.0, v62
v_add_f32 v63, 1.0, v63
v_rcp_f32 v56, v56
v_rcp_f32 v57, v57
v_rcp_f32 v58, v58
v_rcp_f32 v59, v59
v_rcp_f32 v60, v60
v_rcp_f32 v61, v61
v_rcp_f32 v62, v62
v_rcp_f32 v63, v63
v_pk_mul_f32 v[48:49], v[48:49], v[56:57]
v_cvt_pk_bf16_f32 v64, v48, v49
v_pk_mul_f32 v[50:51], v[50:51], v[58:59]
v_cvt_pk_bf16_f32 v65, v50, v51
v_pk_mul_f32 v[52:53], v[52:53], v[60:61]
v_cvt_pk_bf16_f32 v66, v52, v53
v_pk_mul_f32 v[54:55], v[54:55], v[62:63]
v_cvt_pk_bf16_f32 v67, v54, v55
buffer_store_dwordx4 v[64:67], v1, s[4:7], s14 offen offset:2048 sc1
v_accvgpr_read_b32 v48, a36
v_accvgpr_read_b32 v49, a37
v_accvgpr_read_b32 v50, a38
v_accvgpr_read_b32 v51, a39
v_accvgpr_read_b32 v52, a44
v_accvgpr_read_b32 v53, a45
v_accvgpr_read_b32 v54, a46
v_accvgpr_read_b32 v55, a47
v_lshlrev_b32 v6, 16, v40
v_and_b32 v7, 0xffff0000, v40
v_pk_add_f32 v[48:49], v[48:49], v[6:7]
v_lshlrev_b32 v6, 16, v41
v_and_b32 v7, 0xffff0000, v41
v_pk_add_f32 v[50:51], v[50:51], v[6:7]
v_lshlrev_b32 v6, 16, v42
v_and_b32 v7, 0xffff0000, v42
v_pk_add_f32 v[52:53], v[52:53], v[6:7]
v_lshlrev_b32 v6, 16, v43
v_and_b32 v7, 0xffff0000, v43
v_pk_add_f32 v[54:55], v[54:55], v[6:7]
v_mul_f32 v56, 0xbfb8aa3b, v48
v_mul_f32 v57, 0xbfb8aa3b, v49
v_mul_f32 v58, 0xbfb8aa3b, v50
v_mul_f32 v59, 0xbfb8aa3b, v51
v_mul_f32 v60, 0xbfb8aa3b, v52
v_mul_f32 v61, 0xbfb8aa3b, v53
v_mul_f32 v62, 0xbfb8aa3b, v54
v_mul_f32 v63, 0xbfb8aa3b, v55
v_exp_f32 v56, v56
v_exp_f32 v57, v57
v_exp_f32 v58, v58
v_exp_f32 v59, v59
v_exp_f32 v60, v60
v_exp_f32 v61, v61
v_exp_f32 v62, v62
v_exp_f32 v63, v63
v_add_f32 v56, 1.0, v56
v_add_f32 v57, 1.0, v57
v_add_f32 v58, 1.0, v58
v_add_f32 v59, 1.0, v59
v_add_f32 v60, 1.0, v60
v_add_f32 v61, 1.0, v61
v_add_f32 v62, 1.0, v62
v_add_f32 v63, 1.0, v63
v_rcp_f32 v56, v56
v_rcp_f32 v57, v57
v_rcp_f32 v58, v58
v_rcp_f32 v59, v59
v_rcp_f32 v60, v60
v_rcp_f32 v61, v61
v_rcp_f32 v62, v62
v_rcp_f32 v63, v63
v_pk_mul_f32 v[48:49], v[48:49], v[56:57]
v_cvt_pk_bf16_f32 v68, v48, v49
v_pk_mul_f32 v[50:51], v[50:51], v[58:59]
v_cvt_pk_bf16_f32 v69, v50, v51
v_pk_mul_f32 v[52:53], v[52:53], v[60:61]
v_cvt_pk_bf16_f32 v70, v52, v53
v_pk_mul_f32 v[54:55], v[54:55], v[62:63]
v_cvt_pk_bf16_f32 v71, v54, v55
buffer_store_dwordx4 v[68:71], v1, s[4:7], s15 offen offset:2048 sc1
s_cmp_ge_u32 s9, 2
s_cbranch_scc1 WF_gdone
v_accvgpr_read_b32 v48, a48
v_accvgpr_read_b32 v49, a49
v_accvgpr_read_b32 v50, a50
v_accvgpr_read_b32 v51, a51
v_accvgpr_read_b32 v52, a56
v_accvgpr_read_b32 v53, a57
v_accvgpr_read_b32 v54, a58
v_accvgpr_read_b32 v55, a59
v_lshlrev_b32 v6, 16, v44
v_and_b32 v7, 0xffff0000, v44
v_pk_add_f32 v[48:49], v[48:49], v[6:7]
v_lshlrev_b32 v6, 16, v45
v_and_b32 v7, 0xffff0000, v45
v_pk_add_f32 v[50:51], v[50:51], v[6:7]
v_lshlrev_b32 v6, 16, v46
v_and_b32 v7, 0xffff0000, v46
v_pk_add_f32 v[52:53], v[52:53], v[6:7]
v_lshlrev_b32 v6, 16, v47
v_and_b32 v7, 0xffff0000, v47
v_pk_add_f32 v[54:55], v[54:55], v[6:7]
v_mul_f32 v56, 0xbfb8aa3b, v48
v_mul_f32 v57, 0xbfb8aa3b, v49
v_mul_f32 v58, 0xbfb8aa3b, v50
v_mul_f32 v59, 0xbfb8aa3b, v51
v_mul_f32 v60, 0xbfb8aa3b, v52
v_mul_f32 v61, 0xbfb8aa3b, v53
v_mul_f32 v62, 0xbfb8aa3b, v54
v_mul_f32 v63, 0xbfb8aa3b, v55
v_exp_f32 v56, v56
v_exp_f32 v57, v57
v_exp_f32 v58, v58
v_exp_f32 v59, v59
v_exp_f32 v60, v60
v_exp_f32 v61, v61
v_exp_f32 v62, v62
v_exp_f32 v63, v63
v_add_f32 v56, 1.0, v56
v_add_f32 v57, 1.0, v57
v_add_f32 v58, 1.0, v58
v_add_f32 v59, 1.0, v59
v_add_f32 v60, 1.0, v60
v_add_f32 v61, 1.0, v61
v_add_f32 v62, 1.0, v62
v_add_f32 v63, 1.0, v63
v_rcp_f32 v56, v56
v_rcp_f32 v57, v57
v_rcp_f32 v58, v58
v_rcp_f32 v59, v59
v_rcp_f32 v60, v60
v_rcp_f32 v61, v61
v_rcp_f32 v62, v62
v_rcp_f32 v63, v63
v_pk_mul_f32 v[48:49], v[48:49], v[56:57]
v_cvt_pk_bf16_f32 v64, v48, v49
v_pk_mul_f32 v[50:51], v[50:51], v[58:59]
v_cvt_pk_bf16_f32 v65, v50, v51
v_pk_mul_f32 v[52:53], v[52:53], v[60:61]
v_cvt_pk_bf16_f32 v66, v52, v53
v_pk_mul_f32 v[54:55], v[54:55], v[62:63]
v_cvt_pk_bf16_f32 v67, v54, v55
buffer_store_dwordx4 v[64:67], v1, s[4:7], s14 offen offset:3072 sc1
v_accvgpr_read_b32 v48, a52
v_accvgpr_read_b32 v49, a53
v_accvgpr_read_b32 v50, a54
v_accvgpr_read_b32 v51, a55
v_accvgpr_read_b32 v52, a60
v_accvgpr_read_b32 v53, a61
v_accvgpr_read_b32 v54, a62
v_accvgpr_read_b32 v55, a63
v_lshlrev_b32 v6, 16, v44
v_and_b32 v7, 0xffff0000, v44
v_pk_add_f32 v[48:49], v[48:49], v[6:7]
v_lshlrev_b32 v6, 16, v45
v_and_b32 v7, 0xffff0000, v45
v_pk_add_f32 v[50:51], v[50:51], v[6:7]
v_lshlrev_b32 v6, 16, v46
v_and_b32 v7, 0xffff0000, v46
v_pk_add_f32 v[52:53], v[52:53], v[6:7]
v_lshlrev_b32 v6, 16, v47
v_and_b32 v7, 0xffff0000, v47
v_pk_add_f32 v[54:55], v[54:55], v[6:7]
v_mul_f32 v56, 0xbfb8aa3b, v48
v_mul_f32 v57, 0xbfb8aa3b, v49
v_mul_f32 v58, 0xbfb8aa3b, v50
v_mul_f32 v59, 0xbfb8aa3b, v51
v_mul_f32 v60, 0xbfb8aa3b, v52
v_mul_f32 v61, 0xbfb8aa3b, v53
v_mul_f32 v62, 0xbfb8aa3b, v54
v_mul_f32 v63, 0xbfb8aa3b, v55
v_exp_f32 v56, v56
v_exp_f32 v57, v57
v_exp_f32 v58, v58
v_exp_f32 v59, v59
v_exp_f32 v60, v60
v_exp_f32 v61, v61
v_exp_f32 v62, v62
v_exp_f32 v63, v63
v_add_f32 v56, 1.0, v56
v_add_f32 v57, 1.0, v57
v_add_f32 v58, 1.0, v58
v_add_f32 v59, 1.0, v59
v_add_f32 v60, 1.0, v60
v_add_f32 v61, 1.0, v61
v_add_f32 v62, 1.0, v62
v_add_f32 v63, 1.0, v63
v_rcp_f32 v56, v56
v_rcp_f32 v57, v57
v_rcp_f32 v58, v58
v_rcp_f32 v59, v59
v_rcp_f32 v60, v60
v_rcp_f32 v61, v61
v_rcp_f32 v62, v62
v_rcp_f32 v63, v63
v_pk_mul_f32 v[48:49], v[48:49], v[56:57]
v_cvt_pk_bf16_f32 v68, v48, v49
v_pk_mul_f32 v[50:51], v[50:51], v[58:59]
v_cvt_pk_bf16_f32 v69, v50, v51
v_pk_mul_f32 v[52:53], v[52:53], v[60:61]
v_cvt_pk_bf16_f32 v70, v52, v53
v_pk_mul_f32 v[54:55], v[54:55], v[62:63]
v_cvt_pk_bf16_f32 v71, v54, v55
buffer_store_dwordx4 v[68:71], v1, s[4:7], s15 offen offset:3072 sc1
WF_gdone:
s_lshl_b32 s15, s10, 7
s_add_u32 s15, s15, 54771712
s_waitcnt vmcnt(0)
s_barrier
s_cmp_lg_u32 s9, 0
s_cbranch_scc1 WF_gsig
v_mov_b32 v2, 1
s_mov_b64 exec, 1
buffer_atomic_add v2, off, s[4:7], s15 sc1
s_mov_b64 exec, -1
WF_gsig:
s_cmp_ge_u32 s10, 56
s_cbranch_scc1 WF_end
s_mul_i32 s8, s10, 4682
s_lshr_b32 s8, s8, 16
s_mul_i32 s16, s8, 14
s_sub_u32 s16, s10, s16
v_lshrrev_b32 v29, 4, v0
v_mov_b32 v28, 0x1c00
v_mul_lo_u32 v27, v29, v28
v_mov_b32 v24, s16
v_lshlrev_b32 v25, 5, v24
v_and_b32 v22, 15, v0
v_lshrrev_b32 v23, 2, v22
v_lshlrev_b32 v24, 3, v23
v_add_u32 v26, v25, v24
v_and_b32 v25, 15, v0
v_and_b32 v24, 3, v25
v_add_u32 v29, v26, v24
v_lshlrev_b32 v28, 4, v29
v_add_u32 v4, v27, v28
v_and_b32 v24, 15, v0
v_mov_b32 v26, 0x380
v_mul_lo_u32 v29, v24, v26
v_mov_b32 v24, s16
v_lshlrev_b32 v26, 6, v24
v_add_u32 v27, v29, v26
v_lshrrev_b32 v29, 4, v0
v_lshlrev_b32 v26, 4, v29
v_add_u32 v28, v27, v26
v_mov_b32 v29, 1
v_and_b32 v27, s9, v29
v_mov_b32 v29, 0x3800
v_mul_lo_u32 v26, v27, v29
v_add_u32 v5, v28, v26
v_mov_b32 v29, s16
v_lshlrev_b32 v28, 10, v29
v_lshlrev_b32 v29, 4, v0
v_add_u32 v26, v28, v29
v_mov_b32 v27, 1
v_and_b32 v28, s9, v27
v_mov_b32 v27, 0x3800
v_mul_lo_u32 v29, v28, v27
v_add_u32 v6, v26, v29
v_and_b32 v29, 1, v0
v_lshlrev_b32 v7, 14, v29
v_mov_b32 v26, s9
v_lshlrev_b32 v29, 12, v26
v_lshlrev_b32 v26, 4, v0
v_add_u32 v3, v29, v26
v_mov_b32 v27, 1
v_and_b32 v29, s9, v27
v_lshlrev_b32 v26, 11, v29
v_lshlrev_b32 v29, 4, v0
v_add_u32 v123, v26, v29
v_mov_b32 v29, 0x3430000
v_mov_b32 v27, 0x343c000
v_mov_b32 v24, 0x3434000
v_mov_b32 v25, 0x3438000
v_and_b32 v23, 3, v0
v_mov_b32 v22, 3
v_cmp_lt_u32 vcc, v23, v22
s_nop 1
v_cndmask_b32 v28, v25, v24, vcc
v_and_b32 v22, 3, v0
v_mov_b32 v23, 2
v_cmp_lt_u32 vcc, v22, v23
s_nop 1
v_cndmask_b32 v26, v28, v27, vcc
v_and_b32 v23, 3, v0
v_mov_b32 v22, 1
v_cmp_lt_u32 vcc, v23, v22
s_nop 1
v_cndmask_b32 v121, v26, v29, vcc
v_mov_b32 v22, 1
v_mov_b32 v23, 16
v_and_b32 v29, 3, v0
v_xor_b32 v26, 1, v29
v_mov_b32 v29, 1
v_cmp_lt_u32 vcc, v26, v29
s_nop 1
v_cndmask_b32 v122, v23, v22, vcc
s_mul_i32 s17, s9, 114688
s_mul_i32 s18, s9, 28672
s_lshl_b32 s23, s9, 12
s_lshl_b32 s24, s9, 10
s_add_u32 s24, s24, 16384
WF_l3:
s_getpc_b64 s[52:53]
CT_1:
s_add_u32 s52, s52, WF_l3-CT_1
s_addc_u32 s53, s53, (WF_l3-CT_1)>>32
s_mov_b32 s54, WF_end-WF_l3
s_mov_b32 s55, 0x20000
s_lshl_b32 s11, s9, 10
v_lshlrev_b32 v27, 4, v0
buffer_load_dword v120, v27, s[52:55], s11 offen
s_lshl_b32 s13, s8, 7
s_cmp_lg_u32 s9, 0
s_cbranch_scc1 WF_f1go
s_mov_b32 s19, 262144
WF_f1:
buffer_load_dword v2, v121, s[4:7], s13 offen sc1
s_sub_u32 s19, s19, 1
s_cbranch_scc1 M_exit
s_waitcnt vmcnt(0)
v_cmp_gt_u32 vcc, v122, v2
s_and_b32 s11, vcc_lo, 3
s_cbranch_scc1 WF_f1
s_and_b32 s28, vcc_lo, 12
WF_f1go:
s_barrier
s_mul_i32 s14, s8, 458752
s_add_u32 s14, s14, s17
s_add_u32 s14, s14, 16777216
buffer_load_dwordx4 v[32:35], v4, s[4:7], s14 offen offset:0 sc1
buffer_load_dwordx4 v[36:39], v4, s[4:7], s14 offen offset:64 sc1
s_add_u32 s14, s14, 28672
buffer_load_dwordx4 v[40:43], v4, s[4:7], s14 offen offset:0 sc1
buffer_load_dwordx4 v[44:47], v4, s[4:7], s14 offen offset:64 sc1
s_add_u32 s14, s14, 28672
buffer_load_dwordx4 v[48:51], v4, s[4:7], s14 offen offset:0 sc1
buffer_load_dwordx4 v[52:55], v4, s[4:7], s14 offen offset:64 sc1
s_add_u32 s14, s14, 28672
buffer_load_dwordx4 v[56:59], v4, s[4:7], s14 offen offset:0 sc1
buffer_load_dwordx4 v[60:63], v4, s[4:7], s14 offen offset:64 sc1
s_mul_i32 s14, s8, 28672
buffer_load_dwordx4 v[112:115], v5, s[44:47], s14 offen
s_add_u32 s21, s14, 62914560
buffer_load_dwordx4 v[116:119], v6, s[4:7], s21 offen sc1
s_mul_i32 s21, s8, 40960
s_add_u32 s21, s21, 55574528
s_add_u32 s22, s21, s24
s_add_u32 s21, s21, s23
s_add_u32 s25, s21, 20480
s_add_u32 s26, s22, 20480
s_mul_i32 s27, s8, 114688
s_add_u32 s27, s27, s18
s_add_u32 s27, s27, 46137344
s_cmp_eq_u32 s8, 63
s_cbranch_scc0 WF_flags
s_mov_b32 s15, 53928960
s_mov_b32 s19, 262144
WF_dir_1:
buffer_load_dword v2, off, s[4:7], s15 sc1
s_sub_u32 s19, s19, 1
s_cbranch_scc1 M_exit
s_waitcnt vmcnt(0)
v_cmp_eq_u32 vcc, -1, v2
s_cbranch_vccnz WF_dir_1
WF_dir:
buffer_load_dwordx4 v[72:75], v1, s[4:7], s21 offen offset:0 sc1
buffer_load_dwordx4 v[76:79], v1, s[4:7], s25 offen offset:0 sc1
buffer_load_dwordx4 v[80:83], v1, s[4:7], s21 offen offset:1024 sc1
buffer_load_dwordx4 v[84:87], v1, s[4:7], s25 offen offset:1024 sc1
buffer_load_dwordx4 v[88:91], v1, s[4:7], s21 offen offset:2048 sc1
buffer_load_dwordx4 v[92:95], v1, s[4:7], s25 offen offset:2048 sc1
buffer_load_dwordx4 v[96:99], v1, s[4:7], s21 offen offset:3072 sc1
buffer_load_dwordx4 v[100:103], v1, s[4:7], s25 offen offset:3072 sc1
buffer_load_dwordx4 v[104:107], v1, s[4:7], s22 offen sc1
buffer_load_dwordx4 v[108:111], v1, s[4:7], s26 offen sc1
buffer_load_dwordx4 v[64:67], v4, s[4:7], s27 offen offset:0 sc1
buffer_load_dwordx4 v[68:71], v4, s[4:7], s27 offen offset:64 sc1
s_sub_u32 s19, s19, 1
s_cbranch_scc1 M_exit
s_waitcnt vmcnt(0)
v_max3_u32 v2, v64, v65, v66
v_max3_u32 v2, v2, v67, v68
v_max3_u32 v2, v2, v69, v70
v_max3_u32 v2, v2, v71, v72
v_max3_u32 v2, v2, v73, v74
v_max3_u32 v2, v2, v75, v76
v_max3_u32 v2, v2, v77, v78
v_max3_u32 v2, v2, v79, v80
v_max3_u32 v2, v2, v81, v82
v_max3_u32 v2, v2, v83, v84
v_max3_u32 v2, v2, v85, v86
v_max3_u32 v2, v2, v87, v88
v_max3_u32 v2, v2, v89, v90
v_max3_u32 v2, v2, v91, v92
v_max3_u32 v2, v2, v93, v94
v_max3_u32 v2, v2, v95, v96
v_max3_u32 v2, v2, v97, v98
v_max3_u32 v2, v2, v99, v100
v_max3_u32 v2, v2, v101, v102
v_max3_u32 v2, v2, v103, v104
v_max3_u32 v2, v2, v105, v106
v_max3_u32 v2, v2, v107, v108
v_max3_u32 v2, v2, v109, v110
v_max_u32 v2, v2, v111
v_cmp_eq_u32 vcc, -1, v2
s_cbranch_vccnz WF_dir
s_branch WF_go
WF_flags:
s_add_u32 s15, s13, 54738944
s_cmp_lg_u32 s9, 0
s_cbranch_scc1 WF_f2go
s_cmp_eq_u32 s28, 0
s_cbranch_scc1 WF_f2go
s_mov_b32 s19, 262144
WF_f2:
buffer_load_dword v2, v7, s[4:7], s15 offen sc1
s_sub_u32 s19, s19, 1
s_cbranch_scc1 M_exit
s_waitcnt vmcnt(0)
v_cmp_gt_u32 vcc, 16, v2
s_cbranch_vccnz WF_f2
WF_f2go:
s_barrier
buffer_load_dwordx4 v[72:75], v1, s[4:7], s21 offen offset:0 sc1
buffer_load_dwordx4 v[76:79], v1, s[4:7], s25 offen offset:0 sc1
buffer_load_dwordx4 v[80:83], v1, s[4:7], s21 offen offset:1024 sc1
buffer_load_dwordx4 v[84:87], v1, s[4:7], s25 offen offset:1024 sc1
buffer_load_dwordx4 v[88:91], v1, s[4:7], s21 offen offset:2048 sc1
buffer_load_dwordx4 v[92:95], v1, s[4:7], s25 offen offset:2048 sc1
buffer_load_dwordx4 v[96:99], v1, s[4:7], s21 offen offset:3072 sc1
buffer_load_dwordx4 v[100:103], v1, s[4:7], s25 offen offset:3072 sc1
buffer_load_dwordx4 v[104:107], v1, s[4:7], s22 offen sc1
buffer_load_dwordx4 v[108:111], v1, s[4:7], s26 offen sc1
buffer_load_dwordx4 v[64:67], v4, s[4:7], s27 offen offset:0 sc1
buffer_load_dwordx4 v[68:71], v4, s[4:7], s27 offen offset:64 sc1
s_waitcnt vmcnt(0)
WF_go:
v_mfma_f32_16x16x32_bf16 v[8:11], v[32:35], v[72:75], 0
v_mfma_f32_16x16x32_bf16 v[16:19], v[32:35], v[76:79], 0
v_mfma_f32_16x16x32_bf16 v[12:15], v[36:39], v[72:75], 0
v_mfma_f32_16x16x32_bf16 v[20:23], v[36:39], v[76:79], 0
v_mfma_f32_16x16x32_bf16 v[8:11], v[40:43], v[80:83], v[8:11]
v_mfma_f32_16x16x32_bf16 v[16:19], v[40:43], v[84:87], v[16:19]
v_mfma_f32_16x16x32_bf16 v[12:15], v[44:47], v[80:83], v[12:15]
v_mfma_f32_16x16x32_bf16 v[20:23], v[44:47], v[84:87], v[20:23]
v_mfma_f32_16x16x32_bf16 v[8:11], v[48:51], v[88:91], v[8:11]
v_mfma_f32_16x16x32_bf16 v[16:19], v[48:51], v[92:95], v[16:19]
v_mfma_f32_16x16x32_bf16 v[12:15], v[52:55], v[88:91], v[12:15]
v_mfma_f32_16x16x32_bf16 v[20:23], v[52:55], v[92:95], v[20:23]
v_mfma_f32_16x16x32_bf16 v[8:11], v[56:59], v[96:99], v[8:11]
v_mfma_f32_16x16x32_bf16 v[16:19], v[56:59], v[100:103], v[16:19]
v_mfma_f32_16x16x32_bf16 v[12:15], v[60:63], v[96:99], v[12:15]
v_mfma_f32_16x16x32_bf16 v[20:23], v[60:63], v[100:103], v[20:23]
v_mfma_f32_16x16x32_bf16 v[8:11], v[64:67], v[104:107], v[8:11]
v_mfma_f32_16x16x32_bf16 v[16:19], v[64:67], v[108:111], v[16:19]
v_mfma_f32_16x16x32_bf16 v[12:15], v[68:71], v[104:107], v[12:15]
v_mfma_f32_16x16x32_bf16 v[20:23], v[68:71], v[108:111], v[20:23]
ds_write_b128 v3, v[8:11] offset:0
s_nop 2
ds_write_b128 v3, v[12:15] offset:1024
ds_write_b128 v3, v[16:19] offset:2048
s_nop 1
ds_write_b128 v3, v[20:23] offset:3072
s_waitcnt lgkmcnt(0)
s_barrier
s_cmp_ge_u32 s9, 2
s_cbranch_scc1 WF_next
ds_read_b128 v[32:35], v123 offset:0
ds_read_b128 v[36:39], v123 offset:1024
ds_read_b128 v[40:43], v123 offset:4096
ds_read_b128 v[44:47], v123 offset:5120
ds_read_b128 v[48:51], v123 offset:8192
ds_read_b128 v[52:55], v123 offset:9216
ds_read_b128 v[56:59], v123 offset:12288
ds_read_b128 v[60:63], v123 offset:13312
s_waitcnt lgkmcnt(0)
v_pk_add_f32 v[32:33], v[32:33], v[40:41]
v_pk_add_f32 v[48:49], v[48:49], v[56:57]
v_pk_add_f32 v[32:33], v[32:33], v[48:49]
v_cvt_pk_bf16_f32 v32, v32, v33
v_and_b32 v33, 0xffff0000, v32
v_lshlrev_b32 v32, 16, v32
v_lshlrev_b32 v24, 16, v116
v_and_b32 v25, 0xffff0000, v116
v_pk_mul_f32 v[32:33], v[32:33], v[24:25]
v_cvt_pk_bf16_f32 v32, v32, v33
v_and_b32 v33, 0xffff0000, v32
v_lshlrev_b32 v32, 16, v32
v_lshlrev_b32 v24, 16, v112
v_and_b32 v25, 0xffff0000, v112
v_pk_add_f32 v[32:33], v[32:33], v[24:25]
v_cvt_pk_bf16_f32 v28, v32, v33
v_pk_add_f32 v[34:35], v[34:35], v[42:43]
v_pk_add_f32 v[50:51], v[50:51], v[58:59]
v_pk_add_f32 v[34:35], v[34:35], v[50:51]
v_cvt_pk_bf16_f32 v34, v34, v35
v_and_b32 v35, 0xffff0000, v34
v_lshlrev_b32 v34, 16, v34
v_lshlrev_b32 v24, 16, v117
v_and_b32 v25, 0xffff0000, v117
v_pk_mul_f32 v[34:35], v[34:35], v[24:25]
v_cvt_pk_bf16_f32 v34, v34, v35
v_and_b32 v35, 0xffff0000, v34
v_lshlrev_b32 v34, 16, v34
v_lshlrev_b32 v24, 16, v113
v_and_b32 v25, 0xffff0000, v113
v_pk_add_f32 v[34:35], v[34:35], v[24:25]
v_cvt_pk_bf16_f32 v29, v34, v35
v_pk_add_f32 v[36:37], v[36:37], v[44:45]
v_pk_add_f32 v[52:53], v[52:53], v[60:61]
v_pk_add_f32 v[36:37], v[36:37], v[52:53]
v_cvt_pk_bf16_f32 v36, v36, v37
v_and_b32 v37, 0xffff0000, v36
v_lshlrev_b32 v36, 16, v36
v_lshlrev_b32 v24, 16, v118
v_and_b32 v25, 0xffff0000, v118
v_pk_mul_f32 v[36:37], v[36:37], v[24:25]
v_cvt_pk_bf16_f32 v36, v36, v37
v_and_b32 v37, 0xffff0000, v36
v_lshlrev_b32 v36, 16, v36
v_lshlrev_b32 v24, 16, v114
v_and_b32 v25, 0xffff0000, v114
v_pk_add_f32 v[36:37], v[36:37], v[24:25]
v_cvt_pk_bf16_f32 v30, v36, v37
v_pk_add_f32 v[38:39], v[38:39], v[46:47]
v_pk_add_f32 v[54:55], v[54:55], v[62:63]
v_pk_add_f32 v[38:39], v[38:39], v[54:55]
v_cvt_pk_bf16_f32 v38, v38, v39
v_and_b32 v39, 0xffff0000, v38
v_lshlrev_b32 v38, 16, v38
v_lshlrev_b32 v24, 16, v119
v_and_b32 v25, 0xffff0000, v119
v_pk_mul_f32 v[38:39], v[38:39], v[24:25]
v_cvt_pk_bf16_f32 v38, v38, v39
v_and_b32 v39, 0xffff0000, v38
v_lshlrev_b32 v38, 16, v38
v_lshlrev_b32 v24, 16, v115
v_and_b32 v25, 0xffff0000, v115
v_pk_add_f32 v[38:39], v[38:39], v[24:25]
v_cvt_pk_bf16_f32 v31, v38, v39
buffer_store_dwordx4 v[28:31], v5, s[48:51], s14 offen
WF_next:
s_add_u32 s8, s8, 4
s_cmp_lt_u32 s8, 64
s_cbranch_scc1 WF_l3
WF_end:
s_endpgm
M_exit:
s_endpgm
M_rec:
s_mov_b32 s10, s3
s_mov_b32 s12, s10
s_mov_b32 s20, s28
s_mov_b32 s21, s29
s_mov_b32 s22, 1835008
s_mov_b32 s23, 0x20000
s_mov_b32 s24, s30
s_mov_b32 s25, s31
s_mov_b32 s26, 7168
s_mov_b32 s27, 0x20000
P_pass:
s_lshl_b32 s13, s12, 2
s_add_u32 s13, s13, s9
v_mov_b32 v227, s9
v_lshlrev_b32 v228, 6, v227
v_add_u32 v229, v0, v228
v_lshlrev_b32 v2, 4, v229
v_mov_b64 v[184:185], 0
v_mov_b64 v[186:187], 0
s_lshl_b32 s15, s12, 12
s_add_u32 s16, s15, 54657024
buffer_store_dwordx4 v[184:187], v2, s[4:7], s16 offen sc1
v_and_b32 v228, 15, v0
v_mov_b32 v227, 0x380
v_mul_lo_u32 v229, v228, v227
v_lshrrev_b32 v228, 4, v0
v_lshlrev_b32 v227, 4, v228
v_add_u32 v1, v229, v227
s_mul_i32 s14, s13, 14336
buffer_load_dwordx4 v[4:7], v1, s[20:23], s14 offen offset:0
buffer_load_dwordx4 v[8:11], v1, s[20:23], s14 offen offset:64
buffer_load_dwordx4 v[12:15], v1, s[20:23], s14 offen offset:128
buffer_load_dwordx4 v[16:19], v1, s[20:23], s14 offen offset:192
buffer_load_dwordx4 v[20:23], v1, s[20:23], s14 offen offset:256
buffer_load_dwordx4 v[24:27], v1, s[20:23], s14 offen offset:320
buffer_load_dwordx4 v[28:31], v1, s[20:23], s14 offen offset:384
buffer_load_dwordx4 v[32:35], v1, s[20:23], s14 offen offset:448
buffer_load_dwordx4 v[36:39], v1, s[20:23], s14 offen offset:512
buffer_load_dwordx4 v[40:43], v1, s[20:23], s14 offen offset:576
buffer_load_dwordx4 v[44:47], v1, s[20:23], s14 offen offset:640
buffer_load_dwordx4 v[48:51], v1, s[20:23], s14 offen offset:704
buffer_load_dwordx4 v[52:55], v1, s[20:23], s14 offen offset:768
buffer_load_dwordx4 v[56:59], v1, s[20:23], s14 offen offset:832
s_cmp_lt_u32 s12, 30
s_cbranch_scc1 P_nomem
v_mov_b32 v218, 30
v_sub_u32 v219, s12, v218
v_lshlrev_b32 v220, 8, v219
v_mov_b32 v217, s9
v_lshlrev_b32 v218, 6, v217
v_add_u32 v219, v0, v218
v_add_u32 v221, v220, v219
v_and_b32 v222, 15, v221
v_lshrrev_b32 v223, 2, v222
v_lshlrev_b32 v224, 1, v223
v_mov_b32 v218, 30
v_sub_u32 v220, s12, v218
v_lshlrev_b32 v219, 8, v220
v_mov_b32 v217, s9
v_lshlrev_b32 v218, 6, v217
v_add_u32 v220, v0, v218
v_add_u32 v221, v219, v220
v_and_b32 v222, 15, v221
v_and_b32 v223, 1, v222
v_add_u32 v225, v224, v223
v_mov_b32 v223, 0x1c0
v_mul_lo_u32 v226, v225, v223
v_mov_b32 v220, 30
v_sub_u32 v221, s12, v220
v_lshlrev_b32 v222, 8, v221
v_mov_b32 v219, s9
v_lshlrev_b32 v220, 6, v219
v_add_u32 v221, v0, v220
v_add_u32 v224, v222, v221
v_lshrrev_b32 v225, 4, v224
v_lshlrev_b32 v223, 4, v225
v_add_u32 v228, v226, v223
v_mov_b32 v219, 30
v_sub_u32 v220, s12, v219
v_lshlrev_b32 v222, 8, v220
v_mov_b32 v218, s9
v_lshlrev_b32 v219, 6, v218
v_add_u32 v220, v0, v219
v_add_u32 v221, v222, v220
v_and_b32 v224, 15, v221
v_lshrrev_b32 v225, 1, v224
v_and_b32 v226, 1, v225
v_lshlrev_b32 v223, 1, v226
v_add_u32 v229, v228, v223
v_lshlrev_b32 v227, 1, v229
v_mov_b32 v229, 0x40000000
v_mov_b32 v225, 30
v_sub_u32 v226, s12, v225
v_lshlrev_b32 v228, 8, v226
v_mov_b32 v224, s9
v_lshlrev_b32 v225, 6, v224
v_add_u32 v226, v0, v225
v_add_u32 v223, v228, v226
v_mov_b32 v226, 0x1c0
v_cmp_lt_u32 vcc, v223, v226
s_nop 1
v_cndmask_b32 v3, v229, v227, vcc
buffer_load_dword v188, v3, s[24:27], 0 offen offset:0
buffer_load_dword v189, v3, s[24:27], 0 offen offset:8
buffer_load_dword v190, v3, s[24:27], 0 offen offset:16
buffer_load_dword v191, v3, s[24:27], 0 offen offset:24
v_mov_b32 v225, 30
v_sub_u32 v228, s12, v225
v_lshlrev_b32 v227, 8, v228
v_mov_b32 v224, s9
v_lshlrev_b32 v225, 6, v224
v_add_u32 v228, v0, v225
v_add_u32 v229, v227, v228
v_lshlrev_b32 v223, 4, v229
v_add_u32 v226, 0x3400000, v223
v_mov_b32 v223, 0x40000000
v_mov_b32 v225, 30
v_sub_u32 v227, s12, v225
v_lshlrev_b32 v228, 8, v227
v_mov_b32 v224, s9
v_lshlrev_b32 v225, 6, v224
v_add_u32 v227, v0, v225
v_add_u32 v229, v228, v227
v_mov_b32 v227, 0x1c0
v_cmp_lt_u32 vcc, v229, v227
s_nop 1
v_cndmask_b32 v3, v223, v226, vcc
s_waitcnt vmcnt(0)
v_min_u32 v188, -2, v188
v_min_u32 v189, -2, v189
v_min_u32 v190, -2, v190
v_min_u32 v191, -2, v191
buffer_store_dwordx4 v[188:191], v3, s[4:7], 0 offen sc1
s_waitcnt vmcnt(1)
s_branch P_memok
P_nomem:
s_waitcnt vmcnt(0)
P_memok:
s_barrier
s_cmp_lg_u32 s9, 0
s_cbranch_scc1 P_zdone
v_mov_b32 v1, 1
s_mov_b64 exec, 1
buffer_atomic_add v1, off, s[48:51], 0 offset:8 sc0 sc1
s_waitcnt vmcnt(0)
s_mov_b64 exec, -1
v_readfirstlane_b32 s11, v1
s_cmp_lg_u32 s11, 31
s_cbranch_scc1 P_zdone
v_mov_b32 v1, 1
buffer_store_dword v1, off, s[48:51], 0 offset:132 sc1
P_zdone:
v_mov_b64 v[180:181], -1
v_mov_b64 v[182:183], -1
s_lshl_b32 s15, s12, 14
s_add_u32 s15, s15, 53477376
buffer_store_dwordx4 v[180:183], v2, s[4:7], s15 offen sc1
s_add_u32 s15, s15, 4096
buffer_store_dwordx4 v[180:183], v2, s[4:7], s15 offen sc1
s_add_u32 s15, s15, 4096
buffer_store_dwordx4 v[180:183], v2, s[4:7], s15 offen sc1
s_add_u32 s15, s15, 4096
buffer_store_dwordx4 v[180:183], v2, s[4:7], s15 offen sc1
s_lshl_b32 s15, s12, 12
s_add_u32 s16, s15, 53362688
s_cmp_lt_u32 s12, 28
s_cselect_b32 s16, s16, 1073741824
buffer_store_dwordx4 v[180:183], v2, s[4:7], s16 offen sc1
s_add_u32 s16, s15, 58155008
s_cmp_lt_u32 s12, 10
s_cselect_b32 s16, s16, 1073741824
buffer_store_dwordx4 v[180:183], v2, s[4:7], s16 offen sc1
s_mov_b32 s16, 54591488
s_cmp_lt_u32 s12, 16
s_cselect_b32 s16, s16, 54468608
s_add_u32 s16, s16, s15
s_cmp_ge_u32 s12, 22
s_cbranch_scc1 P_nofill
buffer_store_dwordx4 v[180:183], v2, s[4:7], s16 offen sc1
P_nofill:
v_lshlrev_b32 v64, 16, v4
v_and_b32 v65, 0xffff0000, v4
v_lshlrev_b32 v66, 16, v5
v_and_b32 v67, 0xffff0000, v5
v_lshlrev_b32 v68, 16, v6
v_and_b32 v69, 0xffff0000, v6
v_lshlrev_b32 v70, 16, v7
v_and_b32 v71, 0xffff0000, v7
v_lshlrev_b32 v72, 16, v8
v_and_b32 v73, 0xffff0000, v8
v_lshlrev_b32 v74, 16, v9
v_and_b32 v75, 0xffff0000, v9
v_lshlrev_b32 v76, 16, v10
v_and_b32 v77, 0xffff0000, v10
v_lshlrev_b32 v78, 16, v11
v_and_b32 v79, 0xffff0000, v11
v_lshlrev_b32 v80, 16, v12
v_and_b32 v81, 0xffff0000, v12
v_lshlrev_b32 v82, 16, v13
v_and_b32 v83, 0xffff0000, v13
v_lshlrev_b32 v84, 16, v14
v_and_b32 v85, 0xffff0000, v14
v_lshlrev_b32 v86, 16, v15
v_and_b32 v87, 0xffff0000, v15
v_lshlrev_b32 v88, 16, v16
v_and_b32 v89, 0xffff0000, v16
v_lshlrev_b32 v90, 16, v17
v_and_b32 v91, 0xffff0000, v17
v_lshlrev_b32 v92, 16, v18
v_and_b32 v93, 0xffff0000, v18
v_lshlrev_b32 v94, 16, v19
v_and_b32 v95, 0xffff0000, v19
v_lshlrev_b32 v96, 16, v20
v_and_b32 v97, 0xffff0000, v20
v_lshlrev_b32 v98, 16, v21
v_and_b32 v99, 0xffff0000, v21
v_lshlrev_b32 v100, 16, v22
v_and_b32 v101, 0xffff0000, v22
v_lshlrev_b32 v102, 16, v23
v_and_b32 v103, 0xffff0000, v23
v_lshlrev_b32 v104, 16, v24
v_and_b32 v105, 0xffff0000, v24
v_lshlrev_b32 v106, 16, v25
v_and_b32 v107, 0xffff0000, v25
v_lshlrev_b32 v108, 16, v26
v_and_b32 v109, 0xffff0000, v26
v_lshlrev_b32 v110, 16, v27
v_and_b32 v111, 0xffff0000, v27
v_lshlrev_b32 v112, 16, v28
v_and_b32 v113, 0xffff0000, v28
v_lshlrev_b32 v114, 16, v29
v_and_b32 v115, 0xffff0000, v29
v_lshlrev_b32 v116, 16, v30
v_and_b32 v117, 0xffff0000, v30
v_lshlrev_b32 v118, 16, v31
v_and_b32 v119, 0xffff0000, v31
v_lshlrev_b32 v120, 16, v32
v_and_b32 v121, 0xffff0000, v32
v_lshlrev_b32 v122, 16, v33
v_and_b32 v123, 0xffff0000, v33
v_lshlrev_b32 v124, 16, v34
v_and_b32 v125, 0xffff0000, v34
v_lshlrev_b32 v126, 16, v35
v_and_b32 v127, 0xffff0000, v35
v_lshlrev_b32 v128, 16, v36
v_and_b32 v129, 0xffff0000, v36
v_lshlrev_b32 v130, 16, v37
v_and_b32 v131, 0xffff0000, v37
v_lshlrev_b32 v132, 16, v38
v_and_b32 v133, 0xffff0000, v38
v_lshlrev_b32 v134, 16, v39
v_and_b32 v135, 0xffff0000, v39
v_lshlrev_b32 v136, 16, v40
v_and_b32 v137, 0xffff0000, v40
v_lshlrev_b32 v138, 16, v41
v_and_b32 v139, 0xffff0000, v41
v_lshlrev_b32 v140, 16, v42
v_and_b32 v141, 0xffff0000, v42
v_lshlrev_b32 v142, 16, v43
v_and_b32 v143, 0xffff0000, v43
v_lshlrev_b32 v144, 16, v44
v_and_b32 v145, 0xffff0000, v44
v_lshlrev_b32 v146, 16, v45
v_and_b32 v147, 0xffff0000, v45
v_lshlrev_b32 v148, 16, v46
v_and_b32 v149, 0xffff0000, v46
v_lshlrev_b32 v150, 16, v47
v_and_b32 v151, 0xffff0000, v47
v_lshlrev_b32 v152, 16, v48
v_and_b32 v153, 0xffff0000, v48
v_lshlrev_b32 v154, 16, v49
v_and_b32 v155, 0xffff0000, v49
v_lshlrev_b32 v156, 16, v50
v_and_b32 v157, 0xffff0000, v50
v_lshlrev_b32 v158, 16, v51
v_and_b32 v159, 0xffff0000, v51
v_lshlrev_b32 v160, 16, v52
v_and_b32 v161, 0xffff0000, v52
v_lshlrev_b32 v162, 16, v53
v_and_b32 v163, 0xffff0000, v53
v_lshlrev_b32 v164, 16, v54
v_and_b32 v165, 0xffff0000, v54
v_lshlrev_b32 v166, 16, v55
v_and_b32 v167, 0xffff0000, v55
v_lshlrev_b32 v168, 16, v56
v_and_b32 v169, 0xffff0000, v56
v_lshlrev_b32 v170, 16, v57
v_and_b32 v171, 0xffff0000, v57
v_lshlrev_b32 v172, 16, v58
v_and_b32 v173, 0xffff0000, v58
v_lshlrev_b32 v174, 16, v59
v_and_b32 v175, 0xffff0000, v59
v_pk_add_f32 v[180:181], v[64:65], v[66:67]
v_pk_add_f32 v[182:183], v[68:69], v[70:71]
v_pk_add_f32 v[180:181], v[180:181], v[72:73]
v_pk_add_f32 v[182:183], v[182:183], v[74:75]
v_pk_add_f32 v[180:181], v[180:181], v[76:77]
v_pk_add_f32 v[182:183], v[182:183], v[78:79]
v_pk_add_f32 v[180:181], v[180:181], v[80:81]
v_pk_add_f32 v[182:183], v[182:183], v[82:83]
v_pk_add_f32 v[180:181], v[180:181], v[84:85]
v_pk_add_f32 v[182:183], v[182:183], v[86:87]
v_pk_add_f32 v[180:181], v[180:181], v[88:89]
v_pk_add_f32 v[182:183], v[182:183], v[90:91]
v_pk_add_f32 v[180:181], v[180:181], v[92:93]
v_pk_add_f32 v[182:183], v[182:183], v[94:95]
v_pk_add_f32 v[180:181], v[180:181], v[96:97]
v_pk_add_f32 v[182:183], v[182:183], v[98:99]
v_pk_add_f32 v[180:181], v[180:181], v[100:101]
v_pk_add_f32 v[182:183], v[182:183], v[102:103]
v_pk_add_f32 v[180:181], v[180:181], v[104:105]
v_pk_add_f32 v[182:183], v[182:183], v[106:107]
v_pk_add_f32 v[180:181], v[180:181], v[108:109]
v_pk_add_f32 v[182:183], v[182:183], v[110:111]
v_pk_add_f32 v[180:181], v[180:181], v[112:113]
v_pk_add_f32 v[182:183], v[182:183], v[114:115]
v_pk_add_f32 v[180:181], v[180:181], v[116:117]
v_pk_add_f32 v[182:183], v[182:183], v[118:119]
v_pk_add_f32 v[180:181], v[180:181], v[120:121]
v_pk_add_f32 v[182:183], v[182:183], v[122:123]
v_pk_add_f32 v[180:181], v[180:181], v[124:125]
v_pk_add_f32 v[182:183], v[182:183], v[126:127]
v_pk_add_f32 v[180:181], v[180:181], v[128:129]
v_pk_add_f32 v[182:183], v[182:183], v[130:131]
v_pk_add_f32 v[180:181], v[180:181], v[132:133]
v_pk_add_f32 v[182:183], v[182:183], v[134:135]
v_pk_add_f32 v[180:181], v[180:181], v[136:137]
v_pk_add_f32 v[182:183], v[182:183], v[138:139]
v_pk_add_f32 v[180:181], v[180:181], v[140:141]
v_pk_add_f32 v[182:183], v[182:183], v[142:143]
v_pk_add_f32 v[180:181], v[180:181], v[144:145]
v_pk_add_f32 v[182:183], v[182:183], v[146:147]
v_pk_add_f32 v[180:181], v[180:181], v[148:149]
v_pk_add_f32 v[182:183], v[182:183], v[150:151]
v_pk_add_f32 v[180:181], v[180:181], v[152:153]
v_pk_add_f32 v[182:183], v[182:183], v[154:155]
v_pk_add_f32 v[180:181], v[180:181], v[156:157]
v_pk_add_f32 v[182:183], v[182:183], v[158:159]
v_pk_add_f32 v[180:181], v[180:181], v[160:161]
v_pk_add_f32 v[182:183], v[182:183], v[162:163]
v_pk_add_f32 v[180:181], v[180:181], v[164:165]
v_pk_add_f32 v[182:183], v[182:183], v[166:167]
v_pk_add_f32 v[180:181], v[180:181], v[168:169]
v_pk_add_f32 v[182:183], v[182:183], v[170:171]
v_pk_add_f32 v[180:181], v[180:181], v[172:173]
v_pk_add_f32 v[182:183], v[182:183], v[174:175]
v_pk_add_f32 v[180:181], v[180:181], v[182:183]
v_add_f32 v180, v180, v181
v_mov_b32 v181, v180
s_nop 1
v_permlane16_swap_b32 v180, v181
v_add_f32 v180, v180, v181
v_mov_b32 v181, v180
s_nop 1
v_permlane32_swap_b32 v180, v181
v_add_f32 v180, v180, v181
v_mul_f32 v180, 0x3b124925, v180
v_mov_b64 v[184:185], 0
v_mov_b64 v[186:187], 0
v_pk_add_f32 v[188:189], v[64:65], v[180:181] op_sel_hi:[1,0] neg_lo:[0,1] neg_hi:[0,1]
v_pk_fma_f32 v[184:185], v[188:189], v[188:189], v[184:185]
v_pk_add_f32 v[190:191], v[66:67], v[180:181] op_sel_hi:[1,0] neg_lo:[0,1] neg_hi:[0,1]
v_pk_fma_f32 v[186:187], v[190:191], v[190:191], v[186:187]
v_pk_add_f32 v[188:189], v[68:69], v[180:181] op_sel_hi:[1,0] neg_lo:[0,1] neg_hi:[0,1]
v_pk_fma_f32 v[184:185], v[188:189], v[188:189], v[184:185]
v_pk_add_f32 v[190:191], v[70:71], v[180:181] op_sel_hi:[1,0] neg_lo:[0,1] neg_hi:[0,1]
v_pk_fma_f32 v[186:187], v[190:191], v[190:191], v[186:187]
v_pk_add_f32 v[188:189], v[72:73], v[180:181] op_sel_hi:[1,0] neg_lo:[0,1] neg_hi:[0,1]
v_pk_fma_f32 v[184:185], v[188:189], v[188:189], v[184:185]
v_pk_add_f32 v[190:191], v[74:75], v[180:181] op_sel_hi:[1,0] neg_lo:[0,1] neg_hi:[0,1]
v_pk_fma_f32 v[186:187], v[190:191], v[190:191], v[186:187]
v_pk_add_f32 v[188:189], v[76:77], v[180:181] op_sel_hi:[1,0] neg_lo:[0,1] neg_hi:[0,1]
v_pk_fma_f32 v[184:185], v[188:189], v[188:189], v[184:185]
v_pk_add_f32 v[190:191], v[78:79], v[180:181] op_sel_hi:[1,0] neg_lo:[0,1] neg_hi:[0,1]
v_pk_fma_f32 v[186:187], v[190:191], v[190:191], v[186:187]
v_pk_add_f32 v[188:189], v[80:81], v[180:181] op_sel_hi:[1,0] neg_lo:[0,1] neg_hi:[0,1]
v_pk_fma_f32 v[184:185], v[188:189], v[188:189], v[184:185]
v_pk_add_f32 v[190:191], v[82:83], v[180:181] op_sel_hi:[1,0] neg_lo:[0,1] neg_hi:[0,1]
v_pk_fma_f32 v[186:187], v[190:191], v[190:191], v[186:187]
v_pk_add_f32 v[188:189], v[84:85], v[180:181] op_sel_hi:[1,0] neg_lo:[0,1] neg_hi:[0,1]
v_pk_fma_f32 v[184:185], v[188:189], v[188:189], v[184:185]
v_pk_add_f32 v[190:191], v[86:87], v[180:181] op_sel_hi:[1,0] neg_lo:[0,1] neg_hi:[0,1]
v_pk_fma_f32 v[186:187], v[190:191], v[190:191], v[186:187]
v_pk_add_f32 v[188:189], v[88:89], v[180:181] op_sel_hi:[1,0] neg_lo:[0,1] neg_hi:[0,1]
v_pk_fma_f32 v[184:185], v[188:189], v[188:189], v[184:185]
v_pk_add_f32 v[190:191], v[90:91], v[180:181] op_sel_hi:[1,0] neg_lo:[0,1] neg_hi:[0,1]
v_pk_fma_f32 v[186:187], v[190:191], v[190:191], v[186:187]
v_pk_add_f32 v[188:189], v[92:93], v[180:181] op_sel_hi:[1,0] neg_lo:[0,1] neg_hi:[0,1]
v_pk_fma_f32 v[184:185], v[188:189], v[188:189], v[184:185]
v_pk_add_f32 v[190:191], v[94:95], v[180:181] op_sel_hi:[1,0] neg_lo:[0,1] neg_hi:[0,1]
v_pk_fma_f32 v[186:187], v[190:191], v[190:191], v[186:187]
v_pk_add_f32 v[188:189], v[96:97], v[180:181] op_sel_hi:[1,0] neg_lo:[0,1] neg_hi:[0,1]
v_pk_fma_f32 v[184:185], v[188:189], v[188:189], v[184:185]
v_pk_add_f32 v[190:191], v[98:99], v[180:181] op_sel_hi:[1,0] neg_lo:[0,1] neg_hi:[0,1]
v_pk_fma_f32 v[186:187], v[190:191], v[190:191], v[186:187]
v_pk_add_f32 v[188:189], v[100:101], v[180:181] op_sel_hi:[1,0] neg_lo:[0,1] neg_hi:[0,1]
v_pk_fma_f32 v[184:185], v[188:189], v[188:189], v[184:185]
v_pk_add_f32 v[190:191], v[102:103], v[180:181] op_sel_hi:[1,0] neg_lo:[0,1] neg_hi:[0,1]
v_pk_fma_f32 v[186:187], v[190:191], v[190:191], v[186:187]
v_pk_add_f32 v[188:189], v[104:105], v[180:181] op_sel_hi:[1,0] neg_lo:[0,1] neg_hi:[0,1]
v_pk_fma_f32 v[184:185], v[188:189], v[188:189], v[184:185]
v_pk_add_f32 v[190:191], v[106:107], v[180:181] op_sel_hi:[1,0] neg_lo:[0,1] neg_hi:[0,1]
v_pk_fma_f32 v[186:187], v[190:191], v[190:191], v[186:187]
v_pk_add_f32 v[188:189], v[108:109], v[180:181] op_sel_hi:[1,0] neg_lo:[0,1] neg_hi:[0,1]
v_pk_fma_f32 v[184:185], v[188:189], v[188:189], v[184:185]
v_pk_add_f32 v[190:191], v[110:111], v[180:181] op_sel_hi:[1,0] neg_lo:[0,1] neg_hi:[0,1]
v_pk_fma_f32 v[186:187], v[190:191], v[190:191], v[186:187]
v_pk_add_f32 v[188:189], v[112:113], v[180:181] op_sel_hi:[1,0] neg_lo:[0,1] neg_hi:[0,1]
v_pk_fma_f32 v[184:185], v[188:189], v[188:189], v[184:185]
v_pk_add_f32 v[190:191], v[114:115], v[180:181] op_sel_hi:[1,0] neg_lo:[0,1] neg_hi:[0,1]
v_pk_fma_f32 v[186:187], v[190:191], v[190:191], v[186:187]
v_pk_add_f32 v[188:189], v[116:117], v[180:181] op_sel_hi:[1,0] neg_lo:[0,1] neg_hi:[0,1]
v_pk_fma_f32 v[184:185], v[188:189], v[188:189], v[184:185]
v_pk_add_f32 v[190:191], v[118:119], v[180:181] op_sel_hi:[1,0] neg_lo:[0,1] neg_hi:[0,1]
v_pk_fma_f32 v[186:187], v[190:191], v[190:191], v[186:187]
v_pk_add_f32 v[188:189], v[120:121], v[180:181] op_sel_hi:[1,0] neg_lo:[0,1] neg_hi:[0,1]
v_pk_fma_f32 v[184:185], v[188:189], v[188:189], v[184:185]
v_pk_add_f32 v[190:191], v[122:123], v[180:181] op_sel_hi:[1,0] neg_lo:[0,1] neg_hi:[0,1]
v_pk_fma_f32 v[186:187], v[190:191], v[190:191], v[186:187]
v_pk_add_f32 v[188:189], v[124:125], v[180:181] op_sel_hi:[1,0] neg_lo:[0,1] neg_hi:[0,1]
v_pk_fma_f32 v[184:185], v[188:189], v[188:189], v[184:185]
v_pk_add_f32 v[190:191], v[126:127], v[180:181] op_sel_hi:[1,0] neg_lo:[0,1] neg_hi:[0,1]
v_pk_fma_f32 v[186:187], v[190:191], v[190:191], v[186:187]
v_pk_add_f32 v[188:189], v[128:129], v[180:181] op_sel_hi:[1,0] neg_lo:[0,1] neg_hi:[0,1]
v_pk_fma_f32 v[184:185], v[188:189], v[188:189], v[184:185]
v_pk_add_f32 v[190:191], v[130:131], v[180:181] op_sel_hi:[1,0] neg_lo:[0,1] neg_hi:[0,1]
v_pk_fma_f32 v[186:187], v[190:191], v[190:191], v[186:187]
v_pk_add_f32 v[188:189], v[132:133], v[180:181] op_sel_hi:[1,0] neg_lo:[0,1] neg_hi:[0,1]
v_pk_fma_f32 v[184:185], v[188:189], v[188:189], v[184:185]
v_pk_add_f32 v[190:191], v[134:135], v[180:181] op_sel_hi:[1,0] neg_lo:[0,1] neg_hi:[0,1]
v_pk_fma_f32 v[186:187], v[190:191], v[190:191], v[186:187]
v_pk_add_f32 v[188:189], v[136:137], v[180:181] op_sel_hi:[1,0] neg_lo:[0,1] neg_hi:[0,1]
v_pk_fma_f32 v[184:185], v[188:189], v[188:189], v[184:185]
v_pk_add_f32 v[190:191], v[138:139], v[180:181] op_sel_hi:[1,0] neg_lo:[0,1] neg_hi:[0,1]
v_pk_fma_f32 v[186:187], v[190:191], v[190:191], v[186:187]
v_pk_add_f32 v[188:189], v[140:141], v[180:181] op_sel_hi:[1,0] neg_lo:[0,1] neg_hi:[0,1]
v_pk_fma_f32 v[184:185], v[188:189], v[188:189], v[184:185]
v_pk_add_f32 v[190:191], v[142:143], v[180:181] op_sel_hi:[1,0] neg_lo:[0,1] neg_hi:[0,1]
v_pk_fma_f32 v[186:187], v[190:191], v[190:191], v[186:187]
v_pk_add_f32 v[188:189], v[144:145], v[180:181] op_sel_hi:[1,0] neg_lo:[0,1] neg_hi:[0,1]
v_pk_fma_f32 v[184:185], v[188:189], v[188:189], v[184:185]
v_pk_add_f32 v[190:191], v[146:147], v[180:181] op_sel_hi:[1,0] neg_lo:[0,1] neg_hi:[0,1]
v_pk_fma_f32 v[186:187], v[190:191], v[190:191], v[186:187]
v_pk_add_f32 v[188:189], v[148:149], v[180:181] op_sel_hi:[1,0] neg_lo:[0,1] neg_hi:[0,1]
v_pk_fma_f32 v[184:185], v[188:189], v[188:189], v[184:185]
v_pk_add_f32 v[190:191], v[150:151], v[180:181] op_sel_hi:[1,0] neg_lo:[0,1] neg_hi:[0,1]
v_pk_fma_f32 v[186:187], v[190:191], v[190:191], v[186:187]
v_pk_add_f32 v[188:189], v[152:153], v[180:181] op_sel_hi:[1,0] neg_lo:[0,1] neg_hi:[0,1]
v_pk_fma_f32 v[184:185], v[188:189], v[188:189], v[184:185]
v_pk_add_f32 v[190:191], v[154:155], v[180:181] op_sel_hi:[1,0] neg_lo:[0,1] neg_hi:[0,1]
v_pk_fma_f32 v[186:187], v[190:191], v[190:191], v[186:187]
v_pk_add_f32 v[188:189], v[156:157], v[180:181] op_sel_hi:[1,0] neg_lo:[0,1] neg_hi:[0,1]
v_pk_fma_f32 v[184:185], v[188:189], v[188:189], v[184:185]
v_pk_add_f32 v[190:191], v[158:159], v[180:181] op_sel_hi:[1,0] neg_lo:[0,1] neg_hi:[0,1]
v_pk_fma_f32 v[186:187], v[190:191], v[190:191], v[186:187]
v_pk_add_f32 v[188:189], v[160:161], v[180:181] op_sel_hi:[1,0] neg_lo:[0,1] neg_hi:[0,1]
v_pk_fma_f32 v[184:185], v[188:189], v[188:189], v[184:185]
v_pk_add_f32 v[190:191], v[162:163], v[180:181] op_sel_hi:[1,0] neg_lo:[0,1] neg_hi:[0,1]
v_pk_fma_f32 v[186:187], v[190:191], v[190:191], v[186:187]
v_pk_add_f32 v[188:189], v[164:165], v[180:181] op_sel_hi:[1,0] neg_lo:[0,1] neg_hi:[0,1]
v_pk_fma_f32 v[184:185], v[188:189], v[188:189], v[184:185]
v_pk_add_f32 v[190:191], v[166:167], v[180:181] op_sel_hi:[1,0] neg_lo:[0,1] neg_hi:[0,1]
v_pk_fma_f32 v[186:187], v[190:191], v[190:191], v[186:187]
v_pk_add_f32 v[188:189], v[168:169], v[180:181] op_sel_hi:[1,0] neg_lo:[0,1] neg_hi:[0,1]
v_pk_fma_f32 v[184:185], v[188:189], v[188:189], v[184:185]
v_pk_add_f32 v[190:191], v[170:171], v[180:181] op_sel_hi:[1,0] neg_lo:[0,1] neg_hi:[0,1]
v_pk_fma_f32 v[186:187], v[190:191], v[190:191], v[186:187]
v_pk_add_f32 v[188:189], v[172:173], v[180:181] op_sel_hi:[1,0] neg_lo:[0,1] neg_hi:[0,1]
v_pk_fma_f32 v[184:185], v[188:189], v[188:189], v[184:185]
v_pk_add_f32 v[190:191], v[174:175], v[180:181] op_sel_hi:[1,0] neg_lo:[0,1] neg_hi:[0,1]
v_pk_fma_f32 v[186:187], v[190:191], v[190:191], v[186:187]
v_pk_add_f32 v[184:185], v[184:185], v[186:187]
v_add_f32 v184, v184, v185
v_mov_b32 v185, v184
s_nop 1
v_permlane16_swap_b32 v184, v185
v_add_f32 v184, v184, v185
v_mov_b32 v185, v184
s_nop 1
v_permlane32_swap_b32 v184, v185
v_add_f32 v184, v184, v185
v_mul_f32 v184, 0x3b124925, v184
v_cvt_pk_bf16_f32 v180, v180, v180
v_and_b32 v180, 0xffff0000, v180
v_cvt_pk_bf16_f32 v184, v184, v184
v_and_b32 v184, 0xffff0000, v184
v_add_f32 v184, 0x3727c5ac, v184
v_cvt_pk_bf16_f32 v184, v184, v184
v_and_b32 v184, 0xffff0000, v184
v_sqrt_f32 v184, v184
s_nop 0
v_cvt_pk_bf16_f32 v184, v184, v184
v_and_b32 v184, 0xffff0000, v184
v_rcp_f32 v184, v184
v_lshlrev_b32 v2, 4, v0
v_pk_add_f32 v[64:65], v[64:65], v[180:181] op_sel_hi:[1,0] neg_lo:[0,1] neg_hi:[0,1]
v_cvt_pk_bf16_f32 v64, v64, v65
v_and_b32 v65, 0xffff0000, v64
v_lshlrev_b32 v64, 16, v64
v_pk_mul_f32 v[64:65], v[64:65], v[184:185] op_sel_hi:[1,0]
v_cvt_pk_bf16_f32 v4, v64, v65
v_pk_add_f32 v[66:67], v[66:67], v[180:181] op_sel_hi:[1,0] neg_lo:[0,1] neg_hi:[0,1]
v_cvt_pk_bf16_f32 v66, v66, v67
v_and_b32 v67, 0xffff0000, v66
v_lshlrev_b32 v66, 16, v66
v_pk_mul_f32 v[66:67], v[66:67], v[184:185] op_sel_hi:[1,0]
v_cvt_pk_bf16_f32 v5, v66, v67
v_pk_add_f32 v[68:69], v[68:69], v[180:181] op_sel_hi:[1,0] neg_lo:[0,1] neg_hi:[0,1]
v_cvt_pk_bf16_f32 v68, v68, v69
v_and_b32 v69, 0xffff0000, v68
v_lshlrev_b32 v68, 16, v68
v_pk_mul_f32 v[68:69], v[68:69], v[184:185] op_sel_hi:[1,0]
v_cvt_pk_bf16_f32 v6, v68, v69
v_pk_add_f32 v[70:71], v[70:71], v[180:181] op_sel_hi:[1,0] neg_lo:[0,1] neg_hi:[0,1]
v_cvt_pk_bf16_f32 v70, v70, v71
v_and_b32 v71, 0xffff0000, v70
v_lshlrev_b32 v70, 16, v70
v_pk_mul_f32 v[70:71], v[70:71], v[184:185] op_sel_hi:[1,0]
v_cvt_pk_bf16_f32 v7, v70, v71
buffer_store_dwordx4 v[4:7], v2, s[4:7], s14 offen offset:0 sc1
v_pk_add_f32 v[72:73], v[72:73], v[180:181] op_sel_hi:[1,0] neg_lo:[0,1] neg_hi:[0,1]
v_cvt_pk_bf16_f32 v72, v72, v73
v_and_b32 v73, 0xffff0000, v72
v_lshlrev_b32 v72, 16, v72
v_pk_mul_f32 v[72:73], v[72:73], v[184:185] op_sel_hi:[1,0]
v_cvt_pk_bf16_f32 v8, v72, v73
v_pk_add_f32 v[74:75], v[74:75], v[180:181] op_sel_hi:[1,0] neg_lo:[0,1] neg_hi:[0,1]
v_cvt_pk_bf16_f32 v74, v74, v75
v_and_b32 v75, 0xffff0000, v74
v_lshlrev_b32 v74, 16, v74
v_pk_mul_f32 v[74:75], v[74:75], v[184:185] op_sel_hi:[1,0]
v_cvt_pk_bf16_f32 v9, v74, v75
v_pk_add_f32 v[76:77], v[76:77], v[180:181] op_sel_hi:[1,0] neg_lo:[0,1] neg_hi:[0,1]
v_cvt_pk_bf16_f32 v76, v76, v77
v_and_b32 v77, 0xffff0000, v76
v_lshlrev_b32 v76, 16, v76
v_pk_mul_f32 v[76:77], v[76:77], v[184:185] op_sel_hi:[1,0]
v_cvt_pk_bf16_f32 v10, v76, v77
v_pk_add_f32 v[78:79], v[78:79], v[180:181] op_sel_hi:[1,0] neg_lo:[0,1] neg_hi:[0,1]
v_cvt_pk_bf16_f32 v78, v78, v79
v_and_b32 v79, 0xffff0000, v78
v_lshlrev_b32 v78, 16, v78
v_pk_mul_f32 v[78:79], v[78:79], v[184:185] op_sel_hi:[1,0]
v_cvt_pk_bf16_f32 v11, v78, v79
buffer_store_dwordx4 v[8:11], v2, s[4:7], s14 offen offset:1024 sc1
v_pk_add_f32 v[80:81], v[80:81], v[180:181] op_sel_hi:[1,0] neg_lo:[0,1] neg_hi:[0,1]
v_cvt_pk_bf16_f32 v80, v80, v81
v_and_b32 v81, 0xffff0000, v80
v_lshlrev_b32 v80, 16, v80
v_pk_mul_f32 v[80:81], v[80:81], v[184:185] op_sel_hi:[1,0]
v_cvt_pk_bf16_f32 v12, v80, v81
v_pk_add_f32 v[82:83], v[82:83], v[180:181] op_sel_hi:[1,0] neg_lo:[0,1] neg_hi:[0,1]
v_cvt_pk_bf16_f32 v82, v82, v83
v_and_b32 v83, 0xffff0000, v82
v_lshlrev_b32 v82, 16, v82
v_pk_mul_f32 v[82:83], v[82:83], v[184:185] op_sel_hi:[1,0]
v_cvt_pk_bf16_f32 v13, v82, v83
v_pk_add_f32 v[84:85], v[84:85], v[180:181] op_sel_hi:[1,0] neg_lo:[0,1] neg_hi:[0,1]
v_cvt_pk_bf16_f32 v84, v84, v85
v_and_b32 v85, 0xffff0000, v84
v_lshlrev_b32 v84, 16, v84
v_pk_mul_f32 v[84:85], v[84:85], v[184:185] op_sel_hi:[1,0]
v_cvt_pk_bf16_f32 v14, v84, v85
v_pk_add_f32 v[86:87], v[86:87], v[180:181] op_sel_hi:[1,0] neg_lo:[0,1] neg_hi:[0,1]
v_cvt_pk_bf16_f32 v86, v86, v87
v_and_b32 v87, 0xffff0000, v86
v_lshlrev_b32 v86, 16, v86
v_pk_mul_f32 v[86:87], v[86:87], v[184:185] op_sel_hi:[1,0]
v_cvt_pk_bf16_f32 v15, v86, v87
buffer_store_dwordx4 v[12:15], v2, s[4:7], s14 offen offset:2048 sc1
v_pk_add_f32 v[88:89], v[88:89], v[180:181] op_sel_hi:[1,0] neg_lo:[0,1] neg_hi:[0,1]
v_cvt_pk_bf16_f32 v88, v88, v89
v_and_b32 v89, 0xffff0000, v88
v_lshlrev_b32 v88, 16, v88
v_pk_mul_f32 v[88:89], v[88:89], v[184:185] op_sel_hi:[1,0]
v_cvt_pk_bf16_f32 v16, v88, v89
v_pk_add_f32 v[90:91], v[90:91], v[180:181] op_sel_hi:[1,0] neg_lo:[0,1] neg_hi:[0,1]
v_cvt_pk_bf16_f32 v90, v90, v91
v_and_b32 v91, 0xffff0000, v90
v_lshlrev_b32 v90, 16, v90
v_pk_mul_f32 v[90:91], v[90:91], v[184:185] op_sel_hi:[1,0]
v_cvt_pk_bf16_f32 v17, v90, v91
v_pk_add_f32 v[92:93], v[92:93], v[180:181] op_sel_hi:[1,0] neg_lo:[0,1] neg_hi:[0,1]
v_cvt_pk_bf16_f32 v92, v92, v93
v_and_b32 v93, 0xffff0000, v92
v_lshlrev_b32 v92, 16, v92
v_pk_mul_f32 v[92:93], v[92:93], v[184:185] op_sel_hi:[1,0]
v_cvt_pk_bf16_f32 v18, v92, v93
v_pk_add_f32 v[94:95], v[94:95], v[180:181] op_sel_hi:[1,0] neg_lo:[0,1] neg_hi:[0,1]
v_cvt_pk_bf16_f32 v94, v94, v95
v_and_b32 v95, 0xffff0000, v94
v_lshlrev_b32 v94, 16, v94
v_pk_mul_f32 v[94:95], v[94:95], v[184:185] op_sel_hi:[1,0]
v_cvt_pk_bf16_f32 v19, v94, v95
buffer_store_dwordx4 v[16:19], v2, s[4:7], s14 offen offset:3072 sc1
v_pk_add_f32 v[96:97], v[96:97], v[180:181] op_sel_hi:[1,0] neg_lo:[0,1] neg_hi:[0,1]
v_cvt_pk_bf16_f32 v96, v96, v97
v_and_b32 v97, 0xffff0000, v96
v_lshlrev_b32 v96, 16, v96
v_pk_mul_f32 v[96:97], v[96:97], v[184:185] op_sel_hi:[1,0]
v_cvt_pk_bf16_f32 v20, v96, v97
v_pk_add_f32 v[98:99], v[98:99], v[180:181] op_sel_hi:[1,0] neg_lo:[0,1] neg_hi:[0,1]
v_cvt_pk_bf16_f32 v98, v98, v99
v_and_b32 v99, 0xffff0000, v98
v_lshlrev_b32 v98, 16, v98
v_pk_mul_f32 v[98:99], v[98:99], v[184:185] op_sel_hi:[1,0]
v_cvt_pk_bf16_f32 v21, v98, v99
v_pk_add_f32 v[100:101], v[100:101], v[180:181] op_sel_hi:[1,0] neg_lo:[0,1] neg_hi:[0,1]
v_cvt_pk_bf16_f32 v100, v100, v101
v_and_b32 v101, 0xffff0000, v100
v_lshlrev_b32 v100, 16, v100
v_pk_mul_f32 v[100:101], v[100:101], v[184:185] op_sel_hi:[1,0]
v_cvt_pk_bf16_f32 v22, v100, v101
v_pk_add_f32 v[102:103], v[102:103], v[180:181] op_sel_hi:[1,0] neg_lo:[0,1] neg_hi:[0,1]
v_cvt_pk_bf16_f32 v102, v102, v103
v_and_b32 v103, 0xffff0000, v102
v_lshlrev_b32 v102, 16, v102
v_pk_mul_f32 v[102:103], v[102:103], v[184:185] op_sel_hi:[1,0]
v_cvt_pk_bf16_f32 v23, v102, v103
s_add_u32 s14, s14, 4096
buffer_store_dwordx4 v[20:23], v2, s[4:7], s14 offen offset:0 sc1
v_pk_add_f32 v[104:105], v[104:105], v[180:181] op_sel_hi:[1,0] neg_lo:[0,1] neg_hi:[0,1]
v_cvt_pk_bf16_f32 v104, v104, v105
v_and_b32 v105, 0xffff0000, v104
v_lshlrev_b32 v104, 16, v104
v_pk_mul_f32 v[104:105], v[104:105], v[184:185] op_sel_hi:[1,0]
v_cvt_pk_bf16_f32 v24, v104, v105
v_pk_add_f32 v[106:107], v[106:107], v[180:181] op_sel_hi:[1,0] neg_lo:[0,1] neg_hi:[0,1]
v_cvt_pk_bf16_f32 v106, v106, v107
v_and_b32 v107, 0xffff0000, v106
v_lshlrev_b32 v106, 16, v106
v_pk_mul_f32 v[106:107], v[106:107], v[184:185] op_sel_hi:[1,0]
v_cvt_pk_bf16_f32 v25, v106, v107
v_pk_add_f32 v[108:109], v[108:109], v[180:181] op_sel_hi:[1,0] neg_lo:[0,1] neg_hi:[0,1]
v_cvt_pk_bf16_f32 v108, v108, v109
v_and_b32 v109, 0xffff0000, v108
v_lshlrev_b32 v108, 16, v108
v_pk_mul_f32 v[108:109], v[108:109], v[184:185] op_sel_hi:[1,0]
v_cvt_pk_bf16_f32 v26, v108, v109
v_pk_add_f32 v[110:111], v[110:111], v[180:181] op_sel_hi:[1,0] neg_lo:[0,1] neg_hi:[0,1]
v_cvt_pk_bf16_f32 v110, v110, v111
v_and_b32 v111, 0xffff0000, v110
v_lshlrev_b32 v110, 16, v110
v_pk_mul_f32 v[110:111], v[110:111], v[184:185] op_sel_hi:[1,0]
v_cvt_pk_bf16_f32 v27, v110, v111
buffer_store_dwordx4 v[24:27], v2, s[4:7], s14 offen offset:1024 sc1
v_pk_add_f32 v[112:113], v[112:113], v[180:181] op_sel_hi:[1,0] neg_lo:[0,1] neg_hi:[0,1]
v_cvt_pk_bf16_f32 v112, v112, v113
v_and_b32 v113, 0xffff0000, v112
v_lshlrev_b32 v112, 16, v112
v_pk_mul_f32 v[112:113], v[112:113], v[184:185] op_sel_hi:[1,0]
v_cvt_pk_bf16_f32 v28, v112, v113
v_pk_add_f32 v[114:115], v[114:115], v[180:181] op_sel_hi:[1,0] neg_lo:[0,1] neg_hi:[0,1]
v_cvt_pk_bf16_f32 v114, v114, v115
v_and_b32 v115, 0xffff0000, v114
v_lshlrev_b32 v114, 16, v114
v_pk_mul_f32 v[114:115], v[114:115], v[184:185] op_sel_hi:[1,0]
v_cvt_pk_bf16_f32 v29, v114, v115
v_pk_add_f32 v[116:117], v[116:117], v[180:181] op_sel_hi:[1,0] neg_lo:[0,1] neg_hi:[0,1]
v_cvt_pk_bf16_f32 v116, v116, v117
v_and_b32 v117, 0xffff0000, v116
v_lshlrev_b32 v116, 16, v116
v_pk_mul_f32 v[116:117], v[116:117], v[184:185] op_sel_hi:[1,0]
v_cvt_pk_bf16_f32 v30, v116, v117
v_pk_add_f32 v[118:119], v[118:119], v[180:181] op_sel_hi:[1,0] neg_lo:[0,1] neg_hi:[0,1]
v_cvt_pk_bf16_f32 v118, v118, v119
v_and_b32 v119, 0xffff0000, v118
v_lshlrev_b32 v118, 16, v118
v_pk_mul_f32 v[118:119], v[118:119], v[184:185] op_sel_hi:[1,0]
v_cvt_pk_bf16_f32 v31, v118, v119
buffer_store_dwordx4 v[28:31], v2, s[4:7], s14 offen offset:2048 sc1
v_pk_add_f32 v[120:121], v[120:121], v[180:181] op_sel_hi:[1,0] neg_lo:[0,1] neg_hi:[0,1]
v_cvt_pk_bf16_f32 v120, v120, v121
v_and_b32 v121, 0xffff0000, v120
v_lshlrev_b32 v120, 16, v120
v_pk_mul_f32 v[120:121], v[120:121], v[184:185] op_sel_hi:[1,0]
v_cvt_pk_bf16_f32 v32, v120, v121
v_pk_add_f32 v[122:123], v[122:123], v[180:181] op_sel_hi:[1,0] neg_lo:[0,1] neg_hi:[0,1]
v_cvt_pk_bf16_f32 v122, v122, v123
v_and_b32 v123, 0xffff0000, v122
v_lshlrev_b32 v122, 16, v122
v_pk_mul_f32 v[122:123], v[122:123], v[184:185] op_sel_hi:[1,0]
v_cvt_pk_bf16_f32 v33, v122, v123
v_pk_add_f32 v[124:125], v[124:125], v[180:181] op_sel_hi:[1,0] neg_lo:[0,1] neg_hi:[0,1]
v_cvt_pk_bf16_f32 v124, v124, v125
v_and_b32 v125, 0xffff0000, v124
v_lshlrev_b32 v124, 16, v124
v_pk_mul_f32 v[124:125], v[124:125], v[184:185] op_sel_hi:[1,0]
v_cvt_pk_bf16_f32 v34, v124, v125
v_pk_add_f32 v[126:127], v[126:127], v[180:181] op_sel_hi:[1,0] neg_lo:[0,1] neg_hi:[0,1]
v_cvt_pk_bf16_f32 v126, v126, v127
v_and_b32 v127, 0xffff0000, v126
v_lshlrev_b32 v126, 16, v126
v_pk_mul_f32 v[126:127], v[126:127], v[184:185] op_sel_hi:[1,0]
v_cvt_pk_bf16_f32 v35, v126, v127
buffer_store_dwordx4 v[32:35], v2, s[4:7], s14 offen offset:3072 sc1
v_pk_add_f32 v[128:129], v[128:129], v[180:181] op_sel_hi:[1,0] neg_lo:[0,1] neg_hi:[0,1]
v_cvt_pk_bf16_f32 v128, v128, v129
v_and_b32 v129, 0xffff0000, v128
v_lshlrev_b32 v128, 16, v128
v_pk_mul_f32 v[128:129], v[128:129], v[184:185] op_sel_hi:[1,0]
v_cvt_pk_bf16_f32 v36, v128, v129
v_pk_add_f32 v[130:131], v[130:131], v[180:181] op_sel_hi:[1,0] neg_lo:[0,1] neg_hi:[0,1]
v_cvt_pk_bf16_f32 v130, v130, v131
v_and_b32 v131, 0xffff0000, v130
v_lshlrev_b32 v130, 16, v130
v_pk_mul_f32 v[130:131], v[130:131], v[184:185] op_sel_hi:[1,0]
v_cvt_pk_bf16_f32 v37, v130, v131
v_pk_add_f32 v[132:133], v[132:133], v[180:181] op_sel_hi:[1,0] neg_lo:[0,1] neg_hi:[0,1]
v_cvt_pk_bf16_f32 v132, v132, v133
v_and_b32 v133, 0xffff0000, v132
v_lshlrev_b32 v132, 16, v132
v_pk_mul_f32 v[132:133], v[132:133], v[184:185] op_sel_hi:[1,0]
v_cvt_pk_bf16_f32 v38, v132, v133
v_pk_add_f32 v[134:135], v[134:135], v[180:181] op_sel_hi:[1,0] neg_lo:[0,1] neg_hi:[0,1]
v_cvt_pk_bf16_f32 v134, v134, v135
v_and_b32 v135, 0xffff0000, v134
v_lshlrev_b32 v134, 16, v134
v_pk_mul_f32 v[134:135], v[134:135], v[184:185] op_sel_hi:[1,0]
v_cvt_pk_bf16_f32 v39, v134, v135
s_add_u32 s14, s14, 4096
buffer_store_dwordx4 v[36:39], v2, s[4:7], s14 offen offset:0 sc1
v_pk_add_f32 v[136:137], v[136:137], v[180:181] op_sel_hi:[1,0] neg_lo:[0,1] neg_hi:[0,1]
v_cvt_pk_bf16_f32 v136, v136, v137
v_and_b32 v137, 0xffff0000, v136
v_lshlrev_b32 v136, 16, v136
v_pk_mul_f32 v[136:137], v[136:137], v[184:185] op_sel_hi:[1,0]
v_cvt_pk_bf16_f32 v40, v136, v137
v_pk_add_f32 v[138:139], v[138:139], v[180:181] op_sel_hi:[1,0] neg_lo:[0,1] neg_hi:[0,1]
v_cvt_pk_bf16_f32 v138, v138, v139
v_and_b32 v139, 0xffff0000, v138
v_lshlrev_b32 v138, 16, v138
v_pk_mul_f32 v[138:139], v[138:139], v[184:185] op_sel_hi:[1,0]
v_cvt_pk_bf16_f32 v41, v138, v139
v_pk_add_f32 v[140:141], v[140:141], v[180:181] op_sel_hi:[1,0] neg_lo:[0,1] neg_hi:[0,1]
v_cvt_pk_bf16_f32 v140, v140, v141
v_and_b32 v141, 0xffff0000, v140
v_lshlrev_b32 v140, 16, v140
v_pk_mul_f32 v[140:141], v[140:141], v[184:185] op_sel_hi:[1,0]
v_cvt_pk_bf16_f32 v42, v140, v141
v_pk_add_f32 v[142:143], v[142:143], v[180:181] op_sel_hi:[1,0] neg_lo:[0,1] neg_hi:[0,1]
v_cvt_pk_bf16_f32 v142, v142, v143
v_and_b32 v143, 0xffff0000, v142
v_lshlrev_b32 v142, 16, v142
v_pk_mul_f32 v[142:143], v[142:143], v[184:185] op_sel_hi:[1,0]
v_cvt_pk_bf16_f32 v43, v142, v143
buffer_store_dwordx4 v[40:43], v2, s[4:7], s14 offen offset:1024 sc1
v_pk_add_f32 v[144:145], v[144:145], v[180:181] op_sel_hi:[1,0] neg_lo:[0,1] neg_hi:[0,1]
v_cvt_pk_bf16_f32 v144, v144, v145
v_and_b32 v145, 0xffff0000, v144
v_lshlrev_b32 v144, 16, v144
v_pk_mul_f32 v[144:145], v[144:145], v[184:185] op_sel_hi:[1,0]
v_cvt_pk_bf16_f32 v44, v144, v145
v_pk_add_f32 v[146:147], v[146:147], v[180:181] op_sel_hi:[1,0] neg_lo:[0,1] neg_hi:[0,1]
v_cvt_pk_bf16_f32 v146, v146, v147
v_and_b32 v147, 0xffff0000, v146
v_lshlrev_b32 v146, 16, v146
v_pk_mul_f32 v[146:147], v[146:147], v[184:185] op_sel_hi:[1,0]
v_cvt_pk_bf16_f32 v45, v146, v147
v_pk_add_f32 v[148:149], v[148:149], v[180:181] op_sel_hi:[1,0] neg_lo:[0,1] neg_hi:[0,1]
v_cvt_pk_bf16_f32 v148, v148, v149
v_and_b32 v149, 0xffff0000, v148
v_lshlrev_b32 v148, 16, v148
v_pk_mul_f32 v[148:149], v[148:149], v[184:185] op_sel_hi:[1,0]
v_cvt_pk_bf16_f32 v46, v148, v149
v_pk_add_f32 v[150:151], v[150:151], v[180:181] op_sel_hi:[1,0] neg_lo:[0,1] neg_hi:[0,1]
v_cvt_pk_bf16_f32 v150, v150, v151
v_and_b32 v151, 0xffff0000, v150
v_lshlrev_b32 v150, 16, v150
v_pk_mul_f32 v[150:151], v[150:151], v[184:185] op_sel_hi:[1,0]
v_cvt_pk_bf16_f32 v47, v150, v151
buffer_store_dwordx4 v[44:47], v2, s[4:7], s14 offen offset:2048 sc1
v_pk_add_f32 v[152:153], v[152:153], v[180:181] op_sel_hi:[1,0] neg_lo:[0,1] neg_hi:[0,1]
v_cvt_pk_bf16_f32 v152, v152, v153
v_and_b32 v153, 0xffff0000, v152
v_lshlrev_b32 v152, 16, v152
v_pk_mul_f32 v[152:153], v[152:153], v[184:185] op_sel_hi:[1,0]
v_cvt_pk_bf16_f32 v48, v152, v153
v_pk_add_f32 v[154:155], v[154:155], v[180:181] op_sel_hi:[1,0] neg_lo:[0,1] neg_hi:[0,1]
v_cvt_pk_bf16_f32 v154, v154, v155
v_and_b32 v155, 0xffff0000, v154
v_lshlrev_b32 v154, 16, v154
v_pk_mul_f32 v[154:155], v[154:155], v[184:185] op_sel_hi:[1,0]
v_cvt_pk_bf16_f32 v49, v154, v155
v_pk_add_f32 v[156:157], v[156:157], v[180:181] op_sel_hi:[1,0] neg_lo:[0,1] neg_hi:[0,1]
v_cvt_pk_bf16_f32 v156, v156, v157
v_and_b32 v157, 0xffff0000, v156
v_lshlrev_b32 v156, 16, v156
v_pk_mul_f32 v[156:157], v[156:157], v[184:185] op_sel_hi:[1,0]
v_cvt_pk_bf16_f32 v50, v156, v157
v_pk_add_f32 v[158:159], v[158:159], v[180:181] op_sel_hi:[1,0] neg_lo:[0,1] neg_hi:[0,1]
v_cvt_pk_bf16_f32 v158, v158, v159
v_and_b32 v159, 0xffff0000, v158
v_lshlrev_b32 v158, 16, v158
v_pk_mul_f32 v[158:159], v[158:159], v[184:185] op_sel_hi:[1,0]
v_cvt_pk_bf16_f32 v51, v158, v159
buffer_store_dwordx4 v[48:51], v2, s[4:7], s14 offen offset:3072 sc1
v_pk_add_f32 v[160:161], v[160:161], v[180:181] op_sel_hi:[1,0] neg_lo:[0,1] neg_hi:[0,1]
v_cvt_pk_bf16_f32 v160, v160, v161
v_and_b32 v161, 0xffff0000, v160
v_lshlrev_b32 v160, 16, v160
v_pk_mul_f32 v[160:161], v[160:161], v[184:185] op_sel_hi:[1,0]
v_cvt_pk_bf16_f32 v52, v160, v161
v_pk_add_f32 v[162:163], v[162:163], v[180:181] op_sel_hi:[1,0] neg_lo:[0,1] neg_hi:[0,1]
v_cvt_pk_bf16_f32 v162, v162, v163
v_and_b32 v163, 0xffff0000, v162
v_lshlrev_b32 v162, 16, v162
v_pk_mul_f32 v[162:163], v[162:163], v[184:185] op_sel_hi:[1,0]
v_cvt_pk_bf16_f32 v53, v162, v163
v_pk_add_f32 v[164:165], v[164:165], v[180:181] op_sel_hi:[1,0] neg_lo:[0,1] neg_hi:[0,1]
v_cvt_pk_bf16_f32 v164, v164, v165
v_and_b32 v165, 0xffff0000, v164
v_lshlrev_b32 v164, 16, v164
v_pk_mul_f32 v[164:165], v[164:165], v[184:185] op_sel_hi:[1,0]
v_cvt_pk_bf16_f32 v54, v164, v165
v_pk_add_f32 v[166:167], v[166:167], v[180:181] op_sel_hi:[1,0] neg_lo:[0,1] neg_hi:[0,1]
v_cvt_pk_bf16_f32 v166, v166, v167
v_and_b32 v167, 0xffff0000, v166
v_lshlrev_b32 v166, 16, v166
v_pk_mul_f32 v[166:167], v[166:167], v[184:185] op_sel_hi:[1,0]
v_cvt_pk_bf16_f32 v55, v166, v167
s_add_u32 s14, s14, 4096
buffer_store_dwordx4 v[52:55], v2, s[4:7], s14 offen offset:0 sc1
v_pk_add_f32 v[168:169], v[168:169], v[180:181] op_sel_hi:[1,0] neg_lo:[0,1] neg_hi:[0,1]
v_cvt_pk_bf16_f32 v168, v168, v169
v_and_b32 v169, 0xffff0000, v168
v_lshlrev_b32 v168, 16, v168
v_pk_mul_f32 v[168:169], v[168:169], v[184:185] op_sel_hi:[1,0]
v_cvt_pk_bf16_f32 v56, v168, v169
v_pk_add_f32 v[170:171], v[170:171], v[180:181] op_sel_hi:[1,0] neg_lo:[0,1] neg_hi:[0,1]
v_cvt_pk_bf16_f32 v170, v170, v171
v_and_b32 v171, 0xffff0000, v170
v_lshlrev_b32 v170, 16, v170
v_pk_mul_f32 v[170:171], v[170:171], v[184:185] op_sel_hi:[1,0]
v_cvt_pk_bf16_f32 v57, v170, v171
v_pk_add_f32 v[172:173], v[172:173], v[180:181] op_sel_hi:[1,0] neg_lo:[0,1] neg_hi:[0,1]
v_cvt_pk_bf16_f32 v172, v172, v173
v_and_b32 v173, 0xffff0000, v172
v_lshlrev_b32 v172, 16, v172
v_pk_mul_f32 v[172:173], v[172:173], v[184:185] op_sel_hi:[1,0]
v_cvt_pk_bf16_f32 v58, v172, v173
v_pk_add_f32 v[174:175], v[174:175], v[180:181] op_sel_hi:[1,0] neg_lo:[0,1] neg_hi:[0,1]
v_cvt_pk_bf16_f32 v174, v174, v175
v_and_b32 v175, 0xffff0000, v174
v_lshlrev_b32 v174, 16, v174
v_pk_mul_f32 v[174:175], v[174:175], v[184:185] op_sel_hi:[1,0]
v_cvt_pk_bf16_f32 v59, v174, v175
buffer_store_dwordx4 v[56:59], v2, s[4:7], s14 offen offset:1024 sc1
s_waitcnt vmcnt(0)
s_barrier
s_cmp_lg_u32 s9, 0
s_cbranch_scc1 P_xdone
s_mov_b32 s19, 0x40000
P_zr2:
buffer_load_dword v1, off, s[48:51], 0 offset:132 sc1
s_sub_u32 s19, s19, 1
s_cbranch_scc1 R_exit
s_waitcnt vmcnt(0)
v_cmp_eq_u32 vcc, 0, v1
s_cbranch_vccnz P_zr2
s_mov_b32 s19, 54779904
v_mov_b32 v1, 1
s_mov_b64 exec, 1
buffer_atomic_add v1, off, s[4:7], s19 sc1
s_mov_b64 exec, -1
P_xdone:
M_prep:
v_mov_b32 v2, 0x27c00
s_cmp_lg_u32 s9, 0
s_cbranch_scc1 RM_ss
v_and_b32 v4, 7, v0
v_lshlrev_b32 v4, 5, v4
s_mov_b32 s19, 0x40000
RM_cnt:
buffer_load_dword v3, v4, s[48:51], 0 offen sc1
s_sub_u32 s19, s19, 1
s_cbranch_scc1 R_exit
s_waitcnt vmcnt(0)
v_readlane_b32 s47, v3, 0
s_mov_b32 s46, s47
v_readlane_b32 s11, v3, 1
s_add_u32 s46, s46, s11
v_readlane_b32 s11, v3, 2
s_add_u32 s46, s46, s11
v_readlane_b32 s11, v3, 3
s_add_u32 s46, s46, s11
v_readlane_b32 s11, v3, 4
s_add_u32 s46, s46, s11
v_readlane_b32 s11, v3, 5
s_add_u32 s46, s46, s11
v_readlane_b32 s11, v3, 6
s_add_u32 s46, s46, s11
v_readlane_b32 s11, v3, 7
s_add_u32 s46, s46, s11
s_mov_b32 s30, 0
s_cmp_ge_u32 s47, 32
s_cbranch_scc1 RM_md
s_mov_b32 s30, 1
s_cmp_ge_u32 s46, 256
s_cbranch_scc1 RM_md
s_branch RM_cnt
RM_md:
v_mov_b32 v3, s30
ds_write_b32 v2, v3
s_waitcnt lgkmcnt(0)
RM_ss:
s_barrier
ds_read_b32 v3, v2
s_waitcnt lgkmcnt(0)
v_readfirstlane_b32 s30, v3
s_and_b32 s10, s3, 15
s_cmp_ge_u32 s3, 16
s_cbranch_scc1 M_B
v_and_b32 v0, 63, v0
v_mov_b32 v29, 0x44444444
v_mov_b32 v28, 0xeeeeeeee
v_and_b32 v27, 2, v0
v_mov_b32 v26, 1
v_cmp_lt_u32 vcc, v27, v26
s_nop 1
v_cndmask_b32 v119, v28, v29, vcc
v_lshlrev_b32 v118, 4, v0
s_add_u32 s34, s9, s10
s_add_u32 s34, s34, 0
s_and_b32 s34, s34, 3
s_lshl_b32 s12, s34, 10
s_add_u32 s34, s9, s10
s_add_u32 s34, s34, 1
s_and_b32 s34, s34, 3
s_lshl_b32 s13, s34, 10
s_add_u32 s34, s9, s10
s_add_u32 s34, s34, 2
s_and_b32 s34, s34, 3
s_lshl_b32 s14, s34, 10
s_add_u32 s34, s9, s10
s_add_u32 s34, s34, 3
s_and_b32 s34, s34, 3
s_lshl_b32 s15, s34, 10
s_movk_i32 s16, 4096
s_movk_i32 s17, 5120
s_movk_i32 s18, 6144
v_lshlrev_b32 v26, 4, v0
v_add_u32 v111, 0x20000, v26
v_add_u32 v115, s12, v111
v_add_u32 v114, s13, v111
v_add_u32 v113, s14, v111
v_add_u32 v112, s15, v111
s_lshl_b32 s29, s9, 10
s_add_u32 s29, s29, 4096
v_lshrrev_b32 v22, 4, v0
v_lshrrev_b32 v23, 1, v22
v_lshlrev_b32 v24, 4, v23
v_and_b32 v20, 15, v0
v_and_b32 v21, 7, v20
v_lshrrev_b32 v22, 1, v21
v_lshlrev_b32 v23, 2, v22
v_add_u32 v25, v24, v23
v_and_b32 v22, 15, v0
v_and_b32 v24, 7, v22
v_and_b32 v23, 1, v24
v_add_u32 v29, v25, v23
v_lshlrev_b32 v28, 4, v29
v_add_u32 v27, 0x20000, v28
v_lshrrev_b32 v23, 4, v0
v_and_b32 v29, 1, v23
v_lshlrev_b32 v28, 3, v29
v_add_u32 v26, v27, v28
v_mov_b32 v25, s9
v_lshrrev_b32 v23, 1, v25
v_mov_b32 v25, 7
v_mul_lo_u32 v29, v23, v25
v_mov_b32 v24, 1
v_and_b32 v23, s9, v24
v_lshlrev_b32 v25, 2, v23
v_add_u32 v27, v29, v25
v_lshlrev_b32 v28, 9, v27
v_add_u32 v108, v26, v28
v_lshrrev_b32 v22, 4, v0
v_lshrrev_b32 v24, 1, v22
v_lshlrev_b32 v23, 4, v24
v_and_b32 v20, 15, v0
v_and_b32 v21, 7, v20
v_lshrrev_b32 v22, 1, v21
v_lshlrev_b32 v24, 2, v22
v_add_u32 v29, v23, v24
v_and_b32 v22, 15, v0
v_and_b32 v23, 7, v22
v_and_b32 v24, 1, v23
v_add_u32 v25, v29, v24
v_lshlrev_b32 v27, 4, v25
v_add_u32 v26, 0x20000, v27
v_lshrrev_b32 v24, 4, v0
v_and_b32 v25, 1, v24
v_lshlrev_b32 v27, 3, v25
v_add_u32 v28, v26, v27
v_mov_b32 v29, s9
v_lshrrev_b32 v24, 1, v29
v_mov_b32 v29, 7
v_mul_lo_u32 v25, v24, v29
v_add_u32 v26, 3, v25
v_lshlrev_b32 v27, 9, v26
v_add_u32 v107, v28, v27
v_lshrrev_b32 v21, 4, v0
v_lshrrev_b32 v22, 1, v21
v_lshlrev_b32 v23, 4, v22
v_and_b32 v19, 15, v0
v_and_b32 v20, 7, v19
v_lshrrev_b32 v21, 1, v20
v_lshlrev_b32 v22, 2, v21
v_add_u32 v24, v23, v22
v_and_b32 v21, 15, v0
v_and_b32 v23, 7, v21
v_and_b32 v22, 1, v23
v_add_u32 v29, v24, v22
v_lshlrev_b32 v25, 4, v29
v_add_u32 v26, 0x20000, v25
v_lshrrev_b32 v22, 4, v0
v_and_b32 v29, 1, v22
v_lshlrev_b32 v25, 3, v29
v_add_u32 v28, v26, v25
v_mov_b32 v24, s9
v_lshrrev_b32 v22, 1, v24
v_mov_b32 v24, 7
v_mul_lo_u32 v29, v22, v24
v_mov_b32 v23, 1
v_and_b32 v22, s9, v23
v_lshlrev_b32 v24, 2, v22
v_add_u32 v26, v29, v24
v_lshlrev_b32 v25, 9, v26
v_add_u32 v27, v28, v25
v_add_u32 v99, 0x400, v27
v_lshrrev_b32 v24, 4, v0
v_lshlrev_b32 v26, 4, v24
v_and_b32 v29, 15, v0
v_and_b32 v24, 12, v29
v_add_u32 v28, v26, v24
v_and_b32 v29, 15, v0
v_and_b32 v26, 1, v29
v_lshlrev_b32 v24, 1, v26
v_add_u32 v25, v28, v24
v_and_b32 v26, 15, v0
v_lshrrev_b32 v28, 1, v26
v_and_b32 v24, 1, v28
v_add_u32 v27, v25, v24
v_lshlrev_b32 v106, 4, v27
v_mov_b32 v24, 0
v_mul_lo_u32 v27, v0, v24
v_add_u32 v98, 0x10fc0, v27
v_mov_b32 v22, s9
v_lshlrev_b32 v29, 12, v22
v_add_u32 v26, 0x10000, v29
v_and_b32 v22, 3, v0
v_lshlrev_b32 v29, 6, v22
v_add_u32 v28, v26, v29
v_lshrrev_b32 v22, 4, v0
v_and_b32 v26, 1, v22
v_lshlrev_b32 v29, 5, v26
v_add_u32 v25, v28, v29
v_lshrrev_b32 v22, 2, v0
v_and_b32 v26, 3, v22
v_and_b32 v28, 1, v26
v_lshlrev_b32 v29, 3, v28
v_add_u32 v24, v25, v29
v_lshrrev_b32 v22, 4, v0
v_lshrrev_b32 v26, 1, v22
v_lshlrev_b32 v28, 1, v26
v_lshrrev_b32 v21, 2, v0
v_and_b32 v23, 3, v21
v_lshrrev_b32 v22, 1, v23
v_lshrrev_b32 v19, 4, v0
v_lshrrev_b32 v20, 1, v19
v_and_b32 v21, s9, v20
v_and_b32 v23, 1, v21
v_xor_b32 v26, v22, v23
v_add_u32 v25, v28, v26
v_mov_b32 v26, 0x110
v_mul_lo_u32 v29, v25, v26
v_add_u32 v27, v24, v29
v_add_u32 v105, 0x440, v27
v_mov_b32 v28, s9
v_lshlrev_b32 v25, 12, v28
v_add_u32 v26, 0x10000, v25
v_and_b32 v28, 3, v0
v_lshlrev_b32 v25, 6, v28
v_add_u32 v24, v26, v25
v_lshrrev_b32 v28, 4, v0
v_and_b32 v26, 1, v28
v_lshlrev_b32 v25, 5, v26
v_add_u32 v29, v24, v25
v_lshrrev_b32 v28, 2, v0
v_and_b32 v26, 3, v28
v_and_b32 v24, 1, v26
v_lshlrev_b32 v25, 3, v24
v_add_u32 v27, v29, v25
v_lshrrev_b32 v28, 4, v0
v_lshrrev_b32 v26, 1, v28
v_lshlrev_b32 v24, 1, v26
v_lshrrev_b32 v23, 2, v0
v_and_b32 v28, 3, v23
v_lshrrev_b32 v26, 1, v28
v_add_u32 v29, v24, v26
v_mov_b32 v26, 0x110
v_mul_lo_u32 v25, v29, v26
v_add_u32 v104, v27, v25
v_mov_b32 v26, s9
v_lshlrev_b32 v27, 13, v26
v_add_u32 v25, 0, v27
v_lshlrev_b32 v27, 4, v0
v_add_u32 v103, v25, v27
v_mov_b32 v26, s9
v_lshlrev_b32 v25, 2, v26
v_add_u32 v27, 0x10fc0, v25
v_mov_b32 v26, 0
v_mul_lo_u32 v25, v0, v26
v_add_u32 v102, v27, v25
v_mov_b32 v23, 0
v_and_b32 v18, 31, v0
v_min_u32 v19, 19, v18
v_mov_b32 v18, 4
v_sub_u32 v20, v19, v18
v_lshrrev_b32 v21, 3, v20
v_add_u32 v22, 1, v21
v_and_b32 v20, 31, v0
v_min_u32 v21, 19, v20
v_mov_b32 v20, 4
v_cmp_lt_u32 vcc, v21, v20
s_nop 1
v_cndmask_b32 v28, v22, v23, vcc
v_lshlrev_b32 v24, 1, v28
v_lshrrev_b32 v28, 5, v0
v_add_u32 v29, v24, v28
v_mov_b32 v28, 0x120
v_mul_lo_u32 v26, v29, v28
v_add_u32 v27, 0x10900, v26
v_mov_b32 v24, s9
v_lshlrev_b32 v29, 4, v24
v_and_b32 v22, 31, v0
v_min_u32 v21, 19, v22
v_and_b32 v19, 31, v0
v_min_u32 v18, 19, v19
v_mov_b32 v19, 4
v_sub_u32 v23, v18, v19
v_and_b32 v22, 7, v23
v_and_b32 v19, 31, v0
v_min_u32 v23, 19, v19
v_mov_b32 v19, 4
v_cmp_lt_u32 vcc, v23, v19
s_nop 1
v_cndmask_b32 v20, v22, v21, vcc
v_lshlrev_b32 v24, 1, v20
v_add_u32 v28, v29, v24
v_lshlrev_b32 v26, 2, v28
v_add_u32 v25, v27, v26
v_mov_b32 v26, 0x10a00
v_and_b32 v27, 31, v0
v_mov_b32 v28, 20
v_cmp_lt_u32 vcc, v27, v28
s_nop 1
v_cndmask_b32 v101, v26, v25, vcc
v_mov_b32 v29, s10
v_lshrrev_b32 v24, 3, v29
v_add_u32 v25, 8, v24
v_lshlrev_b32 v26, 10, v25
v_mov_b32 v23, s10
v_lshrrev_b32 v19, 1, v23
v_and_b32 v20, 3, v19
v_lshlrev_b32 v29, 4, v20
v_mov_b32 v17, s9
v_lshlrev_b32 v18, 1, v17
v_lshrrev_b32 v17, 5, v0
v_add_u32 v21, v18, v17
v_lshrrev_b32 v22, 1, v21
v_lshlrev_b32 v23, 2, v22
v_and_b32 v17, 31, v0
v_and_b32 v21, 1, v17
v_lshlrev_b32 v22, 1, v21
v_add_u32 v19, v23, v22
v_mov_b32 v17, s9
v_lshlrev_b32 v21, 1, v17
v_lshrrev_b32 v17, 5, v0
v_add_u32 v23, v21, v17
v_and_b32 v22, 1, v23
v_add_u32 v20, v19, v22
v_add_u32 v24, v29, v20
v_lshlrev_b32 v25, 4, v24
v_add_u32 v27, v26, v25
v_mov_b32 v29, 1
v_and_b32 v20, s10, v29
v_lshlrev_b32 v24, 1, v20
v_and_b32 v22, 31, v0
v_lshrrev_b32 v29, 1, v22
v_and_b32 v20, 1, v29
v_add_u32 v26, v24, v20
v_lshlrev_b32 v25, 2, v26
v_add_u32 v28, v27, v25
v_mov_b32 v29, s10
v_lshrrev_b32 v24, 1, v29
v_lshlrev_b32 v20, 10, v24
v_mov_b32 v21, 1
v_and_b32 v17, s10, v21
v_lshlrev_b32 v23, 1, v17
v_and_b32 v14, 31, v0
v_min_u32 v15, 19, v14
v_mov_b32 v14, 4
v_sub_u32 v16, v15, v14
v_lshlrev_b32 v18, 1, v16
v_lshrrev_b32 v21, 3, v18
v_and_b32 v17, 1, v21
v_add_u32 v19, v23, v17
v_lshlrev_b32 v22, 4, v19
v_mov_b32 v14, s9
v_lshlrev_b32 v16, 1, v14
v_lshrrev_b32 v14, 5, v0
v_add_u32 v18, v16, v14
v_lshrrev_b32 v21, 1, v18
v_lshlrev_b32 v23, 2, v21
v_and_b32 v12, 31, v0
v_min_u32 v13, 19, v12
v_mov_b32 v12, 4
v_sub_u32 v15, v13, v12
v_lshlrev_b32 v16, 1, v15
v_lshrrev_b32 v14, 1, v16
v_and_b32 v18, 1, v14
v_lshlrev_b32 v21, 1, v18
v_add_u32 v17, v23, v21
v_mov_b32 v14, s9
v_lshlrev_b32 v18, 1, v14
v_lshrrev_b32 v14, 5, v0
v_add_u32 v23, v18, v14
v_and_b32 v21, 1, v23
v_add_u32 v19, v17, v21
v_add_u32 v29, v22, v19
v_lshlrev_b32 v24, 4, v29
v_add_u32 v26, v20, v24
v_and_b32 v14, 31, v0
v_min_u32 v23, 19, v14
v_mov_b32 v14, 4
v_sub_u32 v17, v23, v14
v_lshlrev_b32 v21, 1, v17
v_lshrrev_b32 v22, 2, v21
v_and_b32 v19, 1, v22
v_lshlrev_b32 v29, 1, v19
v_and_b32 v23, 31, v0
v_min_u32 v14, 19, v23
v_mov_b32 v23, 4
v_sub_u32 v17, v14, v23
v_lshlrev_b32 v21, 1, v17
v_lshrrev_b32 v22, 4, v21
v_and_b32 v19, 1, v22
v_add_u32 v20, v29, v19
v_lshlrev_b32 v24, 2, v20
v_add_u32 v27, v26, v24
v_mov_b32 v24, 0x40000000
v_and_b32 v26, 31, v0
v_mov_b32 v20, 20
v_cmp_lt_u32 vcc, v26, v20
s_nop 1
v_cndmask_b32 v25, v24, v27, vcc
v_and_b32 v20, 31, v0
v_mov_b32 v26, 4
v_cmp_lt_u32 vcc, v20, v26
s_nop 1
v_cndmask_b32 v100, v25, v28, vcc
v_and_b32 v20, 15, v0
v_lshlrev_b32 v26, 2, v20
v_add_u32 v117, 0x3420000, v26
v_mov_b32 v25, s10
v_lshlrev_b32 v20, 2, v25
v_add_u32 v26, 0x3428000, v20
v_mov_b32 v20, 0x40000000
v_mov_b32 v24, s9
v_lshlrev_b32 v28, 6, v24
v_add_u32 v25, v0, v28
v_mov_b32 v28, 1
v_cmp_lt_u32 vcc, v25, v28
s_nop 1
v_cndmask_b32 v116, v20, v26, vcc
s_mov_b32 s52, 0xfffff
s_mov_b32 s53, 0xfffff
s_lshr_b32 s11, s9, 1
s_mul_i32 s34, s11, 7
s_and_b32 s35, s9, 1
s_lshl_b32 s36, s35, 2
s_add_u32 s36, s36, s34
s_add_u32 s37, s36, 0
s_lshl_b32 s21, s37, 10
s_add_u32 s37, s36, 1
s_lshl_b32 s22, s37, 10
s_add_u32 s37, s36, 2
s_lshl_b32 s23, s37, 10
s_add_u32 s37, s34, 3
s_lshl_b32 s24, s37, 10
s_lshl_b32 s32, s9, 13
s_mul_i32 s38, s10, 401408
s_add_u32 s38, s38, 2097152
s_mul_i32 s39, s35, 14336
s_cmp_lg_u32 s9, 0
s_cbranch_scc1 RA_wa_go
v_mov_b32 v10, s10
v_lshlrev_b32 v11, 7, v10
v_add_u32 v12, 0x3433000, v11
v_mov_b32 v11, 0x343e000
v_mov_b32 v10, 1
v_cmp_lt_u32 vcc, v0, v10
s_nop 1
v_cndmask_b32 v1, v11, v12, vcc
v_mov_b32 v10, 14
v_mov_b32 v11, 32
v_mov_b32 v12, 1
v_cmp_lt_u32 vcc, v0, v12
s_nop 1
v_cndmask_b32 v2, v11, v10, vcc
s_mov_b32 s19, 0x40000
RA_wa:
buffer_load_dword v3, v1, s[4:7], 0 offen sc1
s_sub_u32 s19, s19, 1
s_cbranch_scc1 R_exit
s_waitcnt vmcnt(0)
v_cmp_gt_u32 vcc, v2, v3
s_cbranch_vccnz RA_wa
RA_wa_go:
s_barrier
s_mov_b32 s25, 0
s_mov_b32 s26, s32
s_add_u32 s44, s25, s21
s_add_u32 s45, s25, s24
s_add_u32 s46, s44, 14336
s_add_u32 s47, s45, 14336
s_mov_b32 s48, s26
s_add_u32 s49, s26, 3072
s_add_u32 s50, s26, 4096
s_add_u32 s51, s26, 7168
s_mov_b32 m0, s48
s_nop 0
buffer_load_dwordx4 v118, s[4:7], s44 offen offset:0  lds
buffer_load_dwordx4 v118, s[4:7], s44 offen offset:1024  lds
buffer_load_dwordx4 v118, s[4:7], s44 offen offset:2048  lds
s_mov_b32 m0, s49
s_nop 0
buffer_load_dwordx4 v118, s[4:7], s45 offen offset:0  lds
s_mov_b32 m0, s50
s_nop 0
buffer_load_dwordx4 v118, s[4:7], s46 offen offset:0  lds
buffer_load_dwordx4 v118, s[4:7], s46 offen offset:1024  lds
buffer_load_dwordx4 v118, s[4:7], s46 offen offset:2048  lds
s_mov_b32 m0, s51
s_nop 0
buffer_load_dwordx4 v118, s[4:7], s47 offen offset:0  lds
s_mul_i32 s11, s21, 28
s_add_u32 s11, s11, s38
s_add_u32 s11, s11, 0
s_lshl_b32 s37, s12, 1
s_add_u32 s11, s11, s37
buffer_load_dwordx4 a[0:3], v106, s[4:7], s11 offen
s_mul_i32 s11, s21, 28
s_add_u32 s11, s11, s38
s_add_u32 s11, s11, 1024
s_lshl_b32 s37, s12, 1
s_add_u32 s11, s11, s37
buffer_load_dwordx4 a[4:7], v106, s[4:7], s11 offen
s_mul_i32 s11, s21, 28
s_add_u32 s11, s11, s38
s_add_u32 s11, s11, 0
s_lshl_b32 s37, s13, 1
s_add_u32 s11, s11, s37
buffer_load_dwordx4 a[8:11], v106, s[4:7], s11 offen
s_mul_i32 s11, s21, 28
s_add_u32 s11, s11, s38
s_add_u32 s11, s11, 1024
s_lshl_b32 s37, s13, 1
s_add_u32 s11, s11, s37
buffer_load_dwordx4 a[12:15], v106, s[4:7], s11 offen
s_mul_i32 s11, s21, 28
s_add_u32 s11, s11, s38
s_add_u32 s11, s11, 0
s_lshl_b32 s37, s14, 1
s_add_u32 s11, s11, s37
buffer_load_dwordx4 a[16:19], v106, s[4:7], s11 offen
s_mul_i32 s11, s21, 28
s_add_u32 s11, s11, s38
s_add_u32 s11, s11, 1024
s_lshl_b32 s37, s14, 1
s_add_u32 s11, s11, s37
buffer_load_dwordx4 a[20:23], v106, s[4:7], s11 offen
s_mul_i32 s11, s21, 28
s_add_u32 s11, s11, s38
s_add_u32 s11, s11, 0
s_lshl_b32 s37, s15, 1
s_add_u32 s11, s11, s37
buffer_load_dwordx4 a[24:27], v106, s[4:7], s11 offen
s_mul_i32 s11, s21, 28
s_add_u32 s11, s11, s38
s_add_u32 s11, s11, 1024
s_lshl_b32 s37, s15, 1
s_add_u32 s11, s11, s37
buffer_load_dwordx4 a[28:31], v106, s[4:7], s11 offen
s_mul_i32 s11, s21, 28
s_add_u32 s11, s11, s38
s_add_u32 s11, s11, 0
s_lshl_b32 s37, s16, 1
s_add_u32 s11, s11, s37
buffer_load_dwordx4 a[32:35], v106, s[4:7], s11 offen
s_mul_i32 s11, s21, 28
s_add_u32 s11, s11, s38
s_add_u32 s11, s11, 1024
s_lshl_b32 s37, s16, 1
s_add_u32 s11, s11, s37
buffer_load_dwordx4 a[36:39], v106, s[4:7], s11 offen
s_mul_i32 s11, s21, 28
s_add_u32 s11, s11, s38
s_add_u32 s11, s11, 0
s_lshl_b32 s37, s17, 1
s_add_u32 s11, s11, s37
buffer_load_dwordx4 a[40:43], v106, s[4:7], s11 offen
s_mul_i32 s11, s21, 28
s_add_u32 s11, s11, s38
s_add_u32 s11, s11, 1024
s_lshl_b32 s37, s17, 1
s_add_u32 s11, s11, s37
buffer_load_dwordx4 a[44:47], v106, s[4:7], s11 offen
s_mul_i32 s11, s21, 28
s_add_u32 s11, s11, s38
s_add_u32 s11, s11, 0
s_lshl_b32 s37, s18, 1
s_add_u32 s11, s11, s37
buffer_load_dwordx4 a[48:51], v106, s[4:7], s11 offen
s_mul_i32 s11, s21, 28
s_add_u32 s11, s11, s38
s_add_u32 s11, s11, 1024
s_lshl_b32 s37, s18, 1
s_add_u32 s11, s11, s37
buffer_load_dwordx4 a[52:55], v106, s[4:7], s11 offen
s_mul_i32 s11, s21, 28
s_add_u32 s11, s11, s38
s_add_u32 s11, s11, 14336
s_lshl_b32 s37, s12, 1
s_add_u32 s11, s11, s37
buffer_load_dwordx4 a[56:59], v106, s[4:7], s11 offen
s_mul_i32 s11, s21, 28
s_add_u32 s11, s11, s38
s_add_u32 s11, s11, 15360
s_lshl_b32 s37, s12, 1
s_add_u32 s11, s11, s37
buffer_load_dwordx4 a[60:63], v106, s[4:7], s11 offen
s_waitcnt vmcnt(32)
s_mul_i32 s11, s21, 28
s_add_u32 s11, s11, s38
s_add_u32 s11, s11, 14336
s_lshl_b32 s37, s13, 1
s_add_u32 s11, s11, s37
buffer_load_dwordx4 a[64:67], v106, s[4:7], s11 offen
s_mul_i32 s11, s21, 28
s_add_u32 s11, s11, s38
s_add_u32 s11, s11, 15360
s_lshl_b32 s37, s13, 1
s_add_u32 s11, s11, s37
buffer_load_dwordx4 a[68:71], v106, s[4:7], s11 offen
s_mul_i32 s11, s21, 28
s_add_u32 s11, s11, s38
s_add_u32 s11, s11, 14336
s_lshl_b32 s37, s14, 1
s_add_u32 s11, s11, s37
buffer_load_dwordx4 a[72:75], v106, s[4:7], s11 offen
s_mul_i32 s11, s21, 28
s_add_u32 s11, s11, s38
s_add_u32 s11, s11, 15360
s_lshl_b32 s37, s14, 1
s_add_u32 s11, s11, s37
buffer_load_dwordx4 a[76:79], v106, s[4:7], s11 offen
s_mul_i32 s11, s21, 28
s_add_u32 s11, s11, s38
s_add_u32 s11, s11, 14336
s_lshl_b32 s37, s15, 1
s_add_u32 s11, s11, s37
buffer_load_dwordx4 a[80:83], v106, s[4:7], s11 offen
s_mul_i32 s11, s21, 28
s_add_u32 s11, s11, s38
s_add_u32 s11, s11, 15360
s_lshl_b32 s37, s15, 1
s_add_u32 s11, s11, s37
buffer_load_dwordx4 a[84:87], v106, s[4:7], s11 offen
s_mul_i32 s11, s21, 28
s_add_u32 s11, s11, s38
s_add_u32 s11, s11, 14336
s_lshl_b32 s37, s16, 1
s_add_u32 s11, s11, s37
buffer_load_dwordx4 a[88:91], v106, s[4:7], s11 offen
s_mul_i32 s11, s21, 28
s_add_u32 s11, s11, s38
s_add_u32 s11, s11, 15360
s_lshl_b32 s37, s16, 1
s_add_u32 s11, s11, s37
buffer_load_dwordx4 a[92:95], v106, s[4:7], s11 offen
s_mul_i32 s11, s21, 28
s_add_u32 s11, s11, s38
s_add_u32 s11, s11, 14336
s_lshl_b32 s37, s17, 1
s_add_u32 s11, s11, s37
buffer_load_dwordx4 a[96:99], v106, s[4:7], s11 offen
s_mul_i32 s11, s21, 28
s_add_u32 s11, s11, s38
s_add_u32 s11, s11, 15360
s_lshl_b32 s37, s17, 1
s_add_u32 s11, s11, s37
buffer_load_dwordx4 a[100:103], v106, s[4:7], s11 offen
s_mul_i32 s11, s21, 28
s_add_u32 s11, s11, s38
s_add_u32 s11, s11, 14336
s_lshl_b32 s37, s18, 1
s_add_u32 s11, s11, s37
buffer_load_dwordx4 a[104:107], v106, s[4:7], s11 offen
s_mul_i32 s11, s21, 28
s_add_u32 s11, s11, s38
s_add_u32 s11, s11, 15360
s_lshl_b32 s37, s18, 1
s_add_u32 s11, s11, s37
buffer_load_dwordx4 a[108:111], v106, s[4:7], s11 offen
s_mul_i32 s11, s22, 28
s_add_u32 s11, s11, s38
s_add_u32 s11, s11, 0
s_lshl_b32 s37, s12, 1
s_add_u32 s11, s11, s37
buffer_load_dwordx4 a[112:115], v106, s[4:7], s11 offen
s_mul_i32 s11, s22, 28
s_add_u32 s11, s11, s38
s_add_u32 s11, s11, 1024
s_lshl_b32 s37, s12, 1
s_add_u32 s11, s11, s37
buffer_load_dwordx4 a[116:119], v106, s[4:7], s11 offen
s_mul_i32 s11, s22, 28
s_add_u32 s11, s11, s38
s_add_u32 s11, s11, 0
s_lshl_b32 s37, s13, 1
s_add_u32 s11, s11, s37
buffer_load_dwordx4 a[120:123], v106, s[4:7], s11 offen
s_mul_i32 s11, s22, 28
s_add_u32 s11, s11, s38
s_add_u32 s11, s11, 1024
s_lshl_b32 s37, s13, 1
s_add_u32 s11, s11, s37
buffer_load_dwordx4 a[124:127], v106, s[4:7], s11 offen
s_waitcnt vmcnt(32)
s_mul_i32 s11, s22, 28
s_add_u32 s11, s11, s38
s_add_u32 s11, s11, 0
s_lshl_b32 s37, s14, 1
s_add_u32 s11, s11, s37
buffer_load_dwordx4 a[128:131], v106, s[4:7], s11 offen
s_mul_i32 s11, s22, 28
s_add_u32 s11, s11, s38
s_add_u32 s11, s11, 1024
s_lshl_b32 s37, s14, 1
s_add_u32 s11, s11, s37
buffer_load_dwordx4 a[132:135], v106, s[4:7], s11 offen
s_mul_i32 s11, s22, 28
s_add_u32 s11, s11, s38
s_add_u32 s11, s11, 0
s_lshl_b32 s37, s15, 1
s_add_u32 s11, s11, s37
buffer_load_dwordx4 a[136:139], v106, s[4:7], s11 offen
s_mul_i32 s11, s22, 28
s_add_u32 s11, s11, s38
s_add_u32 s11, s11, 1024
s_lshl_b32 s37, s15, 1
s_add_u32 s11, s11, s37
buffer_load_dwordx4 a[140:143], v106, s[4:7], s11 offen
s_mul_i32 s11, s22, 28
s_add_u32 s11, s11, s38
s_add_u32 s11, s11, 0
s_lshl_b32 s37, s16, 1
s_add_u32 s11, s11, s37
buffer_load_dwordx4 a[144:147], v106, s[4:7], s11 offen
s_mul_i32 s11, s22, 28
s_add_u32 s11, s11, s38
s_add_u32 s11, s11, 1024
s_lshl_b32 s37, s16, 1
s_add_u32 s11, s11, s37
buffer_load_dwordx4 a[148:151], v106, s[4:7], s11 offen
s_mul_i32 s11, s22, 28
s_add_u32 s11, s11, s38
s_add_u32 s11, s11, 0
s_lshl_b32 s37, s17, 1
s_add_u32 s11, s11, s37
buffer_load_dwordx4 a[152:155], v106, s[4:7], s11 offen
s_mul_i32 s11, s22, 28
s_add_u32 s11, s11, s38
s_add_u32 s11, s11, 1024
s_lshl_b32 s37, s17, 1
s_add_u32 s11, s11, s37
buffer_load_dwordx4 a[156:159], v106, s[4:7], s11 offen
s_mul_i32 s11, s22, 28
s_add_u32 s11, s11, s38
s_add_u32 s11, s11, 0
s_lshl_b32 s37, s18, 1
s_add_u32 s11, s11, s37
buffer_load_dwordx4 a[160:163], v106, s[4:7], s11 offen
s_mul_i32 s11, s22, 28
s_add_u32 s11, s11, s38
s_add_u32 s11, s11, 1024
s_lshl_b32 s37, s18, 1
s_add_u32 s11, s11, s37
buffer_load_dwordx4 a[164:167], v106, s[4:7], s11 offen
s_mul_i32 s11, s22, 28
s_add_u32 s11, s11, s38
s_add_u32 s11, s11, 14336
s_lshl_b32 s37, s12, 1
s_add_u32 s11, s11, s37
buffer_load_dwordx4 a[168:171], v106, s[4:7], s11 offen
s_mul_i32 s11, s22, 28
s_add_u32 s11, s11, s38
s_add_u32 s11, s11, 15360
s_lshl_b32 s37, s12, 1
s_add_u32 s11, s11, s37
buffer_load_dwordx4 a[172:175], v106, s[4:7], s11 offen
s_mul_i32 s11, s22, 28
s_add_u32 s11, s11, s38
s_add_u32 s11, s11, 14336
s_lshl_b32 s37, s13, 1
s_add_u32 s11, s11, s37
buffer_load_dwordx4 a[176:179], v106, s[4:7], s11 offen
s_mul_i32 s11, s22, 28
s_add_u32 s11, s11, s38
s_add_u32 s11, s11, 15360
s_lshl_b32 s37, s13, 1
s_add_u32 s11, s11, s37
buffer_load_dwordx4 a[180:183], v106, s[4:7], s11 offen
s_mul_i32 s11, s22, 28
s_add_u32 s11, s11, s38
s_add_u32 s11, s11, 14336
s_lshl_b32 s37, s14, 1
s_add_u32 s11, s11, s37
buffer_load_dwordx4 a[184:187], v106, s[4:7], s11 offen
s_mul_i32 s11, s22, 28
s_add_u32 s11, s11, s38
s_add_u32 s11, s11, 15360
s_lshl_b32 s37, s14, 1
s_add_u32 s11, s11, s37
buffer_load_dwordx4 a[188:191], v106, s[4:7], s11 offen
s_waitcnt vmcnt(32)
s_mul_i32 s11, s22, 28
s_add_u32 s11, s11, s38
s_add_u32 s11, s11, 14336
s_lshl_b32 s37, s15, 1
s_add_u32 s11, s11, s37
buffer_load_dwordx4 a[192:195], v106, s[4:7], s11 offen
s_mul_i32 s11, s22, 28
s_add_u32 s11, s11, s38
s_add_u32 s11, s11, 15360
s_lshl_b32 s37, s15, 1
s_add_u32 s11, s11, s37
buffer_load_dwordx4 a[196:199], v106, s[4:7], s11 offen
s_mul_i32 s11, s22, 28
s_add_u32 s11, s11, s38
s_add_u32 s11, s11, 14336
s_lshl_b32 s37, s16, 1
s_add_u32 s11, s11, s37
buffer_load_dwordx4 a[200:203], v106, s[4:7], s11 offen
s_mul_i32 s11, s22, 28
s_add_u32 s11, s11, s38
s_add_u32 s11, s11, 15360
s_lshl_b32 s37, s16, 1
s_add_u32 s11, s11, s37
buffer_load_dwordx4 a[204:207], v106, s[4:7], s11 offen
s_mul_i32 s11, s22, 28
s_add_u32 s11, s11, s38
s_add_u32 s11, s11, 14336
s_lshl_b32 s37, s17, 1
s_add_u32 s11, s11, s37
buffer_load_dwordx4 a[208:211], v106, s[4:7], s11 offen
s_mul_i32 s11, s22, 28
s_add_u32 s11, s11, s38
s_add_u32 s11, s11, 15360
s_lshl_b32 s37, s17, 1
s_add_u32 s11, s11, s37
buffer_load_dwordx4 a[212:215], v106, s[4:7], s11 offen
s_mul_i32 s11, s22, 28
s_add_u32 s11, s11, s38
s_add_u32 s11, s11, 14336
s_lshl_b32 s37, s18, 1
s_add_u32 s11, s11, s37
buffer_load_dwordx4 a[216:219], v106, s[4:7], s11 offen
s_mul_i32 s11, s22, 28
s_add_u32 s11, s11, s38
s_add_u32 s11, s11, 15360
s_lshl_b32 s37, s18, 1
s_add_u32 s11, s11, s37
buffer_load_dwordx4 a[220:223], v106, s[4:7], s11 offen
s_mul_i32 s11, s23, 28
s_add_u32 s11, s11, s38
s_add_u32 s11, s11, 0
s_lshl_b32 s37, s12, 1
s_add_u32 s11, s11, s37
buffer_load_dwordx4 a[224:227], v106, s[4:7], s11 offen
s_mul_i32 s11, s23, 28
s_add_u32 s11, s11, s38
s_add_u32 s11, s11, 1024
s_lshl_b32 s37, s12, 1
s_add_u32 s11, s11, s37
buffer_load_dwordx4 a[228:231], v106, s[4:7], s11 offen
s_mul_i32 s11, s23, 28
s_add_u32 s11, s11, s38
s_add_u32 s11, s11, 0
s_lshl_b32 s37, s13, 1
s_add_u32 s11, s11, s37
buffer_load_dwordx4 a[232:235], v106, s[4:7], s11 offen
s_mul_i32 s11, s23, 28
s_add_u32 s11, s11, s38
s_add_u32 s11, s11, 1024
s_lshl_b32 s37, s13, 1
s_add_u32 s11, s11, s37
buffer_load_dwordx4 a[236:239], v106, s[4:7], s11 offen
s_mul_i32 s11, s23, 28
s_add_u32 s11, s11, s38
s_add_u32 s11, s11, 0
s_lshl_b32 s37, s14, 1
s_add_u32 s11, s11, s37
buffer_load_dwordx4 a[240:243], v106, s[4:7], s11 offen
s_mul_i32 s11, s23, 28
s_add_u32 s11, s11, s38
s_add_u32 s11, s11, 1024
s_lshl_b32 s37, s14, 1
s_add_u32 s11, s11, s37
buffer_load_dwordx4 a[244:247], v106, s[4:7], s11 offen
s_mul_i32 s11, s23, 28
s_add_u32 s11, s11, s38
s_add_u32 s11, s11, 0
s_lshl_b32 s37, s15, 1
s_add_u32 s11, s11, s37
buffer_load_dwordx4 a[248:251], v106, s[4:7], s11 offen
s_mul_i32 s11, s23, 28
s_add_u32 s11, s11, s38
s_add_u32 s11, s11, 1024
s_lshl_b32 s37, s15, 1
s_add_u32 s11, s11, s37
buffer_load_dwordx4 a[252:255], v106, s[4:7], s11 offen
s_waitcnt vmcnt(32)
s_mul_i32 s11, s23, 28
s_add_u32 s11, s11, s38
s_add_u32 s11, s11, 0
s_lshl_b32 s37, s16, 1
s_add_u32 s11, s11, s37
buffer_load_dwordx4 v[120:123], v106, s[4:7], s11 offen
s_mul_i32 s11, s23, 28
s_add_u32 s11, s11, s38
s_add_u32 s11, s11, 1024
s_lshl_b32 s37, s16, 1
s_add_u32 s11, s11, s37
buffer_load_dwordx4 v[124:127], v106, s[4:7], s11 offen
s_mul_i32 s11, s23, 28
s_add_u32 s11, s11, s38
s_add_u32 s11, s11, 0
s_lshl_b32 s37, s17, 1
s_add_u32 s11, s11, s37
buffer_load_dwordx4 v[128:131], v106, s[4:7], s11 offen
s_mul_i32 s11, s23, 28
s_add_u32 s11, s11, s38
s_add_u32 s11, s11, 1024
s_lshl_b32 s37, s17, 1
s_add_u32 s11, s11, s37
buffer_load_dwordx4 v[132:135], v106, s[4:7], s11 offen
s_mul_i32 s11, s23, 28
s_add_u32 s11, s11, s38
s_add_u32 s11, s11, 0
s_lshl_b32 s37, s18, 1
s_add_u32 s11, s11, s37
buffer_load_dwordx4 v[136:139], v106, s[4:7], s11 offen
s_mul_i32 s11, s23, 28
s_add_u32 s11, s11, s38
s_add_u32 s11, s11, 1024
s_lshl_b32 s37, s18, 1
s_add_u32 s11, s11, s37
buffer_load_dwordx4 v[140:143], v106, s[4:7], s11 offen
s_mul_i32 s11, s23, 28
s_add_u32 s11, s11, s38
s_add_u32 s11, s11, 14336
s_lshl_b32 s37, s12, 1
s_add_u32 s11, s11, s37
buffer_load_dwordx4 v[144:147], v106, s[4:7], s11 offen
s_mul_i32 s11, s23, 28
s_add_u32 s11, s11, s38
s_add_u32 s11, s11, 15360
s_lshl_b32 s37, s12, 1
s_add_u32 s11, s11, s37
buffer_load_dwordx4 v[148:151], v106, s[4:7], s11 offen
s_mul_i32 s11, s23, 28
s_add_u32 s11, s11, s38
s_add_u32 s11, s11, 14336
s_lshl_b32 s37, s13, 1
s_add_u32 s11, s11, s37
buffer_load_dwordx4 v[152:155], v106, s[4:7], s11 offen
s_mul_i32 s11, s23, 28
s_add_u32 s11, s11, s38
s_add_u32 s11, s11, 15360
s_lshl_b32 s37, s13, 1
s_add_u32 s11, s11, s37
buffer_load_dwordx4 v[156:159], v106, s[4:7], s11 offen
s_mul_i32 s11, s23, 28
s_add_u32 s11, s11, s38
s_add_u32 s11, s11, 14336
s_lshl_b32 s37, s14, 1
s_add_u32 s11, s11, s37
buffer_load_dwordx4 v[160:163], v106, s[4:7], s11 offen
s_mul_i32 s11, s23, 28
s_add_u32 s11, s11, s38
s_add_u32 s11, s11, 15360
s_lshl_b32 s37, s14, 1
s_add_u32 s11, s11, s37
buffer_load_dwordx4 v[164:167], v106, s[4:7], s11 offen
s_mul_i32 s11, s23, 28
s_add_u32 s11, s11, s38
s_add_u32 s11, s11, 14336
s_lshl_b32 s37, s15, 1
s_add_u32 s11, s11, s37
buffer_load_dwordx4 v[168:171], v106, s[4:7], s11 offen
s_mul_i32 s11, s23, 28
s_add_u32 s11, s11, s38
s_add_u32 s11, s11, 15360
s_lshl_b32 s37, s15, 1
s_add_u32 s11, s11, s37
buffer_load_dwordx4 v[172:175], v106, s[4:7], s11 offen
s_mul_i32 s11, s23, 28
s_add_u32 s11, s11, s38
s_add_u32 s11, s11, 14336
s_lshl_b32 s37, s16, 1
s_add_u32 s11, s11, s37
buffer_load_dwordx4 v[176:179], v106, s[4:7], s11 offen
s_mul_i32 s11, s23, 28
s_add_u32 s11, s11, s38
s_add_u32 s11, s11, 15360
s_lshl_b32 s37, s16, 1
s_add_u32 s11, s11, s37
buffer_load_dwordx4 v[180:183], v106, s[4:7], s11 offen
s_waitcnt vmcnt(32)
s_mul_i32 s11, s23, 28
s_add_u32 s11, s11, s38
s_add_u32 s11, s11, 14336
s_lshl_b32 s37, s17, 1
s_add_u32 s11, s11, s37
buffer_load_dwordx4 v[184:187], v106, s[4:7], s11 offen
s_mul_i32 s11, s23, 28
s_add_u32 s11, s11, s38
s_add_u32 s11, s11, 15360
s_lshl_b32 s37, s17, 1
s_add_u32 s11, s11, s37
buffer_load_dwordx4 v[188:191], v106, s[4:7], s11 offen
s_mul_i32 s11, s23, 28
s_add_u32 s11, s11, s38
s_add_u32 s11, s11, 14336
s_lshl_b32 s37, s18, 1
s_add_u32 s11, s11, s37
buffer_load_dwordx4 v[192:195], v106, s[4:7], s11 offen
s_mul_i32 s11, s23, 28
s_add_u32 s11, s11, s38
s_add_u32 s11, s11, 15360
s_lshl_b32 s37, s18, 1
s_add_u32 s11, s11, s37
buffer_load_dwordx4 v[196:199], v106, s[4:7], s11 offen
s_mul_i32 s11, s24, 28
s_add_u32 s11, s11, s38
s_add_u32 s11, s11, s39
s_add_u32 s11, s11, 0
s_lshl_b32 s37, s12, 1
s_add_u32 s11, s11, s37
buffer_load_dwordx4 v[200:203], v106, s[4:7], s11 offen
s_mul_i32 s11, s24, 28
s_add_u32 s11, s11, s38
s_add_u32 s11, s11, s39
s_add_u32 s11, s11, 1024
s_lshl_b32 s37, s12, 1
s_add_u32 s11, s11, s37
buffer_load_dwordx4 v[204:207], v106, s[4:7], s11 offen
s_mul_i32 s11, s24, 28
s_add_u32 s11, s11, s38
s_add_u32 s11, s11, s39
s_add_u32 s11, s11, 0
s_lshl_b32 s37, s13, 1
s_add_u32 s11, s11, s37
buffer_load_dwordx4 v[208:211], v106, s[4:7], s11 offen
s_mul_i32 s11, s24, 28
s_add_u32 s11, s11, s38
s_add_u32 s11, s11, s39
s_add_u32 s11, s11, 1024
s_lshl_b32 s37, s13, 1
s_add_u32 s11, s11, s37
buffer_load_dwordx4 v[212:215], v106, s[4:7], s11 offen
s_mul_i32 s11, s24, 28
s_add_u32 s11, s11, s38
s_add_u32 s11, s11, s39
s_add_u32 s11, s11, 0
s_lshl_b32 s37, s14, 1
s_add_u32 s11, s11, s37
buffer_load_dwordx4 v[216:219], v106, s[4:7], s11 offen
s_mul_i32 s11, s24, 28
s_add_u32 s11, s11, s38
s_add_u32 s11, s11, s39
s_add_u32 s11, s11, 1024
s_lshl_b32 s37, s14, 1
s_add_u32 s11, s11, s37
buffer_load_dwordx4 v[220:223], v106, s[4:7], s11 offen
s_lshl_b32 s33, s3, 2
s_add_u32 s33, s33, s9
s_getpc_b64 s[56:57]
CT_2:
s_add_u32 s56, s56, M_rec-CT_2
s_addc_u32 s57, s57, (M_rec-CT_2)>>32
s_mov_b32 s58, M_end-M_rec
s_mov_b32 s59, 0x20000
s_lshl_b32 s11, s33, 9
v_lshlrev_b32 v2, 3, v0
buffer_load_dword v94, v2, s[56:59], s11 offen
s_mul_i32 s11, s24, 28
s_add_u32 s11, s11, s38
s_add_u32 s11, s11, s39
s_add_u32 s11, s11, 0
s_lshl_b32 s37, s15, 1
s_add_u32 s11, s11, s37
buffer_load_dwordx4 v[224:227], v106, s[4:7], s11 offen
s_mul_i32 s11, s24, 28
s_add_u32 s11, s11, s38
s_add_u32 s11, s11, s39
s_add_u32 s11, s11, 1024
s_lshl_b32 s37, s15, 1
s_add_u32 s11, s11, s37
buffer_load_dwordx4 v[228:231], v106, s[4:7], s11 offen
s_mul_i32 s11, s24, 28
s_add_u32 s11, s11, s38
s_add_u32 s11, s11, s39
s_add_u32 s11, s11, 0
s_lshl_b32 s37, s16, 1
s_add_u32 s11, s11, s37
buffer_load_dwordx4 v[232:235], v106, s[4:7], s11 offen
s_mul_i32 s11, s24, 28
s_add_u32 s11, s11, s38
s_add_u32 s11, s11, s39
s_add_u32 s11, s11, 1024
s_lshl_b32 s37, s16, 1
s_add_u32 s11, s11, s37
buffer_load_dwordx4 v[236:239], v106, s[4:7], s11 offen
s_mul_i32 s11, s24, 28
s_add_u32 s11, s11, s38
s_add_u32 s11, s11, s39
s_add_u32 s11, s11, 0
s_lshl_b32 s37, s17, 1
s_add_u32 s11, s11, s37
buffer_load_dwordx4 v[240:243], v106, s[4:7], s11 offen
s_mul_i32 s11, s24, 28
s_add_u32 s11, s11, s38
s_add_u32 s11, s11, s39
s_add_u32 s11, s11, 1024
s_lshl_b32 s37, s17, 1
s_add_u32 s11, s11, s37
buffer_load_dwordx4 v[244:247], v106, s[4:7], s11 offen
s_waitcnt vmcnt(32)
s_mul_i32 s11, s24, 28
s_add_u32 s11, s11, s38
s_add_u32 s11, s11, s39
s_add_u32 s11, s11, 0
s_lshl_b32 s37, s18, 1
s_add_u32 s11, s11, s37
buffer_load_dwordx4 v[248:251], v106, s[4:7], s11 offen
s_mul_i32 s11, s24, 28
s_add_u32 s11, s11, s38
s_add_u32 s11, s11, s39
s_add_u32 s11, s11, 1024
s_lshl_b32 s37, s18, 1
s_add_u32 s11, s11, s37
buffer_load_dwordx4 v[252:255], v106, s[4:7], s11 offen
v_mov_b32 v20, s9
v_lshlrev_b32 v25, 12, v20
v_add_u32 v28, 0x10000, v25
v_lshlrev_b32 v25, 4, v0
v_add_u32 v1, v28, v25
v_mov_b64 v[4:5], 0
v_mov_b64 v[6:7], 0
ds_write_b128 v1, v[4:7] offset:0
ds_write_b128 v1, v[4:7] offset:1024
ds_write_b128 v1, v[4:7] offset:2048
v_mov_b32 v20, s9
v_lshlrev_b32 v28, 12, v20
v_add_u32 v25, 0x10a00, v28
v_mov_b32 v20, 0
v_mul_lo_u32 v28, v0, v20
v_add_u32 v1, v25, v28
v_mov_b32 v28, 0xff800000
v_mov_b32 v25, 0
v_mov_b32 v24, 0
v_mul_lo_u32 v26, v0, v24
v_add_u32 v20, s9, v26
v_mov_b32 v26, 1
v_cmp_lt_u32 vcc, v20, v26
s_nop 1
v_cndmask_b32 v8, v25, v28, vcc
v_mov_b32 v9, v8
ds_write_b64 v1, v[8:9]
v_mov_b64 v[28:29], 0
v_mov_b64 v[30:31], 0
v_mov_b64 v[32:33], 0
v_mov_b64 v[34:35], 0
v_mov_b64 v[36:37], 0
v_mov_b64 v[38:39], 0
v_mov_b64 v[40:41], 0
v_mov_b64 v[42:43], 0
v_mov_b64 v[44:45], 0
v_mov_b64 v[46:47], 0
v_mov_b64 v[48:49], 0
v_mov_b64 v[50:51], 0
v_mov_b64 v[52:53], 0
v_mov_b64 v[54:55], 0
v_mov_b64 v[80:81], 0
v_mov_b64 v[82:83], 0
v_mov_b64 v[84:85], 0
v_mov_b64 v[86:87], 0
v_mov_b64 v[88:89], 0
v_mov_b64 v[90:91], 0
s_mov_b32 s8, 0
s_mov_b32 s19, 524288
s_mov_b32 s20, 0
s_mul_i32 s35, s9, 4096
s_add_u32 s35, s35, 32768
s_lshl_b32 s11, s3, 2
s_add_u32 s11, s11, s9
s_lshl_b32 s11, s11, 11
s_add_u32 s11, s11, 54525952
v_lshlrev_b32 v4, 5, v0
buffer_load_dword v3, v4, s[4:7], s11 offen sc1
s_sub_u32 s11, s11, 54525952
s_lshr_b32 s11, s11, 2
s_add_u32 s11, s11, 28672
v_lshlrev_b32 v4, 3, v0
buffer_load_dword v3, v4, s[4:7], s11 offen sc1
s_mov_b32 s19, 524288
s_waitcnt vmcnt(0) lgkmcnt(0)
s_cmp_lg_u32 s30, 0
s_cbranch_scc1 RA_slow
RAx_loop:
s_and_b32 s11, s8, 3
s_lshl_b32 s33, s11, 13
s_add_u32 s33, s33, 54525952
s_add_u32 s36, s33, s12
s_add_u32 s37, s33, s13
s_add_u32 s38, s33, s29
s_add_u32 s39, s29, 131072
s_add_u32 s31, s8, 1
s_lshl_b32 s33, s11, 14
s_add_u32 s27, s33, 54591488
s_xor_b32 s28, s27, 0x8000
s_mul_i32 s25, s31, 28672
s_and_b32 s11, s31, 1
s_lshl_b32 s11, s11, 15
s_add_u32 s26, s11, s32
s_add_u32 s44, s25, s21
s_add_u32 s45, s25, s24
s_add_u32 s46, s44, 14336
s_add_u32 s47, s45, 14336
s_mov_b32 s48, s26
s_add_u32 s49, s26, 3072
s_add_u32 s50, s26, 4096
s_add_u32 s51, s26, 7168
v_mov_b32 v95, s31
v_mov_b64 v[12:13], -1
v_mov_b64 v[14:15], -1
.p2align 6
RAx_mload:
buffer_load_dwordx4 v[12:15], v118, s[4:7], s36 offen sc1
s_waitcnt vmcnt(2)
v_max3_u32 v92, v12, v13, v14
v_max_u32 v92, v92, v15
v_cmp_eq_u32 vcc, -1, v92
s_sub_u32 s19, s19, 1
s_cbranch_scc1 R_exit
s_cbranch_vccnz RAx_mload
RAx_again:
ds_write_b128 v115, v[12:15]
v_smfmac_f32_16x16x64_bf16 v[28:31], v[12:15], a[0:7], v119
v_smfmac_f32_16x16x64_bf16 v[32:35], v[12:15], a[56:63], v119
v_smfmac_f32_16x16x64_bf16 v[36:39], v[12:15], a[112:119], v119
v_smfmac_f32_16x16x64_bf16 v[40:43], v[12:15], a[168:175], v119
s_waitcnt lgkmcnt(0)
s_barrier
ds_read_b128 v[16:19], v114
v_smfmac_f32_16x16x64_bf16 v[44:47], v[12:15], a[224:231], v119
ds_read_b128 v[20:23], v113
s_mov_b32 m0, s39
v_smfmac_f32_16x16x64_bf16 v[48:51], v[12:15], v[144:151], v119
ds_read_b128 v[24:27], v112
buffer_load_dwordx4 v118, s[4:7], s38 offen sc1 lds
v_smfmac_f32_16x16x64_bf16 v[52:55], v[12:15], v[200:207], v119
ds_read_b128 v[64:67], v103 offset:0
s_waitcnt lgkmcnt(3)
v_smfmac_f32_16x16x64_bf16 v[28:31], v[16:19], a[8:15], v119
ds_read_b128 v[68:71], v103 offset:1024
v_smfmac_f32_16x16x64_bf16 v[32:35], v[16:19], a[64:71], v119
ds_read_b128 v[72:75], v103 offset:4096
v_smfmac_f32_16x16x64_bf16 v[36:39], v[16:19], a[120:127], v119
ds_read_b128 v[76:79], v103 offset:5120
v_smfmac_f32_16x16x64_bf16 v[40:43], v[16:19], a[176:183], v119
s_mov_b32 m0, s48
v_smfmac_f32_16x16x64_bf16 v[44:47], v[16:19], a[232:239], v119
buffer_load_dwordx4 v118, s[4:7], s44 offen offset:0  lds
v_smfmac_f32_16x16x64_bf16 v[48:51], v[16:19], v[152:159], v119
v_smfmac_f32_16x16x64_bf16 v[52:55], v[16:19], v[208:215], v119
s_waitcnt lgkmcnt(5)
v_smfmac_f32_16x16x64_bf16 v[28:31], v[20:23], a[16:23], v119
v_smfmac_f32_16x16x64_bf16 v[32:35], v[20:23], a[72:79], v119
buffer_load_dwordx4 v118, s[4:7], s44 offen offset:1024  lds
v_smfmac_f32_16x16x64_bf16 v[36:39], v[20:23], a[128:135], v119
v_smfmac_f32_16x16x64_bf16 v[40:43], v[20:23], a[184:191], v119
v_smfmac_f32_16x16x64_bf16 v[44:47], v[20:23], a[240:247], v119
v_smfmac_f32_16x16x64_bf16 v[48:51], v[20:23], v[160:167], v119
v_smfmac_f32_16x16x64_bf16 v[52:55], v[20:23], v[216:223], v119
buffer_load_dwordx4 v118, s[4:7], s44 offen offset:2048  lds
s_waitcnt lgkmcnt(4)
v_smfmac_f32_16x16x64_bf16 v[28:31], v[24:27], a[24:31], v119
v_smfmac_f32_16x16x64_bf16 v[32:35], v[24:27], a[80:87], v119
s_waitcnt vmcnt(3)
s_barrier
ds_read_b128 v[0:3], v111 offset:4096
ds_read_b128 v[4:7], v111 offset:5120
v_smfmac_f32_16x16x64_bf16 v[36:39], v[24:27], a[136:143], v119
ds_read_b128 v[8:11], v111 offset:6144
v_smfmac_f32_16x16x64_bf16 v[40:43], v[24:27], a[192:199], v119
s_mov_b32 m0, s49
ds_read_b64 v[56:57], v108 offset:0
ds_read_b64 v[58:59], v108 offset:32
v_smfmac_f32_16x16x64_bf16 v[44:47], v[24:27], a[248:255], v119
buffer_load_dwordx4 v118, s[4:7], s45 offen offset:0  lds
ds_read_b64 v[60:61], v108 offset:512
ds_read_b64 v[62:63], v108 offset:544
v_smfmac_f32_16x16x64_bf16 v[48:51], v[24:27], v[168:175], v119
v_smfmac_f32_16x16x64_bf16 v[52:55], v[24:27], v[224:231], v119
s_waitcnt lgkmcnt(6)
v_smfmac_f32_16x16x64_bf16 v[28:31], v[0:3], a[32:39], v119
s_waitcnt lgkmcnt(5)
v_smfmac_f32_16x16x64_bf16 v[28:31], v[4:7], a[40:47], v119
s_waitcnt lgkmcnt(4)
v_smfmac_f32_16x16x64_bf16 v[28:31], v[8:11], a[48:55], v119
s_mov_b32 m0, s35
v_smfmac_f32_16x16x64_bf16 v[32:35], v[0:3], a[88:95], v119
v_smfmac_f32_16x16x64_bf16 v[32:35], v[4:7], a[96:103], v119
v_add_f32 v92, v28, v30
v_smfmac_f32_16x16x64_bf16 v[32:35], v[8:11], a[104:111], v119
v_add_f32 v93, v29, v31
v_smfmac_f32_16x16x64_bf16 v[36:39], v[0:3], a[144:151], v119
v_cmp_u_f32 vcc, v92, v93
v_cvt_pk_bf16_f32 v94, v92, v93
v_smfmac_f32_16x16x64_bf16 v[36:39], v[4:7], a[152:159], v119
ds_write_addtid_b32 v94 offset:32768
v_add_f32 v92, v32, v34
v_smfmac_f32_16x16x64_bf16 v[36:39], v[8:11], a[160:167], v119
s_cbranch_vccnz RAx_lretry
RAx_lok:
v_add_f32 v93, v33, v35
v_smfmac_f32_16x16x64_bf16 v[40:43], v[0:3], a[200:207], v119
ds_read_b128 v[20:23], v103 offset:2048
v_cvt_pk_bf16_f32 v94, v92, v93
v_smfmac_f32_16x16x64_bf16 v[40:43], v[4:7], a[208:215], v119
ds_write_addtid_b32 v94 offset:33040
ds_read_b128 v[24:27], v103 offset:3072
v_add_f32 v92, v36, v38
v_smfmac_f32_16x16x64_bf16 v[40:43], v[8:11], a[216:223], v119
ds_read_b128 v[28:31], v103 offset:6144
v_add_f32 v93, v37, v39
v_smfmac_f32_16x16x64_bf16 v[44:47], v[0:3], v[120:127], v119
ds_read_b128 v[32:35], v103 offset:7168
v_cvt_pk_bf16_f32 v94, v92, v93
v_smfmac_f32_16x16x64_bf16 v[44:47], v[4:7], v[128:135], v119
ds_write_addtid_b32 v94 offset:33312
ds_read_b64 v[12:13], v108 offset:1024
ds_read_b64 v[14:15], v108 offset:1056
v_add_f32 v92, v40, v42
v_smfmac_f32_16x16x64_bf16 v[44:47], v[8:11], v[136:143], v119
ds_read_b64 v[16:17], v107 offset:0
ds_read_b64 v[18:19], v107 offset:32
v_add_f32 v93, v41, v43
v_smfmac_f32_16x16x64_bf16 v[48:51], v[0:3], v[176:183], v119
v_cvt_pk_bf16_f32 v94, v92, v93
v_smfmac_f32_16x16x64_bf16 v[48:51], v[4:7], v[184:191], v119
ds_write_addtid_b32 v94 offset:33584
v_add_f32 v92, v44, v46
v_smfmac_f32_16x16x64_bf16 v[48:51], v[8:11], v[192:199], v119
ds_read_b64_tr_b16 v[36:37], v104
v_add_f32 v93, v45, v47
v_smfmac_f32_16x16x64_bf16 v[52:55], v[0:3], v[232:239], v119
ds_read_b64_tr_b16 v[38:39], v104 offset:16
v_cvt_pk_bf16_f32 v94, v92, v93
v_smfmac_f32_16x16x64_bf16 v[52:55], v[4:7], v[240:247], v119
ds_write_addtid_b32 v94 offset:33856
v_add_f32 v92, v48, v50
v_smfmac_f32_16x16x64_bf16 v[52:55], v[8:11], v[248:255], v119
v_add_f32 v93, v49, v51
s_waitcnt lgkmcnt(1)
v_smfmac_f32_16x16x64_bf16 v[84:87], v[36:39], v[64:71], v119
v_cvt_pk_bf16_f32 v94, v92, v93
v_smfmac_f32_16x16x64_bf16 v[88:91], v[36:39], v[72:79], v119
ds_write_addtid_b32 v94 offset:34128
v_add_f32 v92, v52, v54
v_add_f32 v93, v53, v55
v_cvt_pk_bf16_f32 v94, v92, v93
ds_write_addtid_b32 v94 offset:34400
ds_read_b64_tr_b16 v[40:41], v105
ds_read_b64_tr_b16 v[42:43], v105 offset:16
v_swap_b32 v57, v58
v_swap_b32 v61, v62
v_swap_b32 v13, v14
v_swap_b32 v17, v18
v_smfmac_f32_16x16x64_bf16 v[80:83], v[36:39], v[56:63], v119
s_waitcnt lgkmcnt(0)
v_smfmac_f32_16x16x64_bf16 v[84:87], v[40:43], v[20:27], v119
v_smfmac_f32_16x16x64_bf16 v[88:91], v[40:43], v[28:35], v119
v_smfmac_f32_16x16x64_bf16 v[80:83], v[40:43], v[12:19], v119
v_add_f32 v58, v84, v86
v_add_f32 v59, v85, v87
ds_write_addtid_b32 v58 offset:35648
ds_write_addtid_b32 v59 offset:35936
v_add_f32 v60, v88, v90
v_add_f32 v61, v89, v91
ds_write_addtid_b32 v60 offset:36224
ds_write_addtid_b32 v61 offset:36512
v_add_f32 v56, v80, v82
v_add_f32 v57, v81, v83
ds_write_addtid_b32 v56 offset:35072
ds_write_addtid_b32 v57 offset:35360
s_waitcnt lgkmcnt(0)
s_barrier
ds_read_b64 v[64:65], v101 offset:0
ds_read_b64 v[66:67], v101 offset:4096
ds_read_b64 v[68:69], v101 offset:8192
ds_read_b64 v[70:71], v101 offset:12288
s_waitcnt lgkmcnt(2)
v_pk_add_f32 v[64:65], v[64:65], v[66:67]
s_waitcnt lgkmcnt(0)
v_pk_add_f32 v[68:69], v[68:69], v[70:71]
v_pk_add_f32 v[64:65], v[64:65], v[68:69]
v_max_f32 v66, v64, v65
s_nop 1
v_max_f32_dpp v66, v66, v66 row_ror:8 row_mask:0xf bank_mask:0xf
s_nop 1
v_max_f32_dpp v66, v66, v66 row_ror:4 row_mask:0xf bank_mask:0xf
s_nop 1
v_max_f32_dpp v66, v66, v66 row_ror:2 row_mask:0xf bank_mask:0xf
s_nop 1
v_max_f32_dpp v66, v66, v66 row_ror:1 row_mask:0xf bank_mask:0xf
v_mov_b32 v67, v66
s_nop 1
v_permlane16_swap_b32 v66, v67
v_max_f32 v66, v66, v67
v_pk_add_f32 v[64:65], v[64:65], v[66:67] op_sel_hi:[1,0] neg_lo:[0,1] neg_hi:[0,1]
v_exp_f32 v64, v64
v_exp_f32 v65, v65
buffer_store_dword v95, v116, s[4:7], 0 offen
v_add_f32 v66, v64, v65
s_nop 1
v_add_f32_dpp v66, v66, v66 row_ror:8 row_mask:0xf bank_mask:0xf
s_nop 1
v_add_f32_dpp v66, v66, v66 row_ror:4 row_mask:0xf bank_mask:0xf
s_nop 1
v_add_f32_dpp v66, v66, v66 row_ror:2 row_mask:0xf bank_mask:0xf
s_nop 1
v_add_f32_dpp v66, v66, v66 row_ror:1 row_mask:0xf bank_mask:0xf
v_mov_b32 v67, v66
s_nop 1
v_permlane16_swap_b32 v66, v67
v_add_f32 v66, v66, v67
v_rcp_f32 v66, v66
s_nop 0
v_pk_mul_f32 v[64:65], v[64:65], v[66:67] op_sel_hi:[1,0]
v_cvt_pk_bf16_f32 v64, v64, v65
v_min_u32 v64, -2, v64
buffer_store_dword v64, v100, s[4:7], s27 offen
v_mov_b64 v[28:29], 0
v_mov_b64 v[30:31], 0
v_mov_b64 v[32:33], 0
v_mov_b64 v[34:35], 0
v_mov_b64 v[36:37], 0
v_mov_b64 v[38:39], 0
v_mov_b64 v[40:41], 0
v_mov_b64 v[42:43], 0
v_mov_b64 v[44:45], 0
v_mov_b64 v[46:47], 0
v_mov_b64 v[48:49], 0
v_mov_b64 v[50:51], 0
v_mov_b64 v[52:53], 0
v_mov_b64 v[54:55], 0
v_mov_b64 v[80:81], 0
v_mov_b64 v[82:83], 0
v_mov_b64 v[84:85], 0
v_mov_b64 v[86:87], 0
v_mov_b64 v[88:89], 0
v_mov_b64 v[90:91], 0
v_xor_b32 v103, 0x8000, v103
v_mov_b32 v65, -1
buffer_store_dword v65, v100, s[4:7], s28 offen
s_mov_b32 m0, s50
s_nop 0
buffer_load_dwordx4 v118, s[4:7], s46 offen offset:0  lds
buffer_load_dwordx4 v118, s[4:7], s46 offen offset:1024  lds
buffer_load_dwordx4 v118, s[4:7], s46 offen offset:2048  lds
s_mov_b32 m0, s51
s_nop 0
buffer_load_dwordx4 v118, s[4:7], s47 offen offset:0  lds
s_mov_b32 s19, 524288
s_mov_b32 s8, s31
s_cmp_lt_u32 s8, 63
s_cbranch_scc1 RAx_loop
s_endpgm
RAx_lretry:
v_max3_u32 v95, v0, v1, v2
v_max3_u32 v95, v95, v3, v4
v_max3_u32 v95, v95, v5, v6
v_max3_u32 v95, v95, v7, v8
v_max3_u32 v95, v95, v9, v10
v_max_u32 v95, v95, v11
v_cmp_eq_u32 vcc, -1, v95
v_mov_b32 v95, s31
s_cbranch_vccz RAx_lok
s_add_u32 s20, s20, 1
s_sub_u32 s19, s19, 16
s_cbranch_scc1 R_exit
s_waitcnt vmcnt(0) lgkmcnt(0)
s_barrier
v_mov_b64 v[28:29], 0
v_mov_b64 v[30:31], 0
v_mov_b64 v[32:33], 0
v_mov_b64 v[34:35], 0
v_mov_b64 v[36:37], 0
v_mov_b64 v[38:39], 0
v_mov_b64 v[40:41], 0
v_mov_b64 v[42:43], 0
v_mov_b64 v[44:45], 0
v_mov_b64 v[46:47], 0
v_mov_b64 v[48:49], 0
v_mov_b64 v[50:51], 0
v_mov_b64 v[52:53], 0
v_mov_b64 v[54:55], 0
s_branch RAx_again
RA_slow:
RAy_loop:
s_and_b32 s11, s8, 3
s_lshl_b32 s33, s11, 13
s_add_u32 s33, s33, 54525952
s_add_u32 s36, s33, s12
s_add_u32 s37, s33, s13
s_add_u32 s38, s33, s29
s_add_u32 s39, s29, 131072
s_add_u32 s31, s8, 1
s_lshl_b32 s33, s11, 14
s_add_u32 s27, s33, 54591488
s_xor_b32 s28, s27, 0x8000
s_mul_i32 s25, s31, 28672
s_and_b32 s11, s31, 1
s_lshl_b32 s11, s11, 15
s_add_u32 s26, s11, s32
s_add_u32 s44, s25, s21
s_add_u32 s45, s25, s24
s_add_u32 s46, s44, 14336
s_add_u32 s47, s45, 14336
s_mov_b32 s48, s26
s_add_u32 s49, s26, 3072
s_add_u32 s50, s26, 4096
s_add_u32 s51, s26, 7168
v_mov_b32 v95, s31
v_mov_b64 v[12:13], -1
v_mov_b64 v[14:15], -1
.p2align 6
RAy_mload:
buffer_load_dwordx4 v[12:15], v118, s[4:7], s36 offen sc1
s_waitcnt vmcnt(2)
v_max3_u32 v92, v12, v13, v14
v_max_u32 v92, v92, v15
v_cmp_eq_u32 vcc, -1, v92
s_sub_u32 s19, s19, 1
s_cbranch_scc1 R_exit
s_cbranch_vccnz RAy_mload
RAy_again:
ds_write_b128 v115, v[12:15]
v_smfmac_f32_16x16x64_bf16 v[28:31], v[12:15], a[0:7], v119
v_smfmac_f32_16x16x64_bf16 v[32:35], v[12:15], a[56:63], v119
v_smfmac_f32_16x16x64_bf16 v[36:39], v[12:15], a[112:119], v119
v_smfmac_f32_16x16x64_bf16 v[40:43], v[12:15], a[168:175], v119
s_waitcnt lgkmcnt(0)
s_barrier
ds_read_b128 v[16:19], v114
v_smfmac_f32_16x16x64_bf16 v[44:47], v[12:15], a[224:231], v119
ds_read_b128 v[20:23], v113
s_mov_b32 m0, s39
v_smfmac_f32_16x16x64_bf16 v[48:51], v[12:15], v[144:151], v119
ds_read_b128 v[24:27], v112
buffer_load_dwordx4 v118, s[4:7], s38 offen sc1 lds
v_smfmac_f32_16x16x64_bf16 v[52:55], v[12:15], v[200:207], v119
ds_read_b128 v[64:67], v103 offset:0
s_waitcnt lgkmcnt(3)
v_smfmac_f32_16x16x64_bf16 v[28:31], v[16:19], a[8:15], v119
ds_read_b128 v[68:71], v103 offset:1024
v_smfmac_f32_16x16x64_bf16 v[32:35], v[16:19], a[64:71], v119
ds_read_b128 v[72:75], v103 offset:4096
v_smfmac_f32_16x16x64_bf16 v[36:39], v[16:19], a[120:127], v119
ds_read_b128 v[76:79], v103 offset:5120
v_smfmac_f32_16x16x64_bf16 v[40:43], v[16:19], a[176:183], v119
s_mov_b32 m0, s48
v_smfmac_f32_16x16x64_bf16 v[44:47], v[16:19], a[232:239], v119
buffer_load_dwordx4 v118, s[4:7], s44 offen offset:0  lds
v_smfmac_f32_16x16x64_bf16 v[48:51], v[16:19], v[152:159], v119
v_smfmac_f32_16x16x64_bf16 v[52:55], v[16:19], v[208:215], v119
s_waitcnt lgkmcnt(5)
v_smfmac_f32_16x16x64_bf16 v[28:31], v[20:23], a[16:23], v119
v_smfmac_f32_16x16x64_bf16 v[32:35], v[20:23], a[72:79], v119
buffer_load_dwordx4 v118, s[4:7], s44 offen offset:1024  lds
v_smfmac_f32_16x16x64_bf16 v[36:39], v[20:23], a[128:135], v119
v_smfmac_f32_16x16x64_bf16 v[40:43], v[20:23], a[184:191], v119
v_smfmac_f32_16x16x64_bf16 v[44:47], v[20:23], a[240:247], v119
v_smfmac_f32_16x16x64_bf16 v[48:51], v[20:23], v[160:167], v119
v_smfmac_f32_16x16x64_bf16 v[52:55], v[20:23], v[216:223], v119
buffer_load_dwordx4 v118, s[4:7], s44 offen offset:2048  lds
s_waitcnt lgkmcnt(4)
v_smfmac_f32_16x16x64_bf16 v[28:31], v[24:27], a[24:31], v119
v_smfmac_f32_16x16x64_bf16 v[32:35], v[24:27], a[80:87], v119
s_waitcnt vmcnt(3)
s_barrier
ds_read_b128 v[0:3], v111 offset:4096
ds_read_b128 v[4:7], v111 offset:5120
v_smfmac_f32_16x16x64_bf16 v[36:39], v[24:27], a[136:143], v119
ds_read_b128 v[8:11], v111 offset:6144
v_smfmac_f32_16x16x64_bf16 v[40:43], v[24:27], a[192:199], v119
s_mov_b32 m0, s49
ds_read_b64 v[56:57], v108 offset:0
ds_read_b64 v[58:59], v108 offset:32
v_smfmac_f32_16x16x64_bf16 v[44:47], v[24:27], a[248:255], v119
buffer_load_dwordx4 v118, s[4:7], s45 offen offset:0  lds
ds_read_b64 v[60:61], v108 offset:512
ds_read_b64 v[62:63], v108 offset:544
v_smfmac_f32_16x16x64_bf16 v[48:51], v[24:27], v[168:175], v119
v_smfmac_f32_16x16x64_bf16 v[52:55], v[24:27], v[224:231], v119
s_waitcnt lgkmcnt(6)
v_smfmac_f32_16x16x64_bf16 v[28:31], v[0:3], a[32:39], v119
s_waitcnt lgkmcnt(5)
v_smfmac_f32_16x16x64_bf16 v[28:31], v[4:7], a[40:47], v119
s_waitcnt lgkmcnt(4)
v_smfmac_f32_16x16x64_bf16 v[28:31], v[8:11], a[48:55], v119
s_mov_b32 m0, s35
v_smfmac_f32_16x16x64_bf16 v[32:35], v[0:3], a[88:95], v119
v_smfmac_f32_16x16x64_bf16 v[32:35], v[4:7], a[96:103], v119
v_add_f32 v92, v28, v30
v_smfmac_f32_16x16x64_bf16 v[32:35], v[8:11], a[104:111], v119
v_add_f32 v93, v29, v31
v_smfmac_f32_16x16x64_bf16 v[36:39], v[0:3], a[144:151], v119
v_cmp_u_f32 vcc, v92, v93
v_cvt_pk_bf16_f32 v94, v92, v93
v_smfmac_f32_16x16x64_bf16 v[36:39], v[4:7], a[152:159], v119
ds_write_addtid_b32 v94 offset:32768
v_add_f32 v92, v32, v34
v_smfmac_f32_16x16x64_bf16 v[36:39], v[8:11], a[160:167], v119
s_cbranch_vccnz RAy_lretry
RAy_lok:
v_add_f32 v93, v33, v35
v_smfmac_f32_16x16x64_bf16 v[40:43], v[0:3], a[200:207], v119
ds_read_b128 v[20:23], v103 offset:2048
v_cvt_pk_bf16_f32 v94, v92, v93
v_smfmac_f32_16x16x64_bf16 v[40:43], v[4:7], a[208:215], v119
ds_write_addtid_b32 v94 offset:33040
ds_read_b128 v[24:27], v103 offset:3072
v_add_f32 v92, v36, v38
v_smfmac_f32_16x16x64_bf16 v[40:43], v[8:11], a[216:223], v119
ds_read_b128 v[28:31], v103 offset:6144
v_add_f32 v93, v37, v39
v_smfmac_f32_16x16x64_bf16 v[44:47], v[0:3], v[120:127], v119
ds_read_b128 v[32:35], v103 offset:7168
v_cvt_pk_bf16_f32 v94, v92, v93
v_smfmac_f32_16x16x64_bf16 v[44:47], v[4:7], v[128:135], v119
ds_write_addtid_b32 v94 offset:33312
ds_read_b64 v[12:13], v108 offset:1024
ds_read_b64 v[14:15], v108 offset:1056
v_add_f32 v92, v40, v42
v_smfmac_f32_16x16x64_bf16 v[44:47], v[8:11], v[136:143], v119
ds_read_b64 v[16:17], v107 offset:0
ds_read_b64 v[18:19], v107 offset:32
v_add_f32 v93, v41, v43
v_smfmac_f32_16x16x64_bf16 v[48:51], v[0:3], v[176:183], v119
v_cvt_pk_bf16_f32 v94, v92, v93
v_smfmac_f32_16x16x64_bf16 v[48:51], v[4:7], v[184:191], v119
ds_write_addtid_b32 v94 offset:33584
v_add_f32 v92, v44, v46
v_smfmac_f32_16x16x64_bf16 v[48:51], v[8:11], v[192:199], v119
ds_read_b64_tr_b16 v[36:37], v104
v_add_f32 v93, v45, v47
v_smfmac_f32_16x16x64_bf16 v[52:55], v[0:3], v[232:239], v119
ds_read_b64_tr_b16 v[38:39], v104 offset:16
v_cvt_pk_bf16_f32 v94, v92, v93
v_smfmac_f32_16x16x64_bf16 v[52:55], v[4:7], v[240:247], v119
ds_write_addtid_b32 v94 offset:33856
v_add_f32 v92, v48, v50
v_smfmac_f32_16x16x64_bf16 v[52:55], v[8:11], v[248:255], v119
v_add_f32 v93, v49, v51
s_waitcnt lgkmcnt(1)
v_smfmac_f32_16x16x64_bf16 v[84:87], v[36:39], v[64:71], v119
v_cvt_pk_bf16_f32 v94, v92, v93
v_smfmac_f32_16x16x64_bf16 v[88:91], v[36:39], v[72:79], v119
ds_write_addtid_b32 v94 offset:34128
v_add_f32 v92, v52, v54
v_add_f32 v93, v53, v55
v_cvt_pk_bf16_f32 v94, v92, v93
ds_write_addtid_b32 v94 offset:34400
ds_read_b64_tr_b16 v[40:41], v105
ds_read_b64_tr_b16 v[42:43], v105 offset:16
v_swap_b32 v57, v58
v_swap_b32 v61, v62
v_swap_b32 v13, v14
v_swap_b32 v17, v18
v_smfmac_f32_16x16x64_bf16 v[80:83], v[36:39], v[56:63], v119
s_waitcnt lgkmcnt(0)
v_smfmac_f32_16x16x64_bf16 v[84:87], v[40:43], v[20:27], v119
v_smfmac_f32_16x16x64_bf16 v[88:91], v[40:43], v[28:35], v119
v_smfmac_f32_16x16x64_bf16 v[80:83], v[40:43], v[12:19], v119
v_add_f32 v58, v84, v86
v_add_f32 v59, v85, v87
ds_write_addtid_b32 v58 offset:35648
ds_write_addtid_b32 v59 offset:35936
v_add_f32 v60, v88, v90
v_add_f32 v61, v89, v91
ds_write_addtid_b32 v60 offset:36224
ds_write_addtid_b32 v61 offset:36512
v_add_f32 v56, v80, v82
v_add_f32 v57, v81, v83
ds_write_addtid_b32 v56 offset:35072
ds_write_addtid_b32 v57 offset:35360
s_waitcnt lgkmcnt(0)
s_barrier
ds_read_b64 v[64:65], v101 offset:0
ds_read_b64 v[66:67], v101 offset:4096
ds_read_b64 v[68:69], v101 offset:8192
ds_read_b64 v[70:71], v101 offset:12288
s_waitcnt lgkmcnt(2)
v_pk_add_f32 v[64:65], v[64:65], v[66:67]
s_waitcnt lgkmcnt(0)
v_pk_add_f32 v[68:69], v[68:69], v[70:71]
v_pk_add_f32 v[64:65], v[64:65], v[68:69]
v_max_f32 v66, v64, v65
s_nop 1
v_max_f32_dpp v66, v66, v66 row_ror:8 row_mask:0xf bank_mask:0xf
s_nop 1
v_max_f32_dpp v66, v66, v66 row_ror:4 row_mask:0xf bank_mask:0xf
s_nop 1
v_max_f32_dpp v66, v66, v66 row_ror:2 row_mask:0xf bank_mask:0xf
s_nop 1
v_max_f32_dpp v66, v66, v66 row_ror:1 row_mask:0xf bank_mask:0xf
v_mov_b32 v67, v66
s_nop 1
v_permlane16_swap_b32 v66, v67
v_max_f32 v66, v66, v67
v_pk_add_f32 v[64:65], v[64:65], v[66:67] op_sel_hi:[1,0] neg_lo:[0,1] neg_hi:[0,1]
v_exp_f32 v64, v64
v_exp_f32 v65, v65
buffer_store_dword v95, v116, s[4:7], 0 offen sc1
v_add_f32 v66, v64, v65
s_nop 1
v_add_f32_dpp v66, v66, v66 row_ror:8 row_mask:0xf bank_mask:0xf
s_nop 1
v_add_f32_dpp v66, v66, v66 row_ror:4 row_mask:0xf bank_mask:0xf
s_nop 1
v_add_f32_dpp v66, v66, v66 row_ror:2 row_mask:0xf bank_mask:0xf
s_nop 1
v_add_f32_dpp v66, v66, v66 row_ror:1 row_mask:0xf bank_mask:0xf
v_mov_b32 v67, v66
s_nop 1
v_permlane16_swap_b32 v66, v67
v_add_f32 v66, v66, v67
v_rcp_f32 v66, v66
s_nop 0
v_pk_mul_f32 v[64:65], v[64:65], v[66:67] op_sel_hi:[1,0]
v_cvt_pk_bf16_f32 v64, v64, v65
v_min_u32 v64, -2, v64
buffer_store_dword v64, v100, s[4:7], s27 offen sc1
v_mov_b64 v[28:29], 0
v_mov_b64 v[30:31], 0
v_mov_b64 v[32:33], 0
v_mov_b64 v[34:35], 0
v_mov_b64 v[36:37], 0
v_mov_b64 v[38:39], 0
v_mov_b64 v[40:41], 0
v_mov_b64 v[42:43], 0
v_mov_b64 v[44:45], 0
v_mov_b64 v[46:47], 0
v_mov_b64 v[48:49], 0
v_mov_b64 v[50:51], 0
v_mov_b64 v[52:53], 0
v_mov_b64 v[54:55], 0
v_mov_b64 v[80:81], 0
v_mov_b64 v[82:83], 0
v_mov_b64 v[84:85], 0
v_mov_b64 v[86:87], 0
v_mov_b64 v[88:89], 0
v_mov_b64 v[90:91], 0
v_xor_b32 v103, 0x8000, v103
v_mov_b32 v65, -1
buffer_store_dword v65, v100, s[4:7], s28 offen sc1
s_mov_b32 m0, s50
s_nop 0
buffer_load_dwordx4 v118, s[4:7], s46 offen offset:0  lds
buffer_load_dwordx4 v118, s[4:7], s46 offen offset:1024  lds
buffer_load_dwordx4 v118, s[4:7], s46 offen offset:2048  lds
s_mov_b32 m0, s51
s_nop 0
buffer_load_dwordx4 v118, s[4:7], s47 offen offset:0  lds
s_mov_b32 s19, 524288
s_mov_b32 s8, s31
s_cmp_lt_u32 s8, 63
s_cbranch_scc1 RAy_loop
s_endpgm
RAy_lretry:
v_max3_u32 v95, v0, v1, v2
v_max3_u32 v95, v95, v3, v4
v_max3_u32 v95, v95, v5, v6
v_max3_u32 v95, v95, v7, v8
v_max3_u32 v95, v95, v9, v10
v_max_u32 v95, v95, v11
v_cmp_eq_u32 vcc, -1, v95
v_mov_b32 v95, s31
s_cbranch_vccz RAy_lok
s_add_u32 s20, s20, 1
s_sub_u32 s19, s19, 16
s_cbranch_scc1 R_exit
s_waitcnt vmcnt(0) lgkmcnt(0)
s_barrier
v_mov_b64 v[28:29], 0
v_mov_b64 v[30:31], 0
v_mov_b64 v[32:33], 0
v_mov_b64 v[34:35], 0
v_mov_b64 v[36:37], 0
v_mov_b64 v[38:39], 0
v_mov_b64 v[40:41], 0
v_mov_b64 v[42:43], 0
v_mov_b64 v[44:45], 0
v_mov_b64 v[46:47], 0
v_mov_b64 v[48:49], 0
v_mov_b64 v[50:51], 0
v_mov_b64 v[52:53], 0
v_mov_b64 v[54:55], 0
s_branch RAy_again
R_exit:
s_endpgm
M_B:
s_add_u32 s39, s10, 1
v_and_b32 v0, 63, v0
v_mov_b32 v55, 0x44444444
v_mov_b32 v54, 0xeeeeeeee
v_and_b32 v53, 2, v0
v_mov_b32 v52, 1
v_cmp_lt_u32 vcc, v53, v52
s_nop 1
v_cndmask_b32 v119, v54, v55, vcc
v_lshlrev_b32 v118, 4, v0
s_lshl_b32 s33, s9, 1
s_add_u32 s33, s33, 0
s_cmp_ge_u32 s33, 7
s_cselect_b32 s35, 7, 0
s_sub_u32 s33, s33, s35
s_cmp_ge_u32 s33, 7
s_cselect_b32 s35, 7, 0
s_sub_u32 s33, s33, s35
s_cmp_ge_u32 s33, 7
s_cselect_b32 s35, 7, 0
s_sub_u32 s33, s33, s35
s_add_u32 s34, s33, 0
s_cmp_ge_u32 s34, 7
s_cselect_b32 s35, 7, 0
s_sub_u32 s34, s34, s35
s_lshl_b32 s12, s34, 10
s_add_u32 s34, s33, 1
s_cmp_ge_u32 s34, 7
s_cselect_b32 s35, 7, 0
s_sub_u32 s34, s34, s35
s_lshl_b32 s13, s34, 10
s_add_u32 s34, s33, 2
s_cmp_ge_u32 s34, 7
s_cselect_b32 s35, 7, 0
s_sub_u32 s34, s34, s35
s_lshl_b32 s14, s34, 10
s_add_u32 s34, s33, 3
s_cmp_ge_u32 s34, 7
s_cselect_b32 s35, 7, 0
s_sub_u32 s34, s34, s35
s_lshl_b32 s15, s34, 10
s_add_u32 s34, s33, 4
s_cmp_ge_u32 s34, 7
s_cselect_b32 s35, 7, 0
s_sub_u32 s34, s34, s35
s_lshl_b32 s16, s34, 10
s_add_u32 s34, s33, 5
s_cmp_ge_u32 s34, 7
s_cselect_b32 s35, 7, 0
s_sub_u32 s34, s34, s35
s_lshl_b32 s17, s34, 10
s_add_u32 s34, s33, 6
s_cmp_ge_u32 s34, 7
s_cselect_b32 s35, 7, 0
s_sub_u32 s34, s34, s35
s_lshl_b32 s18, s34, 10
v_lshlrev_b32 v52, 4, v0
v_add_u32 v1, 0x20000, v52
v_add_u32 v115, s12, v1
v_add_u32 v114, s13, v1
v_add_u32 v113, s14, v1
v_add_u32 v112, s15, v1
v_add_u32 v111, s16, v1
v_add_u32 v110, s17, v1
v_add_u32 v109, s18, v1
s_cmp_lg_u32 s9, 3
s_cbranch_scc1 RB_w3skip
v_add_u32 v114, 7168, v1
RB_w3skip:
v_mov_b32 v51, s9
v_lshlrev_b32 v55, 6, v51
v_and_b32 v51, 15, v0
v_add_u32 v54, v55, v51
v_lshlrev_b32 v53, 4, v54
v_add_u32 v52, 0x18000, v53
v_lshrrev_b32 v54, 4, v0
v_lshlrev_b32 v53, 2, v54
v_add_u32 v108, v52, v53
v_mov_b32 v50, s9
v_lshlrev_b32 v55, 2, v50
v_add_u32 v51, 0, v55
v_mov_b32 v55, 56
v_mul_lo_u32 v54, v51, v55
v_lshrrev_b32 v55, 4, v0
v_add_u32 v52, v54, v55
v_mov_b32 v55, 0x1c00
v_mul_lo_u32 v53, v52, v55
v_mov_b32 v51, s10
v_lshlrev_b32 v54, 4, v51
v_and_b32 v51, 15, v0
v_add_u32 v52, v54, v51
v_lshlrev_b32 v55, 4, v52
v_add_u32 v20, v53, v55
v_mov_b32 v50, s9
v_lshlrev_b32 v54, 2, v50
v_add_u32 v51, 1, v54
v_mov_b32 v54, 56
v_mul_lo_u32 v52, v51, v54
v_lshrrev_b32 v54, 4, v0
v_add_u32 v53, v52, v54
v_mov_b32 v54, 0x1c00
v_mul_lo_u32 v55, v53, v54
v_mov_b32 v51, s10
v_lshlrev_b32 v52, 4, v51
v_and_b32 v51, 15, v0
v_add_u32 v53, v52, v51
v_lshlrev_b32 v54, 4, v53
v_add_u32 v21, v55, v54
v_mov_b32 v50, s9
v_lshlrev_b32 v52, 2, v50
v_add_u32 v51, 2, v52
v_mov_b32 v52, 56
v_mul_lo_u32 v53, v51, v52
v_lshrrev_b32 v52, 4, v0
v_add_u32 v55, v53, v52
v_mov_b32 v52, 0x1c00
v_mul_lo_u32 v54, v55, v52
v_mov_b32 v51, s10
v_lshlrev_b32 v53, 4, v51
v_and_b32 v51, 15, v0
v_add_u32 v55, v53, v51
v_lshlrev_b32 v52, 4, v55
v_add_u32 v22, v54, v52
v_mov_b32 v50, s9
v_lshlrev_b32 v53, 2, v50
v_add_u32 v51, 3, v53
v_mov_b32 v53, 56
v_mul_lo_u32 v55, v51, v53
v_lshrrev_b32 v53, 4, v0
v_add_u32 v54, v55, v53
v_mov_b32 v53, 0x1c00
v_mul_lo_u32 v52, v54, v53
v_mov_b32 v51, s10
v_lshlrev_b32 v55, 4, v51
v_and_b32 v51, 15, v0
v_add_u32 v54, v55, v51
v_lshlrev_b32 v53, 4, v54
v_add_u32 v23, v52, v53
v_mov_b32 v50, s9
v_lshlrev_b32 v55, 2, v50
v_and_b32 v47, 15, v0
v_add_u32 v48, 0, v47
v_mov_b32 v47, 0x5556
v_mul_lo_u32 v49, v48, v47
v_lshrrev_b32 v50, 18, v49
v_add_u32 v51, v55, v50
v_mov_b32 v50, 56
v_mul_lo_u32 v54, v51, v50
v_lshrrev_b32 v50, 4, v0
v_add_u32 v52, v54, v50
v_mov_b32 v50, 0x1c00
v_mul_lo_u32 v53, v52, v50
v_mov_b32 v49, s10
v_mov_b32 v47, 12
v_mul_lo_u32 v55, v49, v47
v_add_u32 v51, 0x100, v55
v_and_b32 v47, 15, v0
v_add_u32 v55, 0, v47
v_add_u32 v54, v51, v55
v_and_b32 v48, 15, v0
v_add_u32 v49, 0, v48
v_mov_b32 v48, 0x5556
v_mul_lo_u32 v47, v49, v48
v_lshrrev_b32 v51, 18, v47
v_mov_b32 v47, 12
v_mul_lo_u32 v55, v51, v47
v_sub_u32 v52, v54, v55
v_lshlrev_b32 v50, 4, v52
v_add_u32 v24, v53, v50
v_mov_b32 v47, s9
v_lshlrev_b32 v54, 2, v47
v_and_b32 v49, 15, v0
v_add_u32 v48, 16, v49
v_mov_b32 v49, 0x5556
v_mul_lo_u32 v51, v48, v49
v_lshrrev_b32 v47, 18, v51
v_add_u32 v55, v54, v47
v_mov_b32 v47, 56
v_mul_lo_u32 v52, v55, v47
v_lshrrev_b32 v47, 4, v0
v_add_u32 v53, v52, v47
v_mov_b32 v47, 0x1c00
v_mul_lo_u32 v50, v53, v47
v_mov_b32 v51, s10
v_mov_b32 v49, 12
v_mul_lo_u32 v54, v51, v49
v_add_u32 v55, 0x100, v54
v_and_b32 v49, 15, v0
v_add_u32 v54, 16, v49
v_add_u32 v52, v55, v54
v_and_b32 v48, 15, v0
v_add_u32 v51, 16, v48
v_mov_b32 v48, 0x5556
v_mul_lo_u32 v49, v51, v48
v_lshrrev_b32 v55, 18, v49
v_mov_b32 v49, 12
v_mul_lo_u32 v54, v55, v49
v_sub_u32 v53, v52, v54
v_lshlrev_b32 v47, 4, v53
v_add_u32 v25, v50, v47
v_mov_b32 v49, s9
v_lshlrev_b32 v52, 2, v49
v_and_b32 v51, 15, v0
v_add_u32 v48, 32, v51
v_mov_b32 v51, 0x5556
v_mul_lo_u32 v55, v48, v51
v_lshrrev_b32 v49, 18, v55
v_add_u32 v54, v52, v49
v_mov_b32 v49, 56
v_mul_lo_u32 v53, v54, v49
v_lshrrev_b32 v49, 4, v0
v_add_u32 v50, v53, v49
v_mov_b32 v49, 0x1c00
v_mul_lo_u32 v47, v50, v49
v_mov_b32 v55, s10
v_mov_b32 v51, 12
v_mul_lo_u32 v52, v55, v51
v_add_u32 v54, 0x100, v52
v_and_b32 v51, 15, v0
v_add_u32 v52, 32, v51
v_add_u32 v53, v54, v52
v_and_b32 v48, 15, v0
v_add_u32 v55, 32, v48
v_mov_b32 v48, 0x5556
v_mul_lo_u32 v51, v55, v48
v_lshrrev_b32 v54, 18, v51
v_mov_b32 v51, 12
v_mul_lo_u32 v52, v54, v51
v_sub_u32 v50, v53, v52
v_lshlrev_b32 v49, 4, v50
v_add_u32 v26, v47, v49
s_add_u32 s48, 0, 0
s_and_b32 s48, s48, 3
s_lshl_b32 s48, s48, 11
s_add_u32 s49, 0, 1
s_and_b32 s49, s49, 3
s_lshl_b32 s49, s49, 11
s_add_u32 s50, 0, 2
s_and_b32 s50, s50, 3
s_lshl_b32 s50, s50, 11
s_add_u32 s51, 0, 3
s_and_b32 s51, s51, 3
s_lshl_b32 s51, s51, 11
s_cmp_lg_u32 s9, 0
s_cbranch_scc1 RB_wb_go
v_lshlrev_b32 v11, 7, v0
v_add_u32 v12, 0x3432000, v11
v_mov_b32 v11, 0x343e000
v_mov_b32 v10, 16
v_cmp_lt_u32 vcc, v0, v10
s_nop 1
v_cndmask_b32 v1, v11, v12, vcc
v_mov_b32 v10, 14
v_mov_b32 v11, 32
v_mov_b32 v12, 16
v_cmp_lt_u32 vcc, v0, v12
s_nop 1
v_cndmask_b32 v2, v11, v10, vcc
s_mov_b32 s19, 0x40000
RB_wb:
buffer_load_dword v3, v1, s[4:7], 0 offen sc1
s_sub_u32 s19, s19, 1
s_cbranch_scc1 R_exit
s_waitcnt vmcnt(0)
v_cmp_gt_u32 vcc, v2, v3
s_cbranch_vccnz RB_wb
RB_wb_go:
s_barrier
s_lshl_b32 s11, s9, 1
s_add_u32 s11, s11, 0
s_lshl_b32 s33, s11, 10
s_add_u32 s33, s33, 53477376
s_cmp_eq_u32 s11, s10
s_cselect_b32 s52, s33, 1073741824
s_cmp_eq_u32 s11, 7
s_cselect_b32 s52, 1073741824, s52
s_lshl_b32 s11, s9, 1
s_add_u32 s11, s11, 1
s_lshl_b32 s33, s11, 10
s_add_u32 s33, s33, 53477376
s_cmp_eq_u32 s11, s10
s_cselect_b32 s53, s33, 1073741824
s_cmp_eq_u32 s11, 7
s_cselect_b32 s53, 1073741824, s53
s_cmp_ge_u32 s9, 2
s_cbranch_scc1 RB_loader
v_lshrrev_b32 v52, 4, v0
v_mov_b32 v53, 28
v_mul_lo_u32 v50, v52, v53
v_mov_b32 v54, s9
v_lshlrev_b32 v51, 4, v54
v_and_b32 v54, 15, v0
v_add_u32 v52, v51, v54
v_min_u32 v53, 27, v52
v_add_u32 v47, v50, v53
v_lshlrev_b32 v49, 4, v47
v_add_u32 v107, 0, v49
v_lshrrev_b32 v52, 4, v0
v_lshlrev_b32 v50, 4, v52
v_and_b32 v52, 15, v0
v_add_u32 v53, v50, v52
v_lshrrev_b32 v51, 4, v0
v_mov_b32 v48, 12
v_mul_lo_u32 v54, v51, v48
v_add_u32 v50, 0x100, v54
v_and_b32 v48, 15, v0
v_min_u32 v54, 11, v48
v_add_u32 v52, v50, v54
v_mov_b32 v54, 1
v_cmp_lt_u32 vcc, s9, v54
s_nop 1
v_cndmask_b32 v47, v52, v53, vcc
v_lshlrev_b32 v49, 4, v47
v_add_u32 v106, 0x18000, v49
v_mov_b32 v51, s10
v_lshlrev_b32 v48, 4, v51
v_mov_b32 v45, s9
v_lshlrev_b32 v46, 4, v45
v_and_b32 v45, 15, v0
v_add_u32 v55, v46, v45
v_and_b32 v51, 30, v55
v_add_u32 v50, v48, v51
v_mov_b32 v45, s10
v_mov_b32 v46, 12
v_mul_lo_u32 v55, v45, v46
v_mov_b32 v43, s9
v_lshlrev_b32 v44, 4, v43
v_and_b32 v43, 15, v0
v_add_u32 v45, v44, v43
v_and_b32 v46, 30, v45
v_add_u32 v48, v55, v46
v_add_u32 v51, 0xf0, v48
v_mov_b32 v45, s9
v_lshlrev_b32 v55, 4, v45
v_and_b32 v45, 15, v0
v_add_u32 v46, v55, v45
v_and_b32 v48, 30, v46
v_mov_b32 v46, 16
v_cmp_lt_u32 vcc, v48, v46
s_nop 1
v_cndmask_b32 v53, v51, v50, vcc
v_lshrrev_b32 v52, 6, v53
v_lshlrev_b32 v54, 10, v52
v_mov_b32 v42, s10
v_lshlrev_b32 v44, 4, v42
v_mov_b32 v39, s9
v_lshlrev_b32 v40, 4, v39
v_and_b32 v39, 15, v0
v_add_u32 v41, v40, v39
v_and_b32 v42, 30, v41
v_add_u32 v43, v44, v42
v_mov_b32 v39, s10
v_mov_b32 v40, 12
v_mul_lo_u32 v41, v39, v40
v_mov_b32 v37, s9
v_lshlrev_b32 v38, 4, v37
v_and_b32 v37, 15, v0
v_add_u32 v39, v38, v37
v_and_b32 v40, 30, v39
v_add_u32 v44, v41, v40
v_add_u32 v42, 0xf0, v44
v_mov_b32 v39, s9
v_lshlrev_b32 v41, 4, v39
v_and_b32 v39, 15, v0
v_add_u32 v40, v41, v39
v_and_b32 v44, 30, v40
v_mov_b32 v40, 16
v_cmp_lt_u32 vcc, v44, v40
s_nop 1
v_cndmask_b32 v55, v42, v43, vcc
v_and_b32 v45, 63, v55
v_lshrrev_b32 v50, 4, v45
v_lshlrev_b32 v51, 4, v50
v_lshrrev_b32 v44, 4, v0
v_lshlrev_b32 v40, 1, v44
v_and_b32 v42, 15, v0
v_and_b32 v44, 1, v42
v_add_u32 v55, v40, v44
v_lshrrev_b32 v45, 1, v55
v_lshlrev_b32 v50, 2, v45
v_add_u32 v48, v51, v50
v_mov_b32 v43, s10
v_lshlrev_b32 v42, 4, v43
v_mov_b32 v37, s9
v_lshlrev_b32 v41, 4, v37
v_and_b32 v37, 15, v0
v_add_u32 v39, v41, v37
v_and_b32 v43, 30, v39
v_add_u32 v40, v42, v43
v_mov_b32 v37, s10
v_mov_b32 v41, 12
v_mul_lo_u32 v39, v37, v41
v_mov_b32 v36, s9
v_lshlrev_b32 v38, 4, v36
v_and_b32 v36, 15, v0
v_add_u32 v37, v38, v36
v_and_b32 v41, 30, v37
v_add_u32 v42, v39, v41
v_add_u32 v43, 0xf0, v42
v_mov_b32 v37, s9
v_lshlrev_b32 v39, 4, v37
v_and_b32 v37, 15, v0
v_add_u32 v41, v39, v37
v_and_b32 v42, 30, v41
v_mov_b32 v41, 16
v_cmp_lt_u32 vcc, v42, v41
s_nop 1
v_cndmask_b32 v44, v43, v40, vcc
v_and_b32 v55, 63, v44
v_lshrrev_b32 v45, 1, v55
v_and_b32 v51, 1, v45
v_lshlrev_b32 v50, 1, v51
v_add_u32 v46, v48, v50
v_lshrrev_b32 v45, 4, v0
v_lshlrev_b32 v51, 1, v45
v_and_b32 v55, 15, v0
v_and_b32 v45, 1, v55
v_add_u32 v48, v51, v45
v_and_b32 v50, 1, v48
v_add_u32 v53, v46, v50
v_lshlrev_b32 v52, 4, v53
v_add_u32 v47, v54, v52
v_mov_b32 v51, s10
v_lshlrev_b32 v45, 4, v51
v_mov_b32 v41, s9
v_lshlrev_b32 v44, 4, v41
v_and_b32 v41, 15, v0
v_add_u32 v55, v44, v41
v_and_b32 v51, 30, v55
v_add_u32 v48, v45, v51
v_mov_b32 v41, s10
v_mov_b32 v44, 12
v_mul_lo_u32 v55, v41, v44
v_mov_b32 v43, s9
v_lshlrev_b32 v42, 4, v43
v_and_b32 v43, 15, v0
v_add_u32 v41, v42, v43
v_and_b32 v44, 30, v41
v_add_u32 v45, v55, v44
v_add_u32 v51, 0xf0, v45
v_mov_b32 v41, s9
v_lshlrev_b32 v55, 4, v41
v_and_b32 v41, 15, v0
v_add_u32 v44, v55, v41
v_and_b32 v45, 30, v44
v_mov_b32 v44, 16
v_cmp_lt_u32 vcc, v45, v44
s_nop 1
v_cndmask_b32 v46, v51, v48, vcc
v_and_b32 v50, 63, v46
v_lshrrev_b32 v53, 2, v50
v_and_b32 v54, 3, v53
v_lshlrev_b32 v52, 2, v54
v_add_u32 v49, v47, v52
v_mov_b32 v52, 0x40000000
v_mov_b32 v53, s9
v_lshlrev_b32 v54, 4, v53
v_and_b32 v53, 15, v0
v_add_u32 v47, v54, v53
v_mov_b32 v53, 28
v_cmp_lt_u32 vcc, v47, v53
s_nop 1
v_cndmask_b32 v105, v52, v49, vcc
v_mov_b32 v53, 0x5040100
v_mov_b32 v47, 0x3020706
v_and_b32 v49, 15, v0
v_and_b32 v52, 1, v49
v_mov_b32 v49, 1
v_cmp_lt_u32 vcc, v52, v49
s_nop 1
v_cndmask_b32 v104, v47, v53, vcc
s_lshl_b32 s54, s10, 2
s_add_u32 s54, s54, 54657024
v_mov_b32 v116, v107
s_mov_b32 s47, 0
v_and_b32 v52, 15, v0
v_lshlrev_b32 v49, 2, v52
v_add_u32 v117, 0x3428000, v49
s_mul_i32 s11, s12, 56
s_add_u32 s11, s11, 9437184
buffer_load_dwordx4 a[0:3], v20, s[4:7], s11 offen
s_mul_i32 s11, s12, 56
s_add_u32 s11, s11, 9465856
buffer_load_dwordx4 a[4:7], v20, s[4:7], s11 offen
s_mul_i32 s11, s13, 56
s_add_u32 s11, s11, 9437184
buffer_load_dwordx4 a[8:11], v20, s[4:7], s11 offen
s_mul_i32 s11, s13, 56
s_add_u32 s11, s11, 9465856
buffer_load_dwordx4 a[12:15], v20, s[4:7], s11 offen
s_mul_i32 s11, s14, 56
s_add_u32 s11, s11, 9437184
buffer_load_dwordx4 a[16:19], v20, s[4:7], s11 offen
s_mul_i32 s11, s14, 56
s_add_u32 s11, s11, 9465856
buffer_load_dwordx4 a[20:23], v20, s[4:7], s11 offen
s_mul_i32 s11, s15, 56
s_add_u32 s11, s11, 9437184
buffer_load_dwordx4 a[24:27], v20, s[4:7], s11 offen
s_mul_i32 s11, s15, 56
s_add_u32 s11, s11, 9465856
buffer_load_dwordx4 a[28:31], v20, s[4:7], s11 offen
s_mul_i32 s11, s16, 56
s_add_u32 s11, s11, 9437184
buffer_load_dwordx4 a[32:35], v20, s[4:7], s11 offen
s_mul_i32 s11, s16, 56
s_add_u32 s11, s11, 9465856
buffer_load_dwordx4 a[36:39], v20, s[4:7], s11 offen
s_mul_i32 s11, s17, 56
s_add_u32 s11, s11, 9437184
buffer_load_dwordx4 a[40:43], v20, s[4:7], s11 offen
s_mul_i32 s11, s17, 56
s_add_u32 s11, s11, 9465856
buffer_load_dwordx4 a[44:47], v20, s[4:7], s11 offen
s_mul_i32 s11, s18, 56
s_add_u32 s11, s11, 9437184
buffer_load_dwordx4 a[48:51], v20, s[4:7], s11 offen
s_mul_i32 s11, s18, 56
s_add_u32 s11, s11, 9465856
buffer_load_dwordx4 a[52:55], v20, s[4:7], s11 offen
s_mul_i32 s11, s12, 56
s_add_u32 s11, s11, 9437184
buffer_load_dwordx4 a[56:59], v21, s[4:7], s11 offen
s_mul_i32 s11, s12, 56
s_add_u32 s11, s11, 9465856
buffer_load_dwordx4 a[60:63], v21, s[4:7], s11 offen
s_waitcnt vmcnt(32)
s_mul_i32 s11, s13, 56
s_add_u32 s11, s11, 9437184
buffer_load_dwordx4 a[64:67], v21, s[4:7], s11 offen
s_mul_i32 s11, s13, 56
s_add_u32 s11, s11, 9465856
buffer_load_dwordx4 a[68:71], v21, s[4:7], s11 offen
s_mul_i32 s11, s14, 56
s_add_u32 s11, s11, 9437184
buffer_load_dwordx4 a[72:75], v21, s[4:7], s11 offen
s_mul_i32 s11, s14, 56
s_add_u32 s11, s11, 9465856
buffer_load_dwordx4 a[76:79], v21, s[4:7], s11 offen
s_mul_i32 s11, s15, 56
s_add_u32 s11, s11, 9437184
buffer_load_dwordx4 a[80:83], v21, s[4:7], s11 offen
s_mul_i32 s11, s15, 56
s_add_u32 s11, s11, 9465856
buffer_load_dwordx4 a[84:87], v21, s[4:7], s11 offen
s_mul_i32 s11, s16, 56
s_add_u32 s11, s11, 9437184
buffer_load_dwordx4 a[88:91], v21, s[4:7], s11 offen
s_mul_i32 s11, s16, 56
s_add_u32 s11, s11, 9465856
buffer_load_dwordx4 a[92:95], v21, s[4:7], s11 offen
s_mul_i32 s11, s17, 56
s_add_u32 s11, s11, 9437184
buffer_load_dwordx4 a[96:99], v21, s[4:7], s11 offen
s_mul_i32 s11, s17, 56
s_add_u32 s11, s11, 9465856
buffer_load_dwordx4 a[100:103], v21, s[4:7], s11 offen
s_mul_i32 s11, s18, 56
s_add_u32 s11, s11, 9437184
buffer_load_dwordx4 a[104:107], v21, s[4:7], s11 offen
s_mul_i32 s11, s18, 56
s_add_u32 s11, s11, 9465856
buffer_load_dwordx4 a[108:111], v21, s[4:7], s11 offen
s_mul_i32 s11, s12, 56
s_add_u32 s11, s11, 9437184
buffer_load_dwordx4 a[112:115], v22, s[4:7], s11 offen
s_mul_i32 s11, s12, 56
s_add_u32 s11, s11, 9465856
buffer_load_dwordx4 a[116:119], v22, s[4:7], s11 offen
s_mul_i32 s11, s13, 56
s_add_u32 s11, s11, 9437184
buffer_load_dwordx4 a[120:123], v22, s[4:7], s11 offen
s_mul_i32 s11, s13, 56
s_add_u32 s11, s11, 9465856
buffer_load_dwordx4 a[124:127], v22, s[4:7], s11 offen
s_waitcnt vmcnt(32)
s_mul_i32 s11, s14, 56
s_add_u32 s11, s11, 9437184
buffer_load_dwordx4 a[128:131], v22, s[4:7], s11 offen
s_mul_i32 s11, s14, 56
s_add_u32 s11, s11, 9465856
buffer_load_dwordx4 a[132:135], v22, s[4:7], s11 offen
s_mul_i32 s11, s15, 56
s_add_u32 s11, s11, 9437184
buffer_load_dwordx4 a[136:139], v22, s[4:7], s11 offen
s_mul_i32 s11, s15, 56
s_add_u32 s11, s11, 9465856
buffer_load_dwordx4 a[140:143], v22, s[4:7], s11 offen
s_mul_i32 s11, s16, 56
s_add_u32 s11, s11, 9437184
buffer_load_dwordx4 a[144:147], v22, s[4:7], s11 offen
s_mul_i32 s11, s16, 56
s_add_u32 s11, s11, 9465856
buffer_load_dwordx4 a[148:151], v22, s[4:7], s11 offen
s_mul_i32 s11, s17, 56
s_add_u32 s11, s11, 9437184
buffer_load_dwordx4 a[152:155], v22, s[4:7], s11 offen
s_mul_i32 s11, s17, 56
s_add_u32 s11, s11, 9465856
buffer_load_dwordx4 a[156:159], v22, s[4:7], s11 offen
s_mul_i32 s11, s18, 56
s_add_u32 s11, s11, 9437184
buffer_load_dwordx4 a[160:163], v22, s[4:7], s11 offen
s_mul_i32 s11, s18, 56
s_add_u32 s11, s11, 9465856
buffer_load_dwordx4 a[164:167], v22, s[4:7], s11 offen
s_mul_i32 s11, s12, 56
s_add_u32 s11, s11, 9437184
buffer_load_dwordx4 a[168:171], v23, s[4:7], s11 offen
s_mul_i32 s11, s12, 56
s_add_u32 s11, s11, 9465856
buffer_load_dwordx4 a[172:175], v23, s[4:7], s11 offen
s_mul_i32 s11, s13, 56
s_add_u32 s11, s11, 9437184
buffer_load_dwordx4 a[176:179], v23, s[4:7], s11 offen
s_mul_i32 s11, s13, 56
s_add_u32 s11, s11, 9465856
buffer_load_dwordx4 a[180:183], v23, s[4:7], s11 offen
s_mul_i32 s11, s14, 56
s_add_u32 s11, s11, 9437184
buffer_load_dwordx4 a[184:187], v23, s[4:7], s11 offen
s_mul_i32 s11, s14, 56
s_add_u32 s11, s11, 9465856
buffer_load_dwordx4 a[188:191], v23, s[4:7], s11 offen
s_waitcnt vmcnt(32)
s_mul_i32 s11, s15, 56
s_add_u32 s11, s11, 9437184
buffer_load_dwordx4 a[192:195], v23, s[4:7], s11 offen
s_mul_i32 s11, s15, 56
s_add_u32 s11, s11, 9465856
buffer_load_dwordx4 a[196:199], v23, s[4:7], s11 offen
s_mul_i32 s11, s16, 56
s_add_u32 s11, s11, 9437184
buffer_load_dwordx4 a[200:203], v23, s[4:7], s11 offen
s_mul_i32 s11, s16, 56
s_add_u32 s11, s11, 9465856
buffer_load_dwordx4 a[204:207], v23, s[4:7], s11 offen
s_mul_i32 s11, s17, 56
s_add_u32 s11, s11, 9437184
buffer_load_dwordx4 a[208:211], v23, s[4:7], s11 offen
s_mul_i32 s11, s17, 56
s_add_u32 s11, s11, 9465856
buffer_load_dwordx4 a[212:215], v23, s[4:7], s11 offen
s_mul_i32 s11, s18, 56
s_add_u32 s11, s11, 9437184
buffer_load_dwordx4 a[216:219], v23, s[4:7], s11 offen
s_mul_i32 s11, s18, 56
s_add_u32 s11, s11, 9465856
buffer_load_dwordx4 a[220:223], v23, s[4:7], s11 offen
s_mul_i32 s11, s12, 56
s_add_u32 s11, s11, 9437184
buffer_load_dwordx4 a[224:227], v24, s[4:7], s11 offen
s_mul_i32 s11, s12, 56
s_add_u32 s11, s11, 9465856
buffer_load_dwordx4 a[228:231], v24, s[4:7], s11 offen
s_mul_i32 s11, s13, 56
s_add_u32 s11, s11, 9437184
buffer_load_dwordx4 a[232:235], v24, s[4:7], s11 offen
s_mul_i32 s11, s13, 56
s_add_u32 s11, s11, 9465856
buffer_load_dwordx4 a[236:239], v24, s[4:7], s11 offen
s_mul_i32 s11, s14, 56
s_add_u32 s11, s11, 9437184
buffer_load_dwordx4 a[240:243], v24, s[4:7], s11 offen
s_mul_i32 s11, s14, 56
s_add_u32 s11, s11, 9465856
buffer_load_dwordx4 a[244:247], v24, s[4:7], s11 offen
s_mul_i32 s11, s15, 56
s_add_u32 s11, s11, 9437184
buffer_load_dwordx4 a[248:251], v24, s[4:7], s11 offen
s_mul_i32 s11, s15, 56
s_add_u32 s11, s11, 9465856
buffer_load_dwordx4 a[252:255], v24, s[4:7], s11 offen
s_waitcnt vmcnt(32)
s_mul_i32 s11, s16, 56
s_add_u32 s11, s11, 9437184
buffer_load_dwordx4 v[120:123], v24, s[4:7], s11 offen
s_mul_i32 s11, s16, 56
s_add_u32 s11, s11, 9465856
buffer_load_dwordx4 v[124:127], v24, s[4:7], s11 offen
s_mul_i32 s11, s17, 56
s_add_u32 s11, s11, 9437184
buffer_load_dwordx4 v[128:131], v24, s[4:7], s11 offen
s_mul_i32 s11, s17, 56
s_add_u32 s11, s11, 9465856
buffer_load_dwordx4 v[132:135], v24, s[4:7], s11 offen
s_mul_i32 s11, s18, 56
s_add_u32 s11, s11, 9437184
buffer_load_dwordx4 v[136:139], v24, s[4:7], s11 offen
s_mul_i32 s11, s18, 56
s_add_u32 s11, s11, 9465856
buffer_load_dwordx4 v[140:143], v24, s[4:7], s11 offen
s_mul_i32 s11, s12, 56
s_add_u32 s11, s11, 9437184
buffer_load_dwordx4 v[144:147], v25, s[4:7], s11 offen
s_mul_i32 s11, s12, 56
s_add_u32 s11, s11, 9465856
buffer_load_dwordx4 v[148:151], v25, s[4:7], s11 offen
s_mul_i32 s11, s13, 56
s_add_u32 s11, s11, 9437184
buffer_load_dwordx4 v[152:155], v25, s[4:7], s11 offen
s_mul_i32 s11, s13, 56
s_add_u32 s11, s11, 9465856
buffer_load_dwordx4 v[156:159], v25, s[4:7], s11 offen
s_mul_i32 s11, s14, 56
s_add_u32 s11, s11, 9437184
buffer_load_dwordx4 v[160:163], v25, s[4:7], s11 offen
s_mul_i32 s11, s14, 56
s_add_u32 s11, s11, 9465856
buffer_load_dwordx4 v[164:167], v25, s[4:7], s11 offen
s_mul_i32 s11, s15, 56
s_add_u32 s11, s11, 9437184
buffer_load_dwordx4 v[168:171], v25, s[4:7], s11 offen
s_mul_i32 s11, s15, 56
s_add_u32 s11, s11, 9465856
buffer_load_dwordx4 v[172:175], v25, s[4:7], s11 offen
s_mul_i32 s11, s16, 56
s_add_u32 s11, s11, 9437184
buffer_load_dwordx4 v[176:179], v25, s[4:7], s11 offen
s_mul_i32 s11, s16, 56
s_add_u32 s11, s11, 9465856
buffer_load_dwordx4 v[180:183], v25, s[4:7], s11 offen
s_waitcnt vmcnt(32)
s_mul_i32 s11, s17, 56
s_add_u32 s11, s11, 9437184
buffer_load_dwordx4 v[184:187], v25, s[4:7], s11 offen
s_mul_i32 s11, s17, 56
s_add_u32 s11, s11, 9465856
buffer_load_dwordx4 v[188:191], v25, s[4:7], s11 offen
s_mul_i32 s11, s18, 56
s_add_u32 s11, s11, 9437184
buffer_load_dwordx4 v[192:195], v25, s[4:7], s11 offen
s_mul_i32 s11, s18, 56
s_add_u32 s11, s11, 9465856
buffer_load_dwordx4 v[196:199], v25, s[4:7], s11 offen
s_mul_i32 s11, s12, 56
s_add_u32 s11, s11, 9437184
buffer_load_dwordx4 v[200:203], v26, s[4:7], s11 offen
s_mul_i32 s11, s12, 56
s_add_u32 s11, s11, 9465856
buffer_load_dwordx4 v[204:207], v26, s[4:7], s11 offen
s_mul_i32 s11, s13, 56
s_add_u32 s11, s11, 9437184
buffer_load_dwordx4 v[208:211], v26, s[4:7], s11 offen
s_mul_i32 s11, s13, 56
s_add_u32 s11, s11, 9465856
buffer_load_dwordx4 v[212:215], v26, s[4:7], s11 offen
s_mul_i32 s11, s14, 56
s_add_u32 s11, s11, 9437184
buffer_load_dwordx4 v[216:219], v26, s[4:7], s11 offen
s_mul_i32 s11, s14, 56
s_add_u32 s11, s11, 9465856
buffer_load_dwordx4 v[220:223], v26, s[4:7], s11 offen
s_lshl_b32 s33, s3, 2
s_add_u32 s33, s33, s9
s_getpc_b64 s[56:57]
CT_3:
s_add_u32 s56, s56, M_rec-CT_3
s_addc_u32 s57, s57, (M_rec-CT_3)>>32
s_mov_b32 s58, M_end-M_rec
s_mov_b32 s59, 0x20000
s_lshl_b32 s11, s33, 9
v_lshlrev_b32 v2, 3, v0
buffer_load_dword v102, v2, s[56:59], s11 offen
s_mul_i32 s11, s15, 56
s_add_u32 s11, s11, 9437184
buffer_load_dwordx4 v[224:227], v26, s[4:7], s11 offen
s_mul_i32 s11, s15, 56
s_add_u32 s11, s11, 9465856
buffer_load_dwordx4 v[228:231], v26, s[4:7], s11 offen
s_mul_i32 s11, s16, 56
s_add_u32 s11, s11, 9437184
buffer_load_dwordx4 v[232:235], v26, s[4:7], s11 offen
s_mul_i32 s11, s16, 56
s_add_u32 s11, s11, 9465856
buffer_load_dwordx4 v[236:239], v26, s[4:7], s11 offen
s_mul_i32 s11, s17, 56
s_add_u32 s11, s11, 9437184
buffer_load_dwordx4 v[240:243], v26, s[4:7], s11 offen
s_mul_i32 s11, s17, 56
s_add_u32 s11, s11, 9465856
buffer_load_dwordx4 v[244:247], v26, s[4:7], s11 offen
s_waitcnt vmcnt(32)
s_mul_i32 s11, s18, 56
s_add_u32 s11, s11, 9437184
buffer_load_dwordx4 v[248:251], v26, s[4:7], s11 offen
s_mul_i32 s11, s18, 56
s_add_u32 s11, s11, 9465856
buffer_load_dwordx4 v[252:255], v26, s[4:7], s11 offen
v_mov_b64 v[28:29], 0
v_mov_b64 v[30:31], 0
v_mov_b64 v[32:33], 0
v_mov_b64 v[34:35], 0
v_mov_b64 v[36:37], 0
v_mov_b64 v[38:39], 0
v_mov_b64 v[40:41], 0
v_mov_b64 v[42:43], 0
v_mov_b64 v[44:45], 0
v_mov_b64 v[46:47], 0
v_mov_b64 v[48:49], 0
v_mov_b64 v[50:51], 0
v_mov_b64 v[52:53], 0
v_mov_b64 v[54:55], 0
s_mov_b32 s8, 0
s_mov_b32 s19, 524288
s_mov_b32 s20, 0
s_mov_b32 s19, 524288
s_waitcnt vmcnt(0) lgkmcnt(0)
s_cmp_eq_u32 s9, 1
s_cbranch_scc1 RB_second
s_cmp_lg_u32 s30, 0
s_cbranch_scc1 RBf_slow
s_and_b32 s11, s8, 3
s_lshl_b32 s33, s11, 13
s_add_u32 s33, s33, 54525952
s_add_u32 s36, s33, s12
s_add_u32 s37, s33, s13
s_add_u32 s38, s33, s14
s_add_u32 s31, s8, 1
s_barrier
buffer_load_dwordx4 v[16:19], v118, s[4:7], s36 offen sc1
buffer_load_dwordx4 v[20:23], v118, s[4:7], s37 offen sc1
RBfx_loop:
s_and_b32 s11, s8, 3
s_add_u32 s31, s8, 1
s_lshl_b32 s11, s11, 14
s_add_u32 s11, s11, 54591488
s_add_u32 s46, s11, 8192
s_add_u32 s22, s11, s48
s_add_u32 s23, s11, s49
s_add_u32 s24, s11, s50
s_add_u32 s45, s11, s51
s_and_b32 s11, s31, 3
s_lshl_b32 s11, s11, 13
s_add_u32 s27, s11, 54525952
s_xor_b32 s28, s27, 0x4000
v_mov_b32 v103, s31
v_mov_b64 v[96:97], 0
v_mov_b64 v[98:99], 0
RBfx_mload:
buffer_load_dwordx4 v[16:19], v118, s[4:7], s36 offen sc1
buffer_load_dwordx4 v[20:23], v118, s[4:7], s37 offen sc1
s_waitcnt vmcnt(2)
v_max3_u32 v100, v16, v17, v18
v_max3_u32 v100, v100, v19, v20
v_max3_u32 v100, v100, v21, v22
v_max_u32 v100, v100, v23
v_cmp_eq_u32 vcc, -1, v100
s_sub_u32 s19, s19, 1
s_cbranch_scc1 R_exit
s_cbranch_vccnz RBfx_mload
v_smfmac_f32_16x16x64_bf16 v[28:31], v[16:19], a[0:7], v119
ds_write_b128 v115, v[16:19]
v_smfmac_f32_16x16x64_bf16 v[32:35], v[16:19], a[56:63], v119
ds_write_b128 v114, v[20:23]
v_smfmac_f32_16x16x64_bf16 v[36:39], v[16:19], a[112:119], v119
v_smfmac_f32_16x16x64_bf16 v[40:43], v[16:19], a[168:175], v119
v_smfmac_f32_16x16x64_bf16 v[44:47], v[16:19], a[224:231], v119
v_smfmac_f32_16x16x64_bf16 v[48:51], v[16:19], v[144:151], v119
s_waitcnt lgkmcnt(0)
s_barrier
ds_read_b128 v[24:27], v113
v_smfmac_f32_16x16x64_bf16 v[52:55], v[16:19], v[200:207], v119
ds_read_b128 v[0:3], v112
v_smfmac_f32_16x16x64_bf16 v[28:31], v[20:23], a[8:15], v119
ds_read_b128 v[4:7], v111
v_smfmac_f32_16x16x64_bf16 v[32:35], v[20:23], a[64:71], v119
ds_read_b128 v[8:11], v110
v_smfmac_f32_16x16x64_bf16 v[36:39], v[20:23], a[120:127], v119
ds_read_b128 v[12:15], v109
v_smfmac_f32_16x16x64_bf16 v[40:43], v[20:23], a[176:183], v119
ds_read_b128 v[56:59], v107 offset:0
v_smfmac_f32_16x16x64_bf16 v[44:47], v[20:23], a[232:239], v119
ds_read_b128 v[60:63], v107 offset:1792
v_smfmac_f32_16x16x64_bf16 v[48:51], v[20:23], v[152:159], v119
ds_read_b128 v[64:67], v107 offset:3584
v_smfmac_f32_16x16x64_bf16 v[52:55], v[20:23], v[208:215], v119
ds_read_b128 v[68:71], v107 offset:5376
s_waitcnt lgkmcnt(8)
v_smfmac_f32_16x16x64_bf16 v[28:31], v[24:27], a[16:23], v119
ds_read_b128 v[72:75], v107 offset:7168
v_smfmac_f32_16x16x64_bf16 v[32:35], v[24:27], a[72:79], v119
ds_read_b128 v[76:79], v107 offset:8960
v_smfmac_f32_16x16x64_bf16 v[36:39], v[24:27], a[128:135], v119
ds_read_b128 v[80:83], v107 offset:10752
v_smfmac_f32_16x16x64_bf16 v[40:43], v[24:27], a[184:191], v119
ds_read_b128 v[84:87], v107 offset:12544
v_smfmac_f32_16x16x64_bf16 v[44:47], v[24:27], a[240:247], v119
ds_read_b128 v[88:91], v107 offset:14336
v_smfmac_f32_16x16x64_bf16 v[48:51], v[24:27], v[160:167], v119
ds_read_b128 v[92:95], v107 offset:16128
s_waitcnt vmcnt(0)
v_smfmac_f32_16x16x64_bf16 v[52:55], v[24:27], v[216:223], v119
s_waitcnt lgkmcnt(13)
v_smfmac_f32_16x16x64_bf16 v[28:31], v[0:3], a[24:31], v119
s_waitcnt lgkmcnt(12)
v_smfmac_f32_16x16x64_bf16 v[28:31], v[4:7], a[32:39], v119
s_waitcnt lgkmcnt(11)
v_smfmac_f32_16x16x64_bf16 v[28:31], v[8:11], a[40:47], v119
s_waitcnt lgkmcnt(10)
v_smfmac_f32_16x16x64_bf16 v[28:31], v[12:15], a[48:55], v119
v_smfmac_f32_16x16x64_bf16 v[32:35], v[0:3], a[80:87], v119
v_smfmac_f32_16x16x64_bf16 v[32:35], v[4:7], a[88:95], v119
v_add_f32 v100, v28, v30
v_smfmac_f32_16x16x64_bf16 v[32:35], v[8:11], a[96:103], v119
v_add_f32 v101, v29, v31
v_smfmac_f32_16x16x64_bf16 v[32:35], v[12:15], a[104:111], v119
v_cvt_pk_bf16_f32 v102, v100, v101
v_smfmac_f32_16x16x64_bf16 v[36:39], v[0:3], a[136:143], v119
ds_write_b32 v108, v102 offset:0
v_smfmac_f32_16x16x64_bf16 v[36:39], v[4:7], a[144:151], v119
v_add_f32 v100, v32, v34
v_smfmac_f32_16x16x64_bf16 v[36:39], v[8:11], a[152:159], v119
v_add_f32 v101, v33, v35
v_smfmac_f32_16x16x64_bf16 v[36:39], v[12:15], a[160:167], v119
v_cvt_pk_bf16_f32 v102, v100, v101
v_smfmac_f32_16x16x64_bf16 v[40:43], v[0:3], a[192:199], v119
ds_write_b32 v108, v102 offset:256
v_smfmac_f32_16x16x64_bf16 v[40:43], v[4:7], a[200:207], v119
v_add_f32 v100, v36, v38
v_smfmac_f32_16x16x64_bf16 v[40:43], v[8:11], a[208:215], v119
v_add_f32 v101, v37, v39
v_smfmac_f32_16x16x64_bf16 v[40:43], v[12:15], a[216:223], v119
v_cvt_pk_bf16_f32 v102, v100, v101
v_smfmac_f32_16x16x64_bf16 v[44:47], v[0:3], a[248:255], v119
ds_write_b32 v108, v102 offset:512
v_smfmac_f32_16x16x64_bf16 v[44:47], v[4:7], v[120:127], v119
v_add_f32 v100, v40, v42
v_smfmac_f32_16x16x64_bf16 v[44:47], v[8:11], v[128:135], v119
v_add_f32 v101, v41, v43
v_smfmac_f32_16x16x64_bf16 v[44:47], v[12:15], v[136:143], v119
v_cvt_pk_bf16_f32 v102, v100, v101
v_smfmac_f32_16x16x64_bf16 v[48:51], v[0:3], v[168:175], v119
ds_write_b32 v108, v102 offset:768
v_smfmac_f32_16x16x64_bf16 v[48:51], v[4:7], v[176:183], v119
v_add_f32 v100, v44, v46
v_smfmac_f32_16x16x64_bf16 v[48:51], v[8:11], v[184:191], v119
v_add_f32 v101, v45, v47
v_smfmac_f32_16x16x64_bf16 v[48:51], v[12:15], v[192:199], v119
v_cvt_pk_bf16_f32 v102, v100, v101
v_smfmac_f32_16x16x64_bf16 v[52:55], v[0:3], v[224:231], v119
ds_write_b32 v108, v102 offset:4096
v_smfmac_f32_16x16x64_bf16 v[52:55], v[4:7], v[232:239], v119
v_add_f32 v100, v48, v50
v_smfmac_f32_16x16x64_bf16 v[52:55], v[8:11], v[240:247], v119
v_add_f32 v101, v49, v51
v_smfmac_f32_16x16x64_bf16 v[52:55], v[12:15], v[248:255], v119
v_cvt_pk_bf16_f32 v102, v100, v101
ds_write_b32 v108, v102 offset:4352
s_nop 5
v_add_f32 v100, v52, v54
v_add_f32 v101, v53, v55
v_cvt_pk_bf16_f32 v102, v100, v101
ds_write_b32 v108, v102 offset:4608
ds_read_b128 v[40:43], v107 offset:17920
ds_read_b128 v[44:47], v107 offset:19712
ds_read_b128 v[48:51], v107 offset:21504
ds_read_b128 v[52:55], v107 offset:23296
s_add_u32 s36, s27, s12
s_add_u32 s37, s27, s13
s_waitcnt lgkmcnt(0)
v_mov_b32 v102, 0
s_mov_b32 exec_lo, 0xffff
s_mov_b32 exec_hi, 0
.p2align 6
RBfx_poll2:
buffer_load_dword v102, v117, s[4:7], 0 offen sc1
s_waitcnt vmcnt(40)
v_cmp_gt_u32 vcc, s31, v102
s_sub_u32 s19, s19, 1
s_cbranch_scc1 R_exit
s_cbranch_vccnz RBfx_poll2
s_mov_b64 exec, -1
buffer_load_dwordx4 v[0:3], v118, s[4:7], s22 offen offset:0 sc1
buffer_load_dwordx4 v[4:7], v118, s[4:7], s22 offen offset:1024 sc1
buffer_load_dwordx4 v[8:11], v118, s[4:7], s23 offen offset:0 sc1
buffer_load_dwordx4 v[12:15], v118, s[4:7], s23 offen offset:1024 sc1
buffer_load_dwordx4 v[16:19], v118, s[4:7], s24 offen offset:0 sc1
buffer_load_dwordx4 v[20:23], v118, s[4:7], s24 offen offset:1024 sc1
buffer_load_dwordx4 v[24:27], v118, s[4:7], s45 offen offset:0 sc1
buffer_load_dwordx4 v[28:31], v118, s[4:7], s45 offen offset:1024 sc1
buffer_load_dwordx4 v[32:35], v118, s[4:7], s46 offen offset:0 sc1
buffer_load_dwordx4 v[36:39], v118, s[4:7], s46 offen offset:1024 sc1
s_barrier
RBfx_pchain:
s_waitcnt vmcnt(9)
v_smfmac_f32_16x16x64_bf16 v[96:99], v[0:3], v[56:63], v119
ds_read_b128 v[56:59], v107 offset:25088
ds_read_b128 v[60:63], v107 offset:26880
s_waitcnt vmcnt(8)
v_smfmac_f32_16x16x64_bf16 v[96:99], v[4:7], v[64:71], v119
ds_read_b128 v[64:67], v106 offset:0
ds_read_b128 v[68:71], v106 offset:1024
s_waitcnt vmcnt(7)
v_smfmac_f32_16x16x64_bf16 v[96:99], v[8:11], v[72:79], v119
ds_read_b128 v[72:75], v106 offset:2048
ds_read_b128 v[76:79], v106 offset:3072
s_waitcnt vmcnt(6)
v_smfmac_f32_16x16x64_bf16 v[96:99], v[12:15], v[80:87], v119
s_waitcnt vmcnt(5)
v_smfmac_f32_16x16x64_bf16 v[96:99], v[16:19], v[88:95], v119
s_waitcnt vmcnt(4)
v_smfmac_f32_16x16x64_bf16 v[96:99], v[20:23], v[40:47], v119
s_waitcnt vmcnt(3)
v_smfmac_f32_16x16x64_bf16 v[96:99], v[24:27], v[48:55], v119
s_waitcnt vmcnt(2) lgkmcnt(4)
v_smfmac_f32_16x16x64_bf16 v[96:99], v[28:31], v[56:63], v119
s_waitcnt vmcnt(1) lgkmcnt(2)
v_smfmac_f32_16x16x64_bf16 v[96:99], v[32:35], v[64:71], v119
s_waitcnt vmcnt(0) lgkmcnt(0)
v_smfmac_f32_16x16x64_bf16 v[96:99], v[36:39], v[72:79], v119
s_nop 7
v_add_f32 v100, v96, v98
v_add_f32 v101, v97, v99
v_cvt_pk_bf16_f32 v96, v100, v101
v_cmp_u_f32 vcc, v100, v101
s_nop 0
v_mov_b32_dpp v101, v96 quad_perm:[1,0,3,2] row_mask:0xf bank_mask:0xf
v_perm_b32 v100, v101, v96, v104
v_min_u32 v100, -2, v100
s_cbranch_vccnz RBfx_pretry
RBfx_pok:
buffer_store_dword v100, v105, s[4:7], s27 offen
s_barrier
buffer_load_dwordx4 v[16:19], v118, s[4:7], s36 offen sc1
buffer_load_dwordx4 v[20:23], v118, s[4:7], s37 offen sc1
s_cmp_eq_u32 s8, 62
s_cbranch_scc1 RBfx_last
v_mov_b32 v101, -1
buffer_store_dword v101, v105, s[4:7], s28 offen
v_mov_b64 v[28:29], 0
v_mov_b64 v[30:31], 0
v_mov_b64 v[32:33], 0
v_mov_b64 v[34:35], 0
v_mov_b64 v[36:37], 0
v_mov_b64 v[38:39], 0
v_mov_b64 v[40:41], 0
v_mov_b64 v[42:43], 0
v_mov_b64 v[44:45], 0
v_mov_b64 v[46:47], 0
v_mov_b64 v[48:49], 0
v_mov_b64 v[50:51], 0
v_mov_b64 v[52:53], 0
v_mov_b64 v[54:55], 0
s_add_u32 s47, s47, 0x8000
s_cmp_eq_u32 s47, 0x18000
s_cselect_b32 s47, 0, s47
v_add_u32 v107, s47, v116
s_mov_b32 s19, 524288
s_mov_b32 s8, s31
s_branch RBfx_loop
RBfx_last:
s_mov_b32 s11, 53928960
buffer_store_dword v100, v105, s[4:7], s11 offen sc1
RBfx_done:
s_endpgm
RBfx_mretry:
s_add_u32 s20, s20, 1
s_sub_u32 s19, s19, 8
s_cbranch_scc1 R_exit
s_waitcnt vmcnt(0) lgkmcnt(0)
v_mov_b64 v[28:29], 0
v_mov_b64 v[30:31], 0
v_mov_b64 v[32:33], 0
v_mov_b64 v[34:35], 0
v_mov_b64 v[36:37], 0
v_mov_b64 v[38:39], 0
v_mov_b64 v[40:41], 0
v_mov_b64 v[42:43], 0
v_mov_b64 v[44:45], 0
v_mov_b64 v[46:47], 0
v_mov_b64 v[48:49], 0
v_mov_b64 v[50:51], 0
v_mov_b64 v[52:53], 0
v_mov_b64 v[54:55], 0
s_branch RBfx_mload
RBfx_pretry:
s_waitcnt vmcnt(0) lgkmcnt(0)
v_max3_u32 v102, v0, v1, v2
v_max3_u32 v102, v102, v3, v4
v_max3_u32 v102, v102, v5, v6
v_max3_u32 v102, v102, v7, v8
v_max3_u32 v102, v102, v9, v10
v_max3_u32 v102, v102, v11, v12
v_max3_u32 v102, v102, v13, v14
v_max3_u32 v102, v102, v15, v16
v_max3_u32 v102, v102, v17, v18
v_max3_u32 v102, v102, v19, v20
v_max3_u32 v102, v102, v21, v22
v_max3_u32 v102, v102, v23, v24
v_max3_u32 v102, v102, v25, v26
v_max3_u32 v102, v102, v27, v28
v_max3_u32 v102, v102, v29, v30
v_max3_u32 v102, v102, v31, v32
v_max3_u32 v102, v102, v33, v34
v_max3_u32 v102, v102, v35, v36
v_max3_u32 v102, v102, v37, v38
v_max_u32 v102, v102, v39
v_cmp_eq_u32 vcc, -1, v102
s_cbranch_vccz RBfx_pok
s_add_u32 s20, s20, 0x10000
s_sub_u32 s19, s19, 8
s_cbranch_scc1 R_exit
ds_read_b128 v[56:59], v107 offset:0
ds_read_b128 v[60:63], v107 offset:1792
ds_read_b128 v[64:67], v107 offset:3584
ds_read_b128 v[68:71], v107 offset:5376
ds_read_b128 v[72:75], v107 offset:7168
ds_read_b128 v[76:79], v107 offset:8960
v_mov_b64 v[96:97], 0
v_mov_b64 v[98:99], 0
s_waitcnt lgkmcnt(0)
buffer_load_dwordx4 v[0:3], v118, s[4:7], s22 offen offset:0 sc1
buffer_load_dwordx4 v[4:7], v118, s[4:7], s22 offen offset:1024 sc1
buffer_load_dwordx4 v[8:11], v118, s[4:7], s23 offen offset:0 sc1
buffer_load_dwordx4 v[12:15], v118, s[4:7], s23 offen offset:1024 sc1
buffer_load_dwordx4 v[16:19], v118, s[4:7], s24 offen offset:0 sc1
buffer_load_dwordx4 v[20:23], v118, s[4:7], s24 offen offset:1024 sc1
buffer_load_dwordx4 v[24:27], v118, s[4:7], s45 offen offset:0 sc1
buffer_load_dwordx4 v[28:31], v118, s[4:7], s45 offen offset:1024 sc1
buffer_load_dwordx4 v[32:35], v118, s[4:7], s46 offen offset:0 sc1
buffer_load_dwordx4 v[36:39], v118, s[4:7], s46 offen offset:1024 sc1
s_cmp_eq_u32 0, 0
s_branch RBfx_pchain
RBf_slow:
s_and_b32 s11, s8, 3
s_lshl_b32 s33, s11, 13
s_add_u32 s33, s33, 54525952
s_add_u32 s36, s33, s12
s_add_u32 s37, s33, s13
s_add_u32 s38, s33, s14
s_add_u32 s31, s8, 1
s_barrier
buffer_load_dwordx4 v[16:19], v118, s[4:7], s36 offen sc1
buffer_load_dwordx4 v[20:23], v118, s[4:7], s37 offen sc1
RBfy_loop:
s_and_b32 s11, s8, 3
s_add_u32 s31, s8, 1
s_lshl_b32 s11, s11, 14
s_add_u32 s11, s11, 54591488
s_add_u32 s46, s11, 8192
s_add_u32 s22, s11, s48
s_add_u32 s23, s11, s49
s_add_u32 s24, s11, s50
s_add_u32 s45, s11, s51
s_and_b32 s11, s31, 3
s_lshl_b32 s11, s11, 13
s_add_u32 s27, s11, 54525952
s_xor_b32 s28, s27, 0x4000
v_mov_b32 v103, s31
v_mov_b64 v[96:97], 0
v_mov_b64 v[98:99], 0
RBfy_mload:
buffer_load_dwordx4 v[16:19], v118, s[4:7], s36 offen sc1
buffer_load_dwordx4 v[20:23], v118, s[4:7], s37 offen sc1
s_waitcnt vmcnt(2)
v_max3_u32 v100, v16, v17, v18
v_max3_u32 v100, v100, v19, v20
v_max3_u32 v100, v100, v21, v22
v_max_u32 v100, v100, v23
v_cmp_eq_u32 vcc, -1, v100
s_sub_u32 s19, s19, 1
s_cbranch_scc1 R_exit
s_cbranch_vccnz RBfy_mload
v_smfmac_f32_16x16x64_bf16 v[28:31], v[16:19], a[0:7], v119
ds_write_b128 v115, v[16:19]
v_smfmac_f32_16x16x64_bf16 v[32:35], v[16:19], a[56:63], v119
ds_write_b128 v114, v[20:23]
v_smfmac_f32_16x16x64_bf16 v[36:39], v[16:19], a[112:119], v119
v_smfmac_f32_16x16x64_bf16 v[40:43], v[16:19], a[168:175], v119
v_smfmac_f32_16x16x64_bf16 v[44:47], v[16:19], a[224:231], v119
v_smfmac_f32_16x16x64_bf16 v[48:51], v[16:19], v[144:151], v119
s_waitcnt lgkmcnt(0)
s_barrier
ds_read_b128 v[24:27], v113
v_smfmac_f32_16x16x64_bf16 v[52:55], v[16:19], v[200:207], v119
ds_read_b128 v[0:3], v112
v_smfmac_f32_16x16x64_bf16 v[28:31], v[20:23], a[8:15], v119
ds_read_b128 v[4:7], v111
v_smfmac_f32_16x16x64_bf16 v[32:35], v[20:23], a[64:71], v119
ds_read_b128 v[8:11], v110
v_smfmac_f32_16x16x64_bf16 v[36:39], v[20:23], a[120:127], v119
ds_read_b128 v[12:15], v109
v_smfmac_f32_16x16x64_bf16 v[40:43], v[20:23], a[176:183], v119
ds_read_b128 v[56:59], v107 offset:0
v_smfmac_f32_16x16x64_bf16 v[44:47], v[20:23], a[232:239], v119
ds_read_b128 v[60:63], v107 offset:1792
v_smfmac_f32_16x16x64_bf16 v[48:51], v[20:23], v[152:159], v119
ds_read_b128 v[64:67], v107 offset:3584
v_smfmac_f32_16x16x64_bf16 v[52:55], v[20:23], v[208:215], v119
ds_read_b128 v[68:71], v107 offset:5376
s_waitcnt lgkmcnt(8)
v_smfmac_f32_16x16x64_bf16 v[28:31], v[24:27], a[16:23], v119
ds_read_b128 v[72:75], v107 offset:7168
v_smfmac_f32_16x16x64_bf16 v[32:35], v[24:27], a[72:79], v119
ds_read_b128 v[76:79], v107 offset:8960
v_smfmac_f32_16x16x64_bf16 v[36:39], v[24:27], a[128:135], v119
ds_read_b128 v[80:83], v107 offset:10752
v_smfmac_f32_16x16x64_bf16 v[40:43], v[24:27], a[184:191], v119
ds_read_b128 v[84:87], v107 offset:12544
v_smfmac_f32_16x16x64_bf16 v[44:47], v[24:27], a[240:247], v119
ds_read_b128 v[88:91], v107 offset:14336
v_smfmac_f32_16x16x64_bf16 v[48:51], v[24:27], v[160:167], v119
ds_read_b128 v[92:95], v107 offset:16128
s_waitcnt vmcnt(0)
v_smfmac_f32_16x16x64_bf16 v[52:55], v[24:27], v[216:223], v119
s_waitcnt lgkmcnt(13)
v_smfmac_f32_16x16x64_bf16 v[28:31], v[0:3], a[24:31], v119
s_waitcnt lgkmcnt(12)
v_smfmac_f32_16x16x64_bf16 v[28:31], v[4:7], a[32:39], v119
s_waitcnt lgkmcnt(11)
v_smfmac_f32_16x16x64_bf16 v[28:31], v[8:11], a[40:47], v119
s_waitcnt lgkmcnt(10)
v_smfmac_f32_16x16x64_bf16 v[28:31], v[12:15], a[48:55], v119
v_smfmac_f32_16x16x64_bf16 v[32:35], v[0:3], a[80:87], v119
v_smfmac_f32_16x16x64_bf16 v[32:35], v[4:7], a[88:95], v119
v_add_f32 v100, v28, v30
v_smfmac_f32_16x16x64_bf16 v[32:35], v[8:11], a[96:103], v119
v_add_f32 v101, v29, v31
v_smfmac_f32_16x16x64_bf16 v[32:35], v[12:15], a[104:111], v119
v_cvt_pk_bf16_f32 v102, v100, v101
v_smfmac_f32_16x16x64_bf16 v[36:39], v[0:3], a[136:143], v119
ds_write_b32 v108, v102 offset:0
v_smfmac_f32_16x16x64_bf16 v[36:39], v[4:7], a[144:151], v119
v_add_f32 v100, v32, v34
v_smfmac_f32_16x16x64_bf16 v[36:39], v[8:11], a[152:159], v119
v_add_f32 v101, v33, v35
v_smfmac_f32_16x16x64_bf16 v[36:39], v[12:15], a[160:167], v119
v_cvt_pk_bf16_f32 v102, v100, v101
v_smfmac_f32_16x16x64_bf16 v[40:43], v[0:3], a[192:199], v119
ds_write_b32 v108, v102 offset:256
v_smfmac_f32_16x16x64_bf16 v[40:43], v[4:7], a[200:207], v119
v_add_f32 v100, v36, v38
v_smfmac_f32_16x16x64_bf16 v[40:43], v[8:11], a[208:215], v119
v_add_f32 v101, v37, v39
v_smfmac_f32_16x16x64_bf16 v[40:43], v[12:15], a[216:223], v119
v_cvt_pk_bf16_f32 v102, v100, v101
v_smfmac_f32_16x16x64_bf16 v[44:47], v[0:3], a[248:255], v119
ds_write_b32 v108, v102 offset:512
v_smfmac_f32_16x16x64_bf16 v[44:47], v[4:7], v[120:127], v119
v_add_f32 v100, v40, v42
v_smfmac_f32_16x16x64_bf16 v[44:47], v[8:11], v[128:135], v119
v_add_f32 v101, v41, v43
v_smfmac_f32_16x16x64_bf16 v[44:47], v[12:15], v[136:143], v119
v_cvt_pk_bf16_f32 v102, v100, v101
v_smfmac_f32_16x16x64_bf16 v[48:51], v[0:3], v[168:175], v119
ds_write_b32 v108, v102 offset:768
v_smfmac_f32_16x16x64_bf16 v[48:51], v[4:7], v[176:183], v119
v_add_f32 v100, v44, v46
v_smfmac_f32_16x16x64_bf16 v[48:51], v[8:11], v[184:191], v119
v_add_f32 v101, v45, v47
v_smfmac_f32_16x16x64_bf16 v[48:51], v[12:15], v[192:199], v119
v_cvt_pk_bf16_f32 v102, v100, v101
v_smfmac_f32_16x16x64_bf16 v[52:55], v[0:3], v[224:231], v119
ds_write_b32 v108, v102 offset:4096
v_smfmac_f32_16x16x64_bf16 v[52:55], v[4:7], v[232:239], v119
v_add_f32 v100, v48, v50
v_smfmac_f32_16x16x64_bf16 v[52:55], v[8:11], v[240:247], v119
v_add_f32 v101, v49, v51
v_smfmac_f32_16x16x64_bf16 v[52:55], v[12:15], v[248:255], v119
v_cvt_pk_bf16_f32 v102, v100, v101
ds_write_b32 v108, v102 offset:4352
s_nop 5
v_add_f32 v100, v52, v54
v_add_f32 v101, v53, v55
v_cvt_pk_bf16_f32 v102, v100, v101
ds_write_b32 v108, v102 offset:4608
ds_read_b128 v[40:43], v107 offset:17920
ds_read_b128 v[44:47], v107 offset:19712
ds_read_b128 v[48:51], v107 offset:21504
ds_read_b128 v[52:55], v107 offset:23296
s_add_u32 s36, s27, s12
s_add_u32 s37, s27, s13
s_waitcnt lgkmcnt(0)
v_mov_b32 v102, 0
s_mov_b32 exec_lo, 0xffff
s_mov_b32 exec_hi, 0
.p2align 6
RBfy_poll2:
buffer_load_dword v102, v117, s[4:7], 0 offen sc1
s_waitcnt vmcnt(40)
v_cmp_gt_u32 vcc, s31, v102
s_sub_u32 s19, s19, 1
s_cbranch_scc1 R_exit
s_cbranch_vccnz RBfy_poll2
s_mov_b64 exec, -1
buffer_load_dwordx4 v[0:3], v118, s[4:7], s22 offen offset:0 sc1
buffer_load_dwordx4 v[4:7], v118, s[4:7], s22 offen offset:1024 sc1
buffer_load_dwordx4 v[8:11], v118, s[4:7], s23 offen offset:0 sc1
buffer_load_dwordx4 v[12:15], v118, s[4:7], s23 offen offset:1024 sc1
buffer_load_dwordx4 v[16:19], v118, s[4:7], s24 offen offset:0 sc1
buffer_load_dwordx4 v[20:23], v118, s[4:7], s24 offen offset:1024 sc1
buffer_load_dwordx4 v[24:27], v118, s[4:7], s45 offen offset:0 sc1
buffer_load_dwordx4 v[28:31], v118, s[4:7], s45 offen offset:1024 sc1
buffer_load_dwordx4 v[32:35], v118, s[4:7], s46 offen offset:0 sc1
buffer_load_dwordx4 v[36:39], v118, s[4:7], s46 offen offset:1024 sc1
s_barrier
RBfy_pchain:
s_waitcnt vmcnt(9)
v_smfmac_f32_16x16x64_bf16 v[96:99], v[0:3], v[56:63], v119
ds_read_b128 v[56:59], v107 offset:25088
ds_read_b128 v[60:63], v107 offset:26880
s_waitcnt vmcnt(8)
v_smfmac_f32_16x16x64_bf16 v[96:99], v[4:7], v[64:71], v119
ds_read_b128 v[64:67], v106 offset:0
ds_read_b128 v[68:71], v106 offset:1024
s_waitcnt vmcnt(7)
v_smfmac_f32_16x16x64_bf16 v[96:99], v[8:11], v[72:79], v119
ds_read_b128 v[72:75], v106 offset:2048
ds_read_b128 v[76:79], v106 offset:3072
s_waitcnt vmcnt(6)
v_smfmac_f32_16x16x64_bf16 v[96:99], v[12:15], v[80:87], v119
s_waitcnt vmcnt(5)
v_smfmac_f32_16x16x64_bf16 v[96:99], v[16:19], v[88:95], v119
s_waitcnt vmcnt(4)
v_smfmac_f32_16x16x64_bf16 v[96:99], v[20:23], v[40:47], v119
s_waitcnt vmcnt(3)
v_smfmac_f32_16x16x64_bf16 v[96:99], v[24:27], v[48:55], v119
s_waitcnt vmcnt(2) lgkmcnt(4)
v_smfmac_f32_16x16x64_bf16 v[96:99], v[28:31], v[56:63], v119
s_waitcnt vmcnt(1) lgkmcnt(2)
v_smfmac_f32_16x16x64_bf16 v[96:99], v[32:35], v[64:71], v119
s_waitcnt vmcnt(0) lgkmcnt(0)
v_smfmac_f32_16x16x64_bf16 v[96:99], v[36:39], v[72:79], v119
s_nop 7
v_add_f32 v100, v96, v98
v_add_f32 v101, v97, v99
v_cvt_pk_bf16_f32 v96, v100, v101
v_cmp_u_f32 vcc, v100, v101
s_nop 0
v_mov_b32_dpp v101, v96 quad_perm:[1,0,3,2] row_mask:0xf bank_mask:0xf
v_perm_b32 v100, v101, v96, v104
v_min_u32 v100, -2, v100
s_cbranch_vccnz RBfy_pretry
RBfy_pok:
buffer_store_dword v100, v105, s[4:7], s27 offen sc1
s_barrier
buffer_load_dwordx4 v[16:19], v118, s[4:7], s36 offen sc1
buffer_load_dwordx4 v[20:23], v118, s[4:7], s37 offen sc1
s_cmp_eq_u32 s8, 62
s_cbranch_scc1 RBfy_last
v_mov_b32 v101, -1
buffer_store_dword v101, v105, s[4:7], s28 offen sc1
v_mov_b64 v[28:29], 0
v_mov_b64 v[30:31], 0
v_mov_b64 v[32:33], 0
v_mov_b64 v[34:35], 0
v_mov_b64 v[36:37], 0
v_mov_b64 v[38:39], 0
v_mov_b64 v[40:41], 0
v_mov_b64 v[42:43], 0
v_mov_b64 v[44:45], 0
v_mov_b64 v[46:47], 0
v_mov_b64 v[48:49], 0
v_mov_b64 v[50:51], 0
v_mov_b64 v[52:53], 0
v_mov_b64 v[54:55], 0
s_add_u32 s47, s47, 0x8000
s_cmp_eq_u32 s47, 0x18000
s_cselect_b32 s47, 0, s47
v_add_u32 v107, s47, v116
s_mov_b32 s19, 524288
s_mov_b32 s8, s31
s_branch RBfy_loop
RBfy_last:
s_mov_b32 s11, 53928960
buffer_store_dword v100, v105, s[4:7], s11 offen sc1
RBfy_done:
s_endpgm
RBfy_mretry:
s_add_u32 s20, s20, 1
s_sub_u32 s19, s19, 8
s_cbranch_scc1 R_exit
s_waitcnt vmcnt(0) lgkmcnt(0)
v_mov_b64 v[28:29], 0
v_mov_b64 v[30:31], 0
v_mov_b64 v[32:33], 0
v_mov_b64 v[34:35], 0
v_mov_b64 v[36:37], 0
v_mov_b64 v[38:39], 0
v_mov_b64 v[40:41], 0
v_mov_b64 v[42:43], 0
v_mov_b64 v[44:45], 0
v_mov_b64 v[46:47], 0
v_mov_b64 v[48:49], 0
v_mov_b64 v[50:51], 0
v_mov_b64 v[52:53], 0
v_mov_b64 v[54:55], 0
s_branch RBfy_mload
RBfy_pretry:
s_waitcnt vmcnt(0) lgkmcnt(0)
v_max3_u32 v102, v0, v1, v2
v_max3_u32 v102, v102, v3, v4
v_max3_u32 v102, v102, v5, v6
v_max3_u32 v102, v102, v7, v8
v_max3_u32 v102, v102, v9, v10
v_max3_u32 v102, v102, v11, v12
v_max3_u32 v102, v102, v13, v14
v_max3_u32 v102, v102, v15, v16
v_max3_u32 v102, v102, v17, v18
v_max3_u32 v102, v102, v19, v20
v_max3_u32 v102, v102, v21, v22
v_max3_u32 v102, v102, v23, v24
v_max3_u32 v102, v102, v25, v26
v_max3_u32 v102, v102, v27, v28
v_max3_u32 v102, v102, v29, v30
v_max3_u32 v102, v102, v31, v32
v_max3_u32 v102, v102, v33, v34
v_max3_u32 v102, v102, v35, v36
v_max3_u32 v102, v102, v37, v38
v_max_u32 v102, v102, v39
v_cmp_eq_u32 vcc, -1, v102
s_cbranch_vccz RBfy_pok
s_add_u32 s20, s20, 0x10000
s_sub_u32 s19, s19, 8
s_cbranch_scc1 R_exit
ds_read_b128 v[56:59], v107 offset:0
ds_read_b128 v[60:63], v107 offset:1792
ds_read_b128 v[64:67], v107 offset:3584
ds_read_b128 v[68:71], v107 offset:5376
ds_read_b128 v[72:75], v107 offset:7168
ds_read_b128 v[76:79], v107 offset:8960
v_mov_b64 v[96:97], 0
v_mov_b64 v[98:99], 0
s_waitcnt lgkmcnt(0)
buffer_load_dwordx4 v[0:3], v118, s[4:7], s22 offen offset:0 sc1
buffer_load_dwordx4 v[4:7], v118, s[4:7], s22 offen offset:1024 sc1
buffer_load_dwordx4 v[8:11], v118, s[4:7], s23 offen offset:0 sc1
buffer_load_dwordx4 v[12:15], v118, s[4:7], s23 offen offset:1024 sc1
buffer_load_dwordx4 v[16:19], v118, s[4:7], s24 offen offset:0 sc1
buffer_load_dwordx4 v[20:23], v118, s[4:7], s24 offen offset:1024 sc1
buffer_load_dwordx4 v[24:27], v118, s[4:7], s45 offen offset:0 sc1
buffer_load_dwordx4 v[28:31], v118, s[4:7], s45 offen offset:1024 sc1
buffer_load_dwordx4 v[32:35], v118, s[4:7], s46 offen offset:0 sc1
buffer_load_dwordx4 v[36:39], v118, s[4:7], s46 offen offset:1024 sc1
s_cmp_eq_u32 0, 0
s_branch RBfy_pchain
RB_second:
s_cmp_lg_u32 s30, 0
s_cbranch_scc1 RBg_slow
s_and_b32 s11, s8, 3
s_lshl_b32 s33, s11, 13
s_add_u32 s33, s33, 54525952
s_add_u32 s36, s33, s12
s_add_u32 s37, s33, s13
s_add_u32 s38, s33, s14
s_add_u32 s31, s8, 1
s_barrier
buffer_load_dwordx4 v[16:19], v118, s[4:7], s36 offen sc1
buffer_load_dwordx4 v[20:23], v118, s[4:7], s37 offen sc1
RBgx_loop:
s_and_b32 s11, s8, 3
s_add_u32 s31, s8, 1
s_lshl_b32 s11, s11, 14
s_add_u32 s11, s11, 54591488
s_add_u32 s46, s11, 8192
s_add_u32 s22, s11, s48
s_add_u32 s23, s11, s49
s_add_u32 s24, s11, s50
s_add_u32 s45, s11, s51
s_and_b32 s11, s31, 3
s_lshl_b32 s11, s11, 13
s_add_u32 s27, s11, 54525952
s_xor_b32 s28, s27, 0x4000
v_mov_b32 v103, s31
v_mov_b64 v[96:97], 0
v_mov_b64 v[98:99], 0
RBgx_mload:
buffer_load_dwordx4 v[16:19], v118, s[4:7], s36 offen sc1
buffer_load_dwordx4 v[20:23], v118, s[4:7], s37 offen sc1
s_waitcnt vmcnt(2)
v_max3_u32 v100, v16, v17, v18
v_max3_u32 v100, v100, v19, v20
v_max3_u32 v100, v100, v21, v22
v_max_u32 v100, v100, v23
v_cmp_eq_u32 vcc, -1, v100
s_sub_u32 s19, s19, 1
s_cbranch_scc1 R_exit
s_cbranch_vccnz RBgx_mload
v_smfmac_f32_16x16x64_bf16 v[28:31], v[16:19], a[0:7], v119
ds_write_b128 v115, v[16:19]
v_smfmac_f32_16x16x64_bf16 v[32:35], v[16:19], a[56:63], v119
ds_write_b128 v114, v[20:23]
v_smfmac_f32_16x16x64_bf16 v[36:39], v[16:19], a[112:119], v119
v_smfmac_f32_16x16x64_bf16 v[40:43], v[16:19], a[168:175], v119
v_smfmac_f32_16x16x64_bf16 v[44:47], v[16:19], a[224:231], v119
v_smfmac_f32_16x16x64_bf16 v[48:51], v[16:19], v[144:151], v119
s_waitcnt lgkmcnt(0)
s_barrier
ds_read_b128 v[24:27], v113
v_smfmac_f32_16x16x64_bf16 v[52:55], v[16:19], v[200:207], v119
ds_read_b128 v[0:3], v112
v_smfmac_f32_16x16x64_bf16 v[28:31], v[20:23], a[8:15], v119
ds_read_b128 v[4:7], v111
v_smfmac_f32_16x16x64_bf16 v[32:35], v[20:23], a[64:71], v119
ds_read_b128 v[8:11], v110
v_smfmac_f32_16x16x64_bf16 v[36:39], v[20:23], a[120:127], v119
ds_read_b128 v[12:15], v109
v_smfmac_f32_16x16x64_bf16 v[40:43], v[20:23], a[176:183], v119
ds_read_b128 v[56:59], v107 offset:0
v_smfmac_f32_16x16x64_bf16 v[44:47], v[20:23], a[232:239], v119
ds_read_b128 v[60:63], v107 offset:1792
v_smfmac_f32_16x16x64_bf16 v[48:51], v[20:23], v[152:159], v119
ds_read_b128 v[64:67], v107 offset:3584
v_smfmac_f32_16x16x64_bf16 v[52:55], v[20:23], v[208:215], v119
ds_read_b128 v[68:71], v107 offset:5376
s_waitcnt lgkmcnt(8)
v_smfmac_f32_16x16x64_bf16 v[28:31], v[24:27], a[16:23], v119
ds_read_b128 v[72:75], v107 offset:7168
v_smfmac_f32_16x16x64_bf16 v[32:35], v[24:27], a[72:79], v119
ds_read_b128 v[76:79], v107 offset:8960
v_smfmac_f32_16x16x64_bf16 v[36:39], v[24:27], a[128:135], v119
ds_read_b128 v[80:83], v107 offset:10752
v_smfmac_f32_16x16x64_bf16 v[40:43], v[24:27], a[184:191], v119
ds_read_b128 v[84:87], v107 offset:12544
v_smfmac_f32_16x16x64_bf16 v[44:47], v[24:27], a[240:247], v119
ds_read_b128 v[88:91], v107 offset:14336
v_smfmac_f32_16x16x64_bf16 v[48:51], v[24:27], v[160:167], v119
ds_read_b128 v[92:95], v107 offset:16128
s_waitcnt vmcnt(0)
v_smfmac_f32_16x16x64_bf16 v[52:55], v[24:27], v[216:223], v119
s_waitcnt lgkmcnt(13)
v_smfmac_f32_16x16x64_bf16 v[28:31], v[0:3], a[24:31], v119
s_waitcnt lgkmcnt(12)
v_smfmac_f32_16x16x64_bf16 v[28:31], v[4:7], a[32:39], v119
s_waitcnt lgkmcnt(11)
v_smfmac_f32_16x16x64_bf16 v[28:31], v[8:11], a[40:47], v119
s_waitcnt lgkmcnt(10)
v_smfmac_f32_16x16x64_bf16 v[28:31], v[12:15], a[48:55], v119
v_smfmac_f32_16x16x64_bf16 v[32:35], v[0:3], a[80:87], v119
v_smfmac_f32_16x16x64_bf16 v[32:35], v[4:7], a[88:95], v119
v_add_f32 v100, v28, v30
v_smfmac_f32_16x16x64_bf16 v[32:35], v[8:11], a[96:103], v119
v_add_f32 v101, v29, v31
v_smfmac_f32_16x16x64_bf16 v[32:35], v[12:15], a[104:111], v119
v_cvt_pk_bf16_f32 v102, v100, v101
v_smfmac_f32_16x16x64_bf16 v[36:39], v[0:3], a[136:143], v119
ds_write_b32 v108, v102 offset:0
v_smfmac_f32_16x16x64_bf16 v[36:39], v[4:7], a[144:151], v119
v_add_f32 v100, v32, v34
v_smfmac_f32_16x16x64_bf16 v[36:39], v[8:11], a[152:159], v119
v_add_f32 v101, v33, v35
v_smfmac_f32_16x16x64_bf16 v[36:39], v[12:15], a[160:167], v119
v_cvt_pk_bf16_f32 v102, v100, v101
v_smfmac_f32_16x16x64_bf16 v[40:43], v[0:3], a[192:199], v119
ds_write_b32 v108, v102 offset:256
v_smfmac_f32_16x16x64_bf16 v[40:43], v[4:7], a[200:207], v119
v_add_f32 v100, v36, v38
v_smfmac_f32_16x16x64_bf16 v[40:43], v[8:11], a[208:215], v119
v_add_f32 v101, v37, v39
v_smfmac_f32_16x16x64_bf16 v[40:43], v[12:15], a[216:223], v119
v_cvt_pk_bf16_f32 v102, v100, v101
v_smfmac_f32_16x16x64_bf16 v[44:47], v[0:3], a[248:255], v119
ds_write_b32 v108, v102 offset:512
v_smfmac_f32_16x16x64_bf16 v[44:47], v[4:7], v[120:127], v119
v_add_f32 v100, v40, v42
v_smfmac_f32_16x16x64_bf16 v[44:47], v[8:11], v[128:135], v119
v_add_f32 v101, v41, v43
v_smfmac_f32_16x16x64_bf16 v[44:47], v[12:15], v[136:143], v119
v_cvt_pk_bf16_f32 v102, v100, v101
v_smfmac_f32_16x16x64_bf16 v[48:51], v[0:3], v[168:175], v119
ds_write_b32 v108, v102 offset:768
v_smfmac_f32_16x16x64_bf16 v[48:51], v[4:7], v[176:183], v119
v_add_f32 v100, v44, v46
v_smfmac_f32_16x16x64_bf16 v[48:51], v[8:11], v[184:191], v119
v_add_f32 v101, v45, v47
v_smfmac_f32_16x16x64_bf16 v[48:51], v[12:15], v[192:199], v119
v_cvt_pk_bf16_f32 v102, v100, v101
v_smfmac_f32_16x16x64_bf16 v[52:55], v[0:3], v[224:231], v119
ds_write_b32 v108, v102 offset:4096
v_smfmac_f32_16x16x64_bf16 v[52:55], v[4:7], v[232:239], v119
v_add_f32 v100, v48, v50
v_smfmac_f32_16x16x64_bf16 v[52:55], v[8:11], v[240:247], v119
v_add_f32 v101, v49, v51
v_smfmac_f32_16x16x64_bf16 v[52:55], v[12:15], v[248:255], v119
v_cvt_pk_bf16_f32 v102, v100, v101
ds_write_b32 v108, v102 offset:4352
s_nop 5
v_add_f32 v100, v52, v54
v_add_f32 v101, v53, v55
v_cvt_pk_bf16_f32 v102, v100, v101
ds_write_b32 v108, v102 offset:4608
ds_read_b128 v[40:43], v107 offset:17920
ds_read_b128 v[44:47], v107 offset:19712
ds_read_b128 v[48:51], v107 offset:21504
ds_read_b128 v[52:55], v107 offset:23296
s_add_u32 s36, s27, s12
s_add_u32 s37, s27, s13
s_waitcnt lgkmcnt(0)
s_barrier
buffer_load_dwordx4 v[0:3], v118, s[4:7], s22 offen offset:0 sc1
buffer_load_dwordx4 v[4:7], v118, s[4:7], s22 offen offset:1024 sc1
buffer_load_dwordx4 v[8:11], v118, s[4:7], s23 offen offset:0 sc1
buffer_load_dwordx4 v[12:15], v118, s[4:7], s23 offen offset:1024 sc1
buffer_load_dwordx4 v[16:19], v118, s[4:7], s24 offen offset:0 sc1
buffer_load_dwordx4 v[20:23], v118, s[4:7], s24 offen offset:1024 sc1
buffer_load_dwordx4 v[24:27], v118, s[4:7], s45 offen offset:0 sc1
buffer_load_dwordx4 v[28:31], v118, s[4:7], s45 offen offset:1024 sc1
buffer_load_dwordx4 v[32:35], v118, s[4:7], s46 offen offset:0 sc1
buffer_load_dwordx4 v[36:39], v118, s[4:7], s46 offen offset:1024 sc1
s_cmp_eq_u32 0, 1
RBgx_pchain:
s_waitcnt vmcnt(9)
v_smfmac_f32_16x16x64_bf16 v[96:99], v[0:3], v[56:63], v119
ds_read_b128 v[56:59], v107 offset:25088
ds_read_b128 v[60:63], v107 offset:26880
s_waitcnt vmcnt(8)
v_smfmac_f32_16x16x64_bf16 v[96:99], v[4:7], v[64:71], v119
ds_read_b128 v[64:67], v106 offset:0
ds_read_b128 v[68:71], v106 offset:1024
s_waitcnt vmcnt(7)
v_smfmac_f32_16x16x64_bf16 v[96:99], v[8:11], v[72:79], v119
ds_read_b128 v[72:75], v106 offset:2048
ds_read_b128 v[76:79], v106 offset:3072
s_waitcnt vmcnt(6)
v_smfmac_f32_16x16x64_bf16 v[96:99], v[12:15], v[80:87], v119
s_waitcnt vmcnt(5)
v_smfmac_f32_16x16x64_bf16 v[96:99], v[16:19], v[88:95], v119
s_waitcnt vmcnt(4)
v_smfmac_f32_16x16x64_bf16 v[96:99], v[20:23], v[40:47], v119
s_waitcnt vmcnt(3)
v_smfmac_f32_16x16x64_bf16 v[96:99], v[24:27], v[48:55], v119
s_waitcnt vmcnt(2) lgkmcnt(4)
v_smfmac_f32_16x16x64_bf16 v[96:99], v[28:31], v[56:63], v119
s_waitcnt vmcnt(1) lgkmcnt(2)
v_smfmac_f32_16x16x64_bf16 v[96:99], v[32:35], v[64:71], v119
s_waitcnt vmcnt(0) lgkmcnt(0)
v_smfmac_f32_16x16x64_bf16 v[96:99], v[36:39], v[72:79], v119
s_nop 7
v_add_f32 v100, v96, v98
v_add_f32 v101, v97, v99
v_cvt_pk_bf16_f32 v96, v100, v101
v_cmp_u_f32 vcc, v100, v101
s_nop 0
v_mov_b32_dpp v101, v96 quad_perm:[1,0,3,2] row_mask:0xf bank_mask:0xf
v_perm_b32 v100, v101, v96, v104
v_min_u32 v100, -2, v100
s_cbranch_vccnz RBgx_pretry
RBgx_pok:
buffer_store_dword v100, v105, s[4:7], s27 offen
s_barrier
buffer_load_dwordx4 v[16:19], v118, s[4:7], s36 offen sc1
buffer_load_dwordx4 v[20:23], v118, s[4:7], s37 offen sc1
s_cmp_eq_u32 s8, 62
s_cbranch_scc1 RBgx_last
v_mov_b32 v101, -1
buffer_store_dword v101, v105, s[4:7], s28 offen
v_mov_b64 v[28:29], 0
v_mov_b64 v[30:31], 0
v_mov_b64 v[32:33], 0
v_mov_b64 v[34:35], 0
v_mov_b64 v[36:37], 0
v_mov_b64 v[38:39], 0
v_mov_b64 v[40:41], 0
v_mov_b64 v[42:43], 0
v_mov_b64 v[44:45], 0
v_mov_b64 v[46:47], 0
v_mov_b64 v[48:49], 0
v_mov_b64 v[50:51], 0
v_mov_b64 v[52:53], 0
v_mov_b64 v[54:55], 0
s_add_u32 s47, s47, 0x8000
s_cmp_eq_u32 s47, 0x18000
s_cselect_b32 s47, 0, s47
v_add_u32 v107, s47, v116
s_mov_b32 s19, 524288
s_mov_b32 s8, s31
s_branch RBgx_loop
RBgx_last:
s_mov_b32 s11, 53928960
buffer_store_dword v100, v105, s[4:7], s11 offen sc1
RBgx_done:
s_endpgm
RBgx_mretry:
s_add_u32 s20, s20, 1
s_sub_u32 s19, s19, 8
s_cbranch_scc1 R_exit
s_waitcnt vmcnt(0) lgkmcnt(0)
v_mov_b64 v[28:29], 0
v_mov_b64 v[30:31], 0
v_mov_b64 v[32:33], 0
v_mov_b64 v[34:35], 0
v_mov_b64 v[36:37], 0
v_mov_b64 v[38:39], 0
v_mov_b64 v[40:41], 0
v_mov_b64 v[42:43], 0
v_mov_b64 v[44:45], 0
v_mov_b64 v[46:47], 0
v_mov_b64 v[48:49], 0
v_mov_b64 v[50:51], 0
v_mov_b64 v[52:53], 0
v_mov_b64 v[54:55], 0
s_branch RBgx_mload
RBgx_pretry:
s_waitcnt vmcnt(0) lgkmcnt(0)
v_max3_u32 v102, v0, v1, v2
v_max3_u32 v102, v102, v3, v4
v_max3_u32 v102, v102, v5, v6
v_max3_u32 v102, v102, v7, v8
v_max3_u32 v102, v102, v9, v10
v_max3_u32 v102, v102, v11, v12
v_max3_u32 v102, v102, v13, v14
v_max3_u32 v102, v102, v15, v16
v_max3_u32 v102, v102, v17, v18
v_max3_u32 v102, v102, v19, v20
v_max3_u32 v102, v102, v21, v22
v_max3_u32 v102, v102, v23, v24
v_max3_u32 v102, v102, v25, v26
v_max3_u32 v102, v102, v27, v28
v_max3_u32 v102, v102, v29, v30
v_max3_u32 v102, v102, v31, v32
v_max3_u32 v102, v102, v33, v34
v_max3_u32 v102, v102, v35, v36
v_max3_u32 v102, v102, v37, v38
v_max_u32 v102, v102, v39
v_cmp_eq_u32 vcc, -1, v102
s_cbranch_vccz RBgx_pok
s_add_u32 s20, s20, 0x10000
s_sub_u32 s19, s19, 8
s_cbranch_scc1 R_exit
ds_read_b128 v[56:59], v107 offset:0
ds_read_b128 v[60:63], v107 offset:1792
ds_read_b128 v[64:67], v107 offset:3584
ds_read_b128 v[68:71], v107 offset:5376
ds_read_b128 v[72:75], v107 offset:7168
ds_read_b128 v[76:79], v107 offset:8960
v_mov_b64 v[96:97], 0
v_mov_b64 v[98:99], 0
s_waitcnt lgkmcnt(0)
buffer_load_dwordx4 v[0:3], v118, s[4:7], s22 offen offset:0 sc1
buffer_load_dwordx4 v[4:7], v118, s[4:7], s22 offen offset:1024 sc1
buffer_load_dwordx4 v[8:11], v118, s[4:7], s23 offen offset:0 sc1
buffer_load_dwordx4 v[12:15], v118, s[4:7], s23 offen offset:1024 sc1
buffer_load_dwordx4 v[16:19], v118, s[4:7], s24 offen offset:0 sc1
buffer_load_dwordx4 v[20:23], v118, s[4:7], s24 offen offset:1024 sc1
buffer_load_dwordx4 v[24:27], v118, s[4:7], s45 offen offset:0 sc1
buffer_load_dwordx4 v[28:31], v118, s[4:7], s45 offen offset:1024 sc1
buffer_load_dwordx4 v[32:35], v118, s[4:7], s46 offen offset:0 sc1
buffer_load_dwordx4 v[36:39], v118, s[4:7], s46 offen offset:1024 sc1
s_cmp_eq_u32 0, 0
s_branch RBgx_pchain
RBg_slow:
s_and_b32 s11, s8, 3
s_lshl_b32 s33, s11, 13
s_add_u32 s33, s33, 54525952
s_add_u32 s36, s33, s12
s_add_u32 s37, s33, s13
s_add_u32 s38, s33, s14
s_add_u32 s31, s8, 1
s_barrier
buffer_load_dwordx4 v[16:19], v118, s[4:7], s36 offen sc1
buffer_load_dwordx4 v[20:23], v118, s[4:7], s37 offen sc1
RBgy_loop:
s_and_b32 s11, s8, 3
s_add_u32 s31, s8, 1
s_lshl_b32 s11, s11, 14
s_add_u32 s11, s11, 54591488
s_add_u32 s46, s11, 8192
s_add_u32 s22, s11, s48
s_add_u32 s23, s11, s49
s_add_u32 s24, s11, s50
s_add_u32 s45, s11, s51
s_and_b32 s11, s31, 3
s_lshl_b32 s11, s11, 13
s_add_u32 s27, s11, 54525952
s_xor_b32 s28, s27, 0x4000
v_mov_b32 v103, s31
v_mov_b64 v[96:97], 0
v_mov_b64 v[98:99], 0
RBgy_mload:
buffer_load_dwordx4 v[16:19], v118, s[4:7], s36 offen sc1
buffer_load_dwordx4 v[20:23], v118, s[4:7], s37 offen sc1
s_waitcnt vmcnt(2)
v_max3_u32 v100, v16, v17, v18
v_max3_u32 v100, v100, v19, v20
v_max3_u32 v100, v100, v21, v22
v_max_u32 v100, v100, v23
v_cmp_eq_u32 vcc, -1, v100
s_sub_u32 s19, s19, 1
s_cbranch_scc1 R_exit
s_cbranch_vccnz RBgy_mload
v_smfmac_f32_16x16x64_bf16 v[28:31], v[16:19], a[0:7], v119
ds_write_b128 v115, v[16:19]
v_smfmac_f32_16x16x64_bf16 v[32:35], v[16:19], a[56:63], v119
ds_write_b128 v114, v[20:23]
v_smfmac_f32_16x16x64_bf16 v[36:39], v[16:19], a[112:119], v119
v_smfmac_f32_16x16x64_bf16 v[40:43], v[16:19], a[168:175], v119
v_smfmac_f32_16x16x64_bf16 v[44:47], v[16:19], a[224:231], v119
v_smfmac_f32_16x16x64_bf16 v[48:51], v[16:19], v[144:151], v119
s_waitcnt lgkmcnt(0)
s_barrier
ds_read_b128 v[24:27], v113
v_smfmac_f32_16x16x64_bf16 v[52:55], v[16:19], v[200:207], v119
ds_read_b128 v[0:3], v112
v_smfmac_f32_16x16x64_bf16 v[28:31], v[20:23], a[8:15], v119
ds_read_b128 v[4:7], v111
v_smfmac_f32_16x16x64_bf16 v[32:35], v[20:23], a[64:71], v119
ds_read_b128 v[8:11], v110
v_smfmac_f32_16x16x64_bf16 v[36:39], v[20:23], a[120:127], v119
ds_read_b128 v[12:15], v109
v_smfmac_f32_16x16x64_bf16 v[40:43], v[20:23], a[176:183], v119
ds_read_b128 v[56:59], v107 offset:0
v_smfmac_f32_16x16x64_bf16 v[44:47], v[20:23], a[232:239], v119
ds_read_b128 v[60:63], v107 offset:1792
v_smfmac_f32_16x16x64_bf16 v[48:51], v[20:23], v[152:159], v119
ds_read_b128 v[64:67], v107 offset:3584
v_smfmac_f32_16x16x64_bf16 v[52:55], v[20:23], v[208:215], v119
ds_read_b128 v[68:71], v107 offset:5376
s_waitcnt lgkmcnt(8)
v_smfmac_f32_16x16x64_bf16 v[28:31], v[24:27], a[16:23], v119
ds_read_b128 v[72:75], v107 offset:7168
v_smfmac_f32_16x16x64_bf16 v[32:35], v[24:27], a[72:79], v119
ds_read_b128 v[76:79], v107 offset:8960
v_smfmac_f32_16x16x64_bf16 v[36:39], v[24:27], a[128:135], v119
ds_read_b128 v[80:83], v107 offset:10752
v_smfmac_f32_16x16x64_bf16 v[40:43], v[24:27], a[184:191], v119
ds_read_b128 v[84:87], v107 offset:12544
v_smfmac_f32_16x16x64_bf16 v[44:47], v[24:27], a[240:247], v119
ds_read_b128 v[88:91], v107 offset:14336
v_smfmac_f32_16x16x64_bf16 v[48:51], v[24:27], v[160:167], v119
ds_read_b128 v[92:95], v107 offset:16128
s_waitcnt vmcnt(0)
v_smfmac_f32_16x16x64_bf16 v[52:55], v[24:27], v[216:223], v119
s_waitcnt lgkmcnt(13)
v_smfmac_f32_16x16x64_bf16 v[28:31], v[0:3], a[24:31], v119
s_waitcnt lgkmcnt(12)
v_smfmac_f32_16x16x64_bf16 v[28:31], v[4:7], a[32:39], v119
s_waitcnt lgkmcnt(11)
v_smfmac_f32_16x16x64_bf16 v[28:31], v[8:11], a[40:47], v119
s_waitcnt lgkmcnt(10)
v_smfmac_f32_16x16x64_bf16 v[28:31], v[12:15], a[48:55], v119
v_smfmac_f32_16x16x64_bf16 v[32:35], v[0:3], a[80:87], v119
v_smfmac_f32_16x16x64_bf16 v[32:35], v[4:7], a[88:95], v119
v_add_f32 v100, v28, v30
v_smfmac_f32_16x16x64_bf16 v[32:35], v[8:11], a[96:103], v119
v_add_f32 v101, v29, v31
v_smfmac_f32_16x16x64_bf16 v[32:35], v[12:15], a[104:111], v119
v_cvt_pk_bf16_f32 v102, v100, v101
v_smfmac_f32_16x16x64_bf16 v[36:39], v[0:3], a[136:143], v119
ds_write_b32 v108, v102 offset:0
v_smfmac_f32_16x16x64_bf16 v[36:39], v[4:7], a[144:151], v119
v_add_f32 v100, v32, v34
v_smfmac_f32_16x16x64_bf16 v[36:39], v[8:11], a[152:159], v119
v_add_f32 v101, v33, v35
v_smfmac_f32_16x16x64_bf16 v[36:39], v[12:15], a[160:167], v119
v_cvt_pk_bf16_f32 v102, v100, v101
v_smfmac_f32_16x16x64_bf16 v[40:43], v[0:3], a[192:199], v119
ds_write_b32 v108, v102 offset:256
v_smfmac_f32_16x16x64_bf16 v[40:43], v[4:7], a[200:207], v119
v_add_f32 v100, v36, v38
v_smfmac_f32_16x16x64_bf16 v[40:43], v[8:11], a[208:215], v119
v_add_f32 v101, v37, v39
v_smfmac_f32_16x16x64_bf16 v[40:43], v[12:15], a[216:223], v119
v_cvt_pk_bf16_f32 v102, v100, v101
v_smfmac_f32_16x16x64_bf16 v[44:47], v[0:3], a[248:255], v119
ds_write_b32 v108, v102 offset:512
v_smfmac_f32_16x16x64_bf16 v[44:47], v[4:7], v[120:127], v119
v_add_f32 v100, v40, v42
v_smfmac_f32_16x16x64_bf16 v[44:47], v[8:11], v[128:135], v119
v_add_f32 v101, v41, v43
v_smfmac_f32_16x16x64_bf16 v[44:47], v[12:15], v[136:143], v119
v_cvt_pk_bf16_f32 v102, v100, v101
v_smfmac_f32_16x16x64_bf16 v[48:51], v[0:3], v[168:175], v119
ds_write_b32 v108, v102 offset:768
v_smfmac_f32_16x16x64_bf16 v[48:51], v[4:7], v[176:183], v119
v_add_f32 v100, v44, v46
v_smfmac_f32_16x16x64_bf16 v[48:51], v[8:11], v[184:191], v119
v_add_f32 v101, v45, v47
v_smfmac_f32_16x16x64_bf16 v[48:51], v[12:15], v[192:199], v119
v_cvt_pk_bf16_f32 v102, v100, v101
v_smfmac_f32_16x16x64_bf16 v[52:55], v[0:3], v[224:231], v119
ds_write_b32 v108, v102 offset:4096
v_smfmac_f32_16x16x64_bf16 v[52:55], v[4:7], v[232:239], v119
v_add_f32 v100, v48, v50
v_smfmac_f32_16x16x64_bf16 v[52:55], v[8:11], v[240:247], v119
v_add_f32 v101, v49, v51
v_smfmac_f32_16x16x64_bf16 v[52:55], v[12:15], v[248:255], v119
v_cvt_pk_bf16_f32 v102, v100, v101
ds_write_b32 v108, v102 offset:4352
s_nop 5
v_add_f32 v100, v52, v54
v_add_f32 v101, v53, v55
v_cvt_pk_bf16_f32 v102, v100, v101
ds_write_b32 v108, v102 offset:4608
ds_read_b128 v[40:43], v107 offset:17920
ds_read_b128 v[44:47], v107 offset:19712
ds_read_b128 v[48:51], v107 offset:21504
ds_read_b128 v[52:55], v107 offset:23296
s_add_u32 s36, s27, s12
s_add_u32 s37, s27, s13
s_waitcnt lgkmcnt(0)
s_barrier
buffer_load_dwordx4 v[0:3], v118, s[4:7], s22 offen offset:0 sc1
buffer_load_dwordx4 v[4:7], v118, s[4:7], s22 offen offset:1024 sc1
buffer_load_dwordx4 v[8:11], v118, s[4:7], s23 offen offset:0 sc1
buffer_load_dwordx4 v[12:15], v118, s[4:7], s23 offen offset:1024 sc1
buffer_load_dwordx4 v[16:19], v118, s[4:7], s24 offen offset:0 sc1
buffer_load_dwordx4 v[20:23], v118, s[4:7], s24 offen offset:1024 sc1
buffer_load_dwordx4 v[24:27], v118, s[4:7], s45 offen offset:0 sc1
buffer_load_dwordx4 v[28:31], v118, s[4:7], s45 offen offset:1024 sc1
buffer_load_dwordx4 v[32:35], v118, s[4:7], s46 offen offset:0 sc1
buffer_load_dwordx4 v[36:39], v118, s[4:7], s46 offen offset:1024 sc1
s_cmp_eq_u32 0, 1
RBgy_pchain:
s_waitcnt vmcnt(9)
v_smfmac_f32_16x16x64_bf16 v[96:99], v[0:3], v[56:63], v119
ds_read_b128 v[56:59], v107 offset:25088
ds_read_b128 v[60:63], v107 offset:26880
s_waitcnt vmcnt(8)
v_smfmac_f32_16x16x64_bf16 v[96:99], v[4:7], v[64:71], v119
ds_read_b128 v[64:67], v106 offset:0
ds_read_b128 v[68:71], v106 offset:1024
s_waitcnt vmcnt(7)
v_smfmac_f32_16x16x64_bf16 v[96:99], v[8:11], v[72:79], v119
ds_read_b128 v[72:75], v106 offset:2048
ds_read_b128 v[76:79], v106 offset:3072
s_waitcnt vmcnt(6)
v_smfmac_f32_16x16x64_bf16 v[96:99], v[12:15], v[80:87], v119
s_waitcnt vmcnt(5)
v_smfmac_f32_16x16x64_bf16 v[96:99], v[16:19], v[88:95], v119
s_waitcnt vmcnt(4)
v_smfmac_f32_16x16x64_bf16 v[96:99], v[20:23], v[40:47], v119
s_waitcnt vmcnt(3)
v_smfmac_f32_16x16x64_bf16 v[96:99], v[24:27], v[48:55], v119
s_waitcnt vmcnt(2) lgkmcnt(4)
v_smfmac_f32_16x16x64_bf16 v[96:99], v[28:31], v[56:63], v119
s_waitcnt vmcnt(1) lgkmcnt(2)
v_smfmac_f32_16x16x64_bf16 v[96:99], v[32:35], v[64:71], v119
s_waitcnt vmcnt(0) lgkmcnt(0)
v_smfmac_f32_16x16x64_bf16 v[96:99], v[36:39], v[72:79], v119
s_nop 7
v_add_f32 v100, v96, v98
v_add_f32 v101, v97, v99
v_cvt_pk_bf16_f32 v96, v100, v101
v_cmp_u_f32 vcc, v100, v101
s_nop 0
v_mov_b32_dpp v101, v96 quad_perm:[1,0,3,2] row_mask:0xf bank_mask:0xf
v_perm_b32 v100, v101, v96, v104
v_min_u32 v100, -2, v100
s_cbranch_vccnz RBgy_pretry
RBgy_pok:
buffer_store_dword v100, v105, s[4:7], s27 offen sc1
s_barrier
buffer_load_dwordx4 v[16:19], v118, s[4:7], s36 offen sc1
buffer_load_dwordx4 v[20:23], v118, s[4:7], s37 offen sc1
s_cmp_eq_u32 s8, 62
s_cbranch_scc1 RBgy_last
v_mov_b32 v101, -1
buffer_store_dword v101, v105, s[4:7], s28 offen sc1
v_mov_b64 v[28:29], 0
v_mov_b64 v[30:31], 0
v_mov_b64 v[32:33], 0
v_mov_b64 v[34:35], 0
v_mov_b64 v[36:37], 0
v_mov_b64 v[38:39], 0
v_mov_b64 v[40:41], 0
v_mov_b64 v[42:43], 0
v_mov_b64 v[44:45], 0
v_mov_b64 v[46:47], 0
v_mov_b64 v[48:49], 0
v_mov_b64 v[50:51], 0
v_mov_b64 v[52:53], 0
v_mov_b64 v[54:55], 0
s_add_u32 s47, s47, 0x8000
s_cmp_eq_u32 s47, 0x18000
s_cselect_b32 s47, 0, s47
v_add_u32 v107, s47, v116
s_mov_b32 s19, 524288
s_mov_b32 s8, s31
s_branch RBgy_loop
RBgy_last:
s_mov_b32 s11, 53928960
buffer_store_dword v100, v105, s[4:7], s11 offen sc1
RBgy_done:
s_endpgm
RBgy_mretry:
s_add_u32 s20, s20, 1
s_sub_u32 s19, s19, 8
s_cbranch_scc1 R_exit
s_waitcnt vmcnt(0) lgkmcnt(0)
v_mov_b64 v[28:29], 0
v_mov_b64 v[30:31], 0
v_mov_b64 v[32:33], 0
v_mov_b64 v[34:35], 0
v_mov_b64 v[36:37], 0
v_mov_b64 v[38:39], 0
v_mov_b64 v[40:41], 0
v_mov_b64 v[42:43], 0
v_mov_b64 v[44:45], 0
v_mov_b64 v[46:47], 0
v_mov_b64 v[48:49], 0
v_mov_b64 v[50:51], 0
v_mov_b64 v[52:53], 0
v_mov_b64 v[54:55], 0
s_branch RBgy_mload
RBgy_pretry:
s_waitcnt vmcnt(0) lgkmcnt(0)
v_max3_u32 v102, v0, v1, v2
v_max3_u32 v102, v102, v3, v4
v_max3_u32 v102, v102, v5, v6
v_max3_u32 v102, v102, v7, v8
v_max3_u32 v102, v102, v9, v10
v_max3_u32 v102, v102, v11, v12
v_max3_u32 v102, v102, v13, v14
v_max3_u32 v102, v102, v15, v16
v_max3_u32 v102, v102, v17, v18
v_max3_u32 v102, v102, v19, v20
v_max3_u32 v102, v102, v21, v22
v_max3_u32 v102, v102, v23, v24
v_max3_u32 v102, v102, v25, v26
v_max3_u32 v102, v102, v27, v28
v_max3_u32 v102, v102, v29, v30
v_max3_u32 v102, v102, v31, v32
v_max3_u32 v102, v102, v33, v34
v_max3_u32 v102, v102, v35, v36
v_max3_u32 v102, v102, v37, v38
v_max_u32 v102, v102, v39
v_cmp_eq_u32 vcc, -1, v102
s_cbranch_vccz RBgy_pok
s_add_u32 s20, s20, 0x10000
s_sub_u32 s19, s19, 8
s_cbranch_scc1 R_exit
ds_read_b128 v[56:59], v107 offset:0
ds_read_b128 v[60:63], v107 offset:1792
ds_read_b128 v[64:67], v107 offset:3584
ds_read_b128 v[68:71], v107 offset:5376
ds_read_b128 v[72:75], v107 offset:7168
ds_read_b128 v[76:79], v107 offset:8960
v_mov_b64 v[96:97], 0
v_mov_b64 v[98:99], 0
s_waitcnt lgkmcnt(0)
buffer_load_dwordx4 v[0:3], v118, s[4:7], s22 offen offset:0 sc1
buffer_load_dwordx4 v[4:7], v118, s[4:7], s22 offen offset:1024 sc1
buffer_load_dwordx4 v[8:11], v118, s[4:7], s23 offen offset:0 sc1
buffer_load_dwordx4 v[12:15], v118, s[4:7], s23 offen offset:1024 sc1
buffer_load_dwordx4 v[16:19], v118, s[4:7], s24 offen offset:0 sc1
buffer_load_dwordx4 v[20:23], v118, s[4:7], s24 offen offset:1024 sc1
buffer_load_dwordx4 v[24:27], v118, s[4:7], s45 offen offset:0 sc1
buffer_load_dwordx4 v[28:31], v118, s[4:7], s45 offen offset:1024 sc1
buffer_load_dwordx4 v[32:35], v118, s[4:7], s46 offen offset:0 sc1
buffer_load_dwordx4 v[36:39], v118, s[4:7], s46 offen offset:1024 sc1
s_cmp_eq_u32 0, 0
s_branch RBgy_pchain
RB_loader:
v_add_u32 v54, 0, v0
v_mov_b32 v50, 0x2493
v_mul_lo_u32 v53, v54, v50
v_lshrrev_b32 v47, 18, v53
v_mov_b32 v53, 0x1c00
v_mul_lo_u32 v52, v47, v53
v_mov_b32 v46, s10
v_lshlrev_b32 v54, 4, v46
v_add_u32 v44, 0, v0
v_add_u32 v41, 0, v0
v_mov_b32 v55, 0x2493
v_mul_lo_u32 v48, v41, v55
v_lshrrev_b32 v51, 18, v48
v_mov_b32 v48, 28
v_mul_lo_u32 v45, v51, v48
v_sub_u32 v46, v44, v45
v_add_u32 v50, v54, v46
v_mov_b32 v44, s10
v_mov_b32 v48, 12
v_mul_lo_u32 v45, v44, v48
v_add_u32 v44, 0, v0
v_add_u32 v43, 0, v0
v_mov_b32 v42, 0x2493
v_mul_lo_u32 v41, v43, v42
v_lshrrev_b32 v55, 18, v41
v_mov_b32 v41, 28
v_mul_lo_u32 v51, v55, v41
v_sub_u32 v48, v44, v51
v_add_u32 v54, v45, v48
v_add_u32 v46, 0xf0, v54
v_add_u32 v48, 0, v0
v_add_u32 v41, 0, v0
v_mov_b32 v55, 0x2493
v_mul_lo_u32 v44, v41, v55
v_lshrrev_b32 v51, 18, v44
v_mov_b32 v44, 28
v_mul_lo_u32 v45, v51, v44
v_sub_u32 v54, v48, v45
v_mov_b32 v45, 16
v_cmp_lt_u32 vcc, v54, v45
s_nop 1
v_cndmask_b32 v47, v46, v50, vcc
v_lshlrev_b32 v53, 4, v47
v_add_u32 v49, v52, v53
v_add_u32 v89, 0x1000, v49
v_add_u32 v45, 64, v0
v_mov_b32 v54, 0x2493
v_mul_lo_u32 v47, v45, v54
v_lshrrev_b32 v52, 18, v47
v_mov_b32 v47, 0x1c00
v_mul_lo_u32 v53, v52, v47
v_mov_b32 v46, s10
v_lshlrev_b32 v45, 4, v46
v_add_u32 v50, 64, v0
v_add_u32 v55, 64, v0
v_mov_b32 v41, 0x2493
v_mul_lo_u32 v51, v55, v41
v_lshrrev_b32 v44, 18, v51
v_mov_b32 v51, 28
v_mul_lo_u32 v48, v44, v51
v_sub_u32 v46, v50, v48
v_add_u32 v54, v45, v46
v_mov_b32 v50, s10
v_mov_b32 v51, 12
v_mul_lo_u32 v48, v50, v51
v_add_u32 v50, 64, v0
v_add_u32 v42, 64, v0
v_mov_b32 v43, 0x2493
v_mul_lo_u32 v55, v42, v43
v_lshrrev_b32 v41, 18, v55
v_mov_b32 v55, 28
v_mul_lo_u32 v44, v41, v55
v_sub_u32 v51, v50, v44
v_add_u32 v45, v48, v51
v_add_u32 v46, 0xf0, v45
v_add_u32 v51, 64, v0
v_add_u32 v55, 64, v0
v_mov_b32 v41, 0x2493
v_mul_lo_u32 v50, v55, v41
v_lshrrev_b32 v44, 18, v50
v_mov_b32 v50, 28
v_mul_lo_u32 v48, v44, v50
v_sub_u32 v45, v51, v48
v_mov_b32 v48, 16
v_cmp_lt_u32 vcc, v45, v48
s_nop 1
v_cndmask_b32 v52, v46, v54, vcc
v_lshlrev_b32 v47, 4, v52
v_add_u32 v49, v53, v47
v_add_u32 v90, 0xc00, v49
v_add_u32 v48, 0x80, v0
v_mov_b32 v45, 0x2493
v_mul_lo_u32 v52, v48, v45
v_lshrrev_b32 v53, 18, v52
v_mov_b32 v52, 0x1c00
v_mul_lo_u32 v47, v53, v52
v_mov_b32 v46, s10
v_lshlrev_b32 v48, 4, v46
v_add_u32 v54, 0x80, v0
v_add_u32 v41, 0x80, v0
v_mov_b32 v55, 0x2493
v_mul_lo_u32 v44, v41, v55
v_lshrrev_b32 v50, 18, v44
v_mov_b32 v44, 28
v_mul_lo_u32 v51, v50, v44
v_sub_u32 v46, v54, v51
v_add_u32 v45, v48, v46
v_mov_b32 v54, s10
v_mov_b32 v44, 12
v_mul_lo_u32 v51, v54, v44
v_add_u32 v54, 0x80, v0
v_add_u32 v43, 0x80, v0
v_mov_b32 v42, 0x2493
v_mul_lo_u32 v41, v43, v42
v_lshrrev_b32 v55, 18, v41
v_mov_b32 v41, 28
v_mul_lo_u32 v50, v55, v41
v_sub_u32 v44, v54, v50
v_add_u32 v48, v51, v44
v_add_u32 v46, 0xf0, v48
v_add_u32 v44, 0x80, v0
v_add_u32 v41, 0x80, v0
v_mov_b32 v55, 0x2493
v_mul_lo_u32 v54, v41, v55
v_lshrrev_b32 v50, 18, v54
v_mov_b32 v54, 28
v_mul_lo_u32 v51, v50, v54
v_sub_u32 v48, v44, v51
v_mov_b32 v51, 16
v_cmp_lt_u32 vcc, v48, v51
s_nop 1
v_cndmask_b32 v53, v46, v45, vcc
v_lshlrev_b32 v52, 4, v53
v_add_u32 v49, v47, v52
v_add_u32 v91, 0x800, v49
v_add_u32 v51, 0xc0, v0
v_mov_b32 v48, 0x2493
v_mul_lo_u32 v53, v51, v48
v_lshrrev_b32 v47, 18, v53
v_mov_b32 v53, 0x1c00
v_mul_lo_u32 v52, v47, v53
v_mov_b32 v46, s10
v_lshlrev_b32 v51, 4, v46
v_add_u32 v45, 0xc0, v0
v_add_u32 v55, 0xc0, v0
v_mov_b32 v41, 0x2493
v_mul_lo_u32 v50, v55, v41
v_lshrrev_b32 v54, 18, v50
v_mov_b32 v50, 28
v_mul_lo_u32 v44, v54, v50
v_sub_u32 v46, v45, v44
v_add_u32 v48, v51, v46
v_mov_b32 v45, s10
v_mov_b32 v50, 12
v_mul_lo_u32 v44, v45, v50
v_add_u32 v45, 0xc0, v0
v_add_u32 v42, 0xc0, v0
v_mov_b32 v43, 0x2493
v_mul_lo_u32 v55, v42, v43
v_lshrrev_b32 v41, 18, v55
v_mov_b32 v55, 28
v_mul_lo_u32 v54, v41, v55
v_sub_u32 v50, v45, v54
v_add_u32 v51, v44, v50
v_add_u32 v46, 0xf0, v51
v_add_u32 v50, 0xc0, v0
v_add_u32 v55, 0xc0, v0
v_mov_b32 v41, 0x2493
v_mul_lo_u32 v45, v55, v41
v_lshrrev_b32 v54, 18, v45
v_mov_b32 v45, 28
v_mul_lo_u32 v44, v54, v45
v_sub_u32 v51, v50, v44
v_mov_b32 v44, 16
v_cmp_lt_u32 vcc, v51, v44
s_nop 1
v_cndmask_b32 v47, v46, v48, vcc
v_lshlrev_b32 v53, 4, v47
v_add_u32 v49, v52, v53
v_add_u32 v92, 0x400, v49
v_add_u32 v44, 0x100, v0
v_mov_b32 v51, 0x2493
v_mul_lo_u32 v47, v44, v51
v_lshrrev_b32 v52, 18, v47
v_mov_b32 v47, 0x1c00
v_mul_lo_u32 v53, v52, v47
v_mov_b32 v46, s10
v_lshlrev_b32 v44, 4, v46
v_add_u32 v48, 0x100, v0
v_add_u32 v41, 0x100, v0
v_mov_b32 v55, 0x2493
v_mul_lo_u32 v54, v41, v55
v_lshrrev_b32 v45, 18, v54
v_mov_b32 v54, 28
v_mul_lo_u32 v50, v45, v54
v_sub_u32 v46, v48, v50
v_add_u32 v51, v44, v46
v_mov_b32 v48, s10
v_mov_b32 v54, 12
v_mul_lo_u32 v50, v48, v54
v_add_u32 v48, 0x100, v0
v_add_u32 v43, 0x100, v0
v_mov_b32 v42, 0x2493
v_mul_lo_u32 v41, v43, v42
v_lshrrev_b32 v55, 18, v41
v_mov_b32 v41, 28
v_mul_lo_u32 v45, v55, v41
v_sub_u32 v54, v48, v45
v_add_u32 v44, v50, v54
v_add_u32 v46, 0xf0, v44
v_add_u32 v54, 0x100, v0
v_add_u32 v41, 0x100, v0
v_mov_b32 v55, 0x2493
v_mul_lo_u32 v48, v41, v55
v_lshrrev_b32 v45, 18, v48
v_mov_b32 v48, 28
v_mul_lo_u32 v50, v45, v48
v_sub_u32 v44, v54, v50
v_mov_b32 v50, 16
v_cmp_lt_u32 vcc, v44, v50
s_nop 1
v_cndmask_b32 v52, v46, v51, vcc
v_lshlrev_b32 v47, 4, v52
v_add_u32 v49, v53, v47
v_add_u32 v93, 0x1000, v49
v_add_u32 v50, 0x140, v0
v_mov_b32 v44, 0x2493
v_mul_lo_u32 v52, v50, v44
v_lshrrev_b32 v53, 18, v52
v_mov_b32 v52, 0x1c00
v_mul_lo_u32 v47, v53, v52
v_mov_b32 v46, s10
v_lshlrev_b32 v50, 4, v46
v_add_u32 v51, 0x140, v0
v_add_u32 v55, 0x140, v0
v_mov_b32 v41, 0x2493
v_mul_lo_u32 v45, v55, v41
v_lshrrev_b32 v48, 18, v45
v_mov_b32 v45, 28
v_mul_lo_u32 v54, v48, v45
v_sub_u32 v46, v51, v54
v_add_u32 v44, v50, v46
v_mov_b32 v51, s10
v_mov_b32 v45, 12
v_mul_lo_u32 v54, v51, v45
v_add_u32 v51, 0x140, v0
v_add_u32 v42, 0x140, v0
v_mov_b32 v43, 0x2493
v_mul_lo_u32 v55, v42, v43
v_lshrrev_b32 v41, 18, v55
v_mov_b32 v55, 28
v_mul_lo_u32 v48, v41, v55
v_sub_u32 v45, v51, v48
v_add_u32 v50, v54, v45
v_add_u32 v46, 0xf0, v50
v_add_u32 v45, 0x140, v0
v_add_u32 v55, 0x140, v0
v_mov_b32 v41, 0x2493
v_mul_lo_u32 v51, v55, v41
v_lshrrev_b32 v48, 18, v51
v_mov_b32 v51, 28
v_mul_lo_u32 v54, v48, v51
v_sub_u32 v50, v45, v54
v_mov_b32 v54, 16
v_cmp_lt_u32 vcc, v50, v54
s_nop 1
v_cndmask_b32 v53, v46, v44, vcc
v_lshlrev_b32 v52, 4, v53
v_add_u32 v49, v47, v52
v_add_u32 v94, 0xc00, v49
v_add_u32 v54, 0x180, v0
v_mov_b32 v50, 0x2493
v_mul_lo_u32 v53, v54, v50
v_lshrrev_b32 v47, 18, v53
v_mov_b32 v53, 0x1c00
v_mul_lo_u32 v52, v47, v53
v_mov_b32 v46, s10
v_lshlrev_b32 v54, 4, v46
v_add_u32 v44, 0x180, v0
v_add_u32 v41, 0x180, v0
v_mov_b32 v55, 0x2493
v_mul_lo_u32 v48, v41, v55
v_lshrrev_b32 v51, 18, v48
v_mov_b32 v48, 28
v_mul_lo_u32 v45, v51, v48
v_sub_u32 v46, v44, v45
v_add_u32 v50, v54, v46
v_mov_b32 v44, s10
v_mov_b32 v48, 12
v_mul_lo_u32 v45, v44, v48
v_add_u32 v44, 0x180, v0
v_add_u32 v43, 0x180, v0
v_mov_b32 v42, 0x2493
v_mul_lo_u32 v41, v43, v42
v_lshrrev_b32 v55, 18, v41
v_mov_b32 v41, 28
v_mul_lo_u32 v51, v55, v41
v_sub_u32 v48, v44, v51
v_add_u32 v54, v45, v48
v_add_u32 v46, 0xf0, v54
v_add_u32 v48, 0x180, v0
v_add_u32 v41, 0x180, v0
v_mov_b32 v55, 0x2493
v_mul_lo_u32 v44, v41, v55
v_lshrrev_b32 v51, 18, v44
v_mov_b32 v44, 28
v_mul_lo_u32 v45, v51, v44
v_sub_u32 v54, v48, v45
v_mov_b32 v45, 16
v_cmp_lt_u32 vcc, v54, v45
s_nop 1
v_cndmask_b32 v47, v46, v50, vcc
v_lshlrev_b32 v53, 4, v47
v_add_u32 v49, v52, v53
v_add_u32 v95, 0x800, v49
v_and_b32 v52, 31, v0
v_lshlrev_b32 v53, 2, v52
v_add_u32 v49, 0x3420080, v53
v_and_b32 v47, 15, v0
v_lshlrev_b32 v52, 2, v47
v_add_u32 v53, 0x3428000, v52
v_mov_b32 v52, 3
v_cmp_lt_u32 vcc, s9, v52
s_nop 1
v_cndmask_b32 v117, v53, v49, vcc
v_mov_b32 v49, s10
v_lshlrev_b32 v53, 2, v49
v_add_u32 v52, 0x3420000, v53
v_mov_b32 v53, 0x40000000
v_mov_b32 v54, s9
v_sub_u32 v45, 3, v54
v_lshlrev_b32 v47, 6, v45
v_add_u32 v49, v0, v47
v_mov_b32 v47, 1
v_cmp_lt_u32 vcc, v49, v47
s_nop 1
v_cndmask_b32 v116, v53, v52, vcc
v_mov_b32 v53, s10
v_lshlrev_b32 v49, 10, v53
v_lshlrev_b32 v53, 4, v0
v_add_u32 v47, v49, v53
v_mov_b32 v53, 0x40000000
v_mov_b32 v54, s9
v_sub_u32 v45, 3, v54
v_lshlrev_b32 v52, 4, v45
v_add_u32 v49, s10, v52
v_mov_b32 v52, 7
v_cmp_lt_u32 vcc, v49, v52
s_nop 1
v_cndmask_b32 v107, v53, v47, vcc
v_mov_b32 v47, 7
v_and_b32 v53, s10, v47
v_lshlrev_b32 v49, 10, v53
v_add_u32 v52, 0x20000, v49
v_lshlrev_b32 v49, 4, v0
v_add_u32 v88, v52, v49
v_mov_b32 v50, s10
v_lshlrev_b32 v46, 1, v50
v_add_u32 v54, s9, v46
v_mov_b32 v46, 2
v_sub_u32 v45, v54, v46
v_mov_b32 v46, 7
v_mul_lo_u32 v47, v45, v46
v_add_u32 v53, v47, v0
v_lshlrev_b32 v52, 7, v53
v_add_u32 v49, 0xe000, v52
v_mov_b32 v53, 0x40000000
v_mov_b32 v47, 0x3430100
v_mov_b32 v46, 63
v_cmp_lt_u32 vcc, v0, v46
s_nop 1
v_cndmask_b32 v52, v47, v53, vcc
v_mov_b32 v46, 7
v_cmp_lt_u32 vcc, v0, v46
s_nop 1
v_cndmask_b32 v99, v52, v49, vcc
v_mov_b32 v46, 0x7000
v_mov_b32 v52, 0x80
v_mov_b32 v49, 63
v_cmp_lt_u32 vcc, v0, v49
s_nop 1
v_cndmask_b32 v98, v52, v46, vcc
v_mov_b32 v97, 16
s_sub_u32 s11, s9, 2
s_mul_i32 s23, s11, 14336
s_cmp_eq_u32 s11, 0
s_cselect_b32 s24, s48, s50
s_cselect_b32 s45, s49, s51
s_mul_i32 s24, s24, 56
s_add_u32 s24, s24, 16773120
s_mul_i32 s45, s45, 56
s_add_u32 s45, s45, 16773120
s_mul_i32 s11, s12, 56
s_add_u32 s11, s11, 9437184
buffer_load_dwordx4 a[0:3], v20, s[4:7], s11 offen
s_mul_i32 s11, s12, 56
s_add_u32 s11, s11, 9465856
buffer_load_dwordx4 a[4:7], v20, s[4:7], s11 offen
s_mul_i32 s11, s13, 56
s_add_u32 s11, s11, 9437184
buffer_load_dwordx4 a[8:11], v20, s[4:7], s11 offen
s_mul_i32 s11, s13, 56
s_add_u32 s11, s11, 9465856
buffer_load_dwordx4 a[12:15], v20, s[4:7], s11 offen
s_mul_i32 s11, s14, 56
s_add_u32 s11, s11, 9437184
buffer_load_dwordx4 a[16:19], v20, s[4:7], s11 offen
s_mul_i32 s11, s14, 56
s_add_u32 s11, s11, 9465856
buffer_load_dwordx4 a[20:23], v20, s[4:7], s11 offen
s_mul_i32 s11, s15, 56
s_add_u32 s11, s11, 9437184
buffer_load_dwordx4 a[24:27], v20, s[4:7], s11 offen
s_mul_i32 s11, s15, 56
s_add_u32 s11, s11, 9465856
buffer_load_dwordx4 a[28:31], v20, s[4:7], s11 offen
s_mul_i32 s11, s16, 56
s_add_u32 s11, s11, 9437184
buffer_load_dwordx4 a[32:35], v20, s[4:7], s11 offen
s_mul_i32 s11, s16, 56
s_add_u32 s11, s11, 9465856
buffer_load_dwordx4 a[36:39], v20, s[4:7], s11 offen
s_mul_i32 s11, s17, 56
s_add_u32 s11, s11, 9437184
buffer_load_dwordx4 a[40:43], v20, s[4:7], s11 offen
s_mul_i32 s11, s17, 56
s_add_u32 s11, s11, 9465856
buffer_load_dwordx4 a[44:47], v20, s[4:7], s11 offen
s_mul_i32 s11, s18, 56
s_add_u32 s11, s11, 9437184
buffer_load_dwordx4 a[48:51], v20, s[4:7], s11 offen
s_mul_i32 s11, s18, 56
s_add_u32 s11, s11, 9465856
buffer_load_dwordx4 a[52:55], v20, s[4:7], s11 offen
s_mul_i32 s11, s12, 56
s_add_u32 s11, s11, 9437184
buffer_load_dwordx4 a[56:59], v21, s[4:7], s11 offen
s_mul_i32 s11, s12, 56
s_add_u32 s11, s11, 9465856
buffer_load_dwordx4 a[60:63], v21, s[4:7], s11 offen
s_waitcnt vmcnt(32)
s_mul_i32 s11, s13, 56
s_add_u32 s11, s11, 9437184
buffer_load_dwordx4 a[64:67], v21, s[4:7], s11 offen
s_mul_i32 s11, s13, 56
s_add_u32 s11, s11, 9465856
buffer_load_dwordx4 a[68:71], v21, s[4:7], s11 offen
s_mul_i32 s11, s14, 56
s_add_u32 s11, s11, 9437184
buffer_load_dwordx4 a[72:75], v21, s[4:7], s11 offen
s_mul_i32 s11, s14, 56
s_add_u32 s11, s11, 9465856
buffer_load_dwordx4 a[76:79], v21, s[4:7], s11 offen
s_mul_i32 s11, s15, 56
s_add_u32 s11, s11, 9437184
buffer_load_dwordx4 a[80:83], v21, s[4:7], s11 offen
s_mul_i32 s11, s15, 56
s_add_u32 s11, s11, 9465856
buffer_load_dwordx4 a[84:87], v21, s[4:7], s11 offen
s_mul_i32 s11, s16, 56
s_add_u32 s11, s11, 9437184
buffer_load_dwordx4 a[88:91], v21, s[4:7], s11 offen
s_mul_i32 s11, s16, 56
s_add_u32 s11, s11, 9465856
buffer_load_dwordx4 a[92:95], v21, s[4:7], s11 offen
s_mul_i32 s11, s17, 56
s_add_u32 s11, s11, 9437184
buffer_load_dwordx4 a[96:99], v21, s[4:7], s11 offen
s_mul_i32 s11, s17, 56
s_add_u32 s11, s11, 9465856
buffer_load_dwordx4 a[100:103], v21, s[4:7], s11 offen
s_mul_i32 s11, s18, 56
s_add_u32 s11, s11, 9437184
buffer_load_dwordx4 a[104:107], v21, s[4:7], s11 offen
s_mul_i32 s11, s18, 56
s_add_u32 s11, s11, 9465856
buffer_load_dwordx4 a[108:111], v21, s[4:7], s11 offen
s_mul_i32 s11, s12, 56
s_add_u32 s11, s11, 9437184
buffer_load_dwordx4 a[112:115], v22, s[4:7], s11 offen
s_mul_i32 s11, s12, 56
s_add_u32 s11, s11, 9465856
buffer_load_dwordx4 a[116:119], v22, s[4:7], s11 offen
s_mul_i32 s11, s13, 56
s_add_u32 s11, s11, 9437184
buffer_load_dwordx4 a[120:123], v22, s[4:7], s11 offen
s_mul_i32 s11, s13, 56
s_add_u32 s11, s11, 9465856
buffer_load_dwordx4 a[124:127], v22, s[4:7], s11 offen
s_waitcnt vmcnt(32)
s_mul_i32 s11, s14, 56
s_add_u32 s11, s11, 9437184
buffer_load_dwordx4 a[128:131], v22, s[4:7], s11 offen
s_mul_i32 s11, s14, 56
s_add_u32 s11, s11, 9465856
buffer_load_dwordx4 a[132:135], v22, s[4:7], s11 offen
s_mul_i32 s11, s15, 56
s_add_u32 s11, s11, 9437184
buffer_load_dwordx4 a[136:139], v22, s[4:7], s11 offen
s_mul_i32 s11, s15, 56
s_add_u32 s11, s11, 9465856
buffer_load_dwordx4 a[140:143], v22, s[4:7], s11 offen
s_mul_i32 s11, s16, 56
s_add_u32 s11, s11, 9437184
buffer_load_dwordx4 a[144:147], v22, s[4:7], s11 offen
s_mul_i32 s11, s16, 56
s_add_u32 s11, s11, 9465856
buffer_load_dwordx4 a[148:151], v22, s[4:7], s11 offen
s_mul_i32 s11, s17, 56
s_add_u32 s11, s11, 9437184
buffer_load_dwordx4 a[152:155], v22, s[4:7], s11 offen
s_mul_i32 s11, s17, 56
s_add_u32 s11, s11, 9465856
buffer_load_dwordx4 a[156:159], v22, s[4:7], s11 offen
s_mul_i32 s11, s18, 56
s_add_u32 s11, s11, 9437184
buffer_load_dwordx4 a[160:163], v22, s[4:7], s11 offen
s_mul_i32 s11, s18, 56
s_add_u32 s11, s11, 9465856
buffer_load_dwordx4 a[164:167], v22, s[4:7], s11 offen
s_mul_i32 s11, s12, 56
s_add_u32 s11, s11, 9437184
buffer_load_dwordx4 a[168:171], v23, s[4:7], s11 offen
s_mul_i32 s11, s12, 56
s_add_u32 s11, s11, 9465856
buffer_load_dwordx4 a[172:175], v23, s[4:7], s11 offen
s_mul_i32 s11, s13, 56
s_add_u32 s11, s11, 9437184
buffer_load_dwordx4 a[176:179], v23, s[4:7], s11 offen
s_mul_i32 s11, s13, 56
s_add_u32 s11, s11, 9465856
buffer_load_dwordx4 a[180:183], v23, s[4:7], s11 offen
s_mul_i32 s11, s14, 56
s_add_u32 s11, s11, 9437184
buffer_load_dwordx4 a[184:187], v23, s[4:7], s11 offen
s_mul_i32 s11, s14, 56
s_add_u32 s11, s11, 9465856
buffer_load_dwordx4 a[188:191], v23, s[4:7], s11 offen
s_waitcnt vmcnt(32)
s_mul_i32 s11, s15, 56
s_add_u32 s11, s11, 9437184
buffer_load_dwordx4 a[192:195], v23, s[4:7], s11 offen
s_mul_i32 s11, s15, 56
s_add_u32 s11, s11, 9465856
buffer_load_dwordx4 a[196:199], v23, s[4:7], s11 offen
s_mul_i32 s11, s16, 56
s_add_u32 s11, s11, 9437184
buffer_load_dwordx4 a[200:203], v23, s[4:7], s11 offen
s_mul_i32 s11, s16, 56
s_add_u32 s11, s11, 9465856
buffer_load_dwordx4 a[204:207], v23, s[4:7], s11 offen
s_mul_i32 s11, s17, 56
s_add_u32 s11, s11, 9437184
buffer_load_dwordx4 a[208:211], v23, s[4:7], s11 offen
s_mul_i32 s11, s17, 56
s_add_u32 s11, s11, 9465856
buffer_load_dwordx4 a[212:215], v23, s[4:7], s11 offen
s_mul_i32 s11, s18, 56
s_add_u32 s11, s11, 9437184
buffer_load_dwordx4 a[216:219], v23, s[4:7], s11 offen
s_mul_i32 s11, s18, 56
s_add_u32 s11, s11, 9465856
buffer_load_dwordx4 a[220:223], v23, s[4:7], s11 offen
s_mul_i32 s11, s12, 56
s_add_u32 s11, s11, 9437184
buffer_load_dwordx4 a[224:227], v24, s[4:7], s11 offen
s_mul_i32 s11, s12, 56
s_add_u32 s11, s11, 9465856
buffer_load_dwordx4 a[228:231], v24, s[4:7], s11 offen
s_mul_i32 s11, s13, 56
s_add_u32 s11, s11, 9437184
buffer_load_dwordx4 a[232:235], v24, s[4:7], s11 offen
s_mul_i32 s11, s13, 56
s_add_u32 s11, s11, 9465856
buffer_load_dwordx4 a[236:239], v24, s[4:7], s11 offen
s_mul_i32 s11, s14, 56
s_add_u32 s11, s11, 9437184
buffer_load_dwordx4 a[240:243], v24, s[4:7], s11 offen
s_mul_i32 s11, s14, 56
s_add_u32 s11, s11, 9465856
buffer_load_dwordx4 a[244:247], v24, s[4:7], s11 offen
s_mul_i32 s11, s15, 56
s_add_u32 s11, s11, 9437184
buffer_load_dwordx4 a[248:251], v24, s[4:7], s11 offen
s_mul_i32 s11, s15, 56
s_add_u32 s11, s11, 9465856
buffer_load_dwordx4 a[252:255], v24, s[4:7], s11 offen
s_waitcnt vmcnt(32)
s_mul_i32 s11, s16, 56
s_add_u32 s11, s11, 9437184
buffer_load_dwordx4 v[120:123], v24, s[4:7], s11 offen
s_mul_i32 s11, s16, 56
s_add_u32 s11, s11, 9465856
buffer_load_dwordx4 v[124:127], v24, s[4:7], s11 offen
s_mul_i32 s11, s17, 56
s_add_u32 s11, s11, 9437184
buffer_load_dwordx4 v[128:131], v24, s[4:7], s11 offen
s_mul_i32 s11, s17, 56
s_add_u32 s11, s11, 9465856
buffer_load_dwordx4 v[132:135], v24, s[4:7], s11 offen
s_mul_i32 s11, s18, 56
s_add_u32 s11, s11, 9437184
buffer_load_dwordx4 v[136:139], v24, s[4:7], s11 offen
s_mul_i32 s11, s18, 56
s_add_u32 s11, s11, 9465856
buffer_load_dwordx4 v[140:143], v24, s[4:7], s11 offen
s_mul_i32 s11, s12, 56
s_add_u32 s11, s11, 9437184
buffer_load_dwordx4 v[144:147], v25, s[4:7], s11 offen
s_mul_i32 s11, s12, 56
s_add_u32 s11, s11, 9465856
buffer_load_dwordx4 v[148:151], v25, s[4:7], s11 offen
s_mul_i32 s11, s13, 56
s_add_u32 s11, s11, 9437184
buffer_load_dwordx4 v[152:155], v25, s[4:7], s11 offen
s_mul_i32 s11, s13, 56
s_add_u32 s11, s11, 9465856
buffer_load_dwordx4 v[156:159], v25, s[4:7], s11 offen
s_mul_i32 s11, s14, 56
s_add_u32 s11, s11, 9437184
buffer_load_dwordx4 v[160:163], v25, s[4:7], s11 offen
s_mul_i32 s11, s14, 56
s_add_u32 s11, s11, 9465856
buffer_load_dwordx4 v[164:167], v25, s[4:7], s11 offen
s_mul_i32 s11, s15, 56
s_add_u32 s11, s11, 9437184
buffer_load_dwordx4 v[168:171], v25, s[4:7], s11 offen
s_mul_i32 s11, s15, 56
s_add_u32 s11, s11, 9465856
buffer_load_dwordx4 v[172:175], v25, s[4:7], s11 offen
s_mul_i32 s11, s16, 56
s_add_u32 s11, s11, 9437184
buffer_load_dwordx4 v[176:179], v25, s[4:7], s11 offen
s_mul_i32 s11, s16, 56
s_add_u32 s11, s11, 9465856
buffer_load_dwordx4 v[180:183], v25, s[4:7], s11 offen
s_waitcnt vmcnt(32)
s_mul_i32 s11, s17, 56
s_add_u32 s11, s11, 9437184
buffer_load_dwordx4 v[184:187], v25, s[4:7], s11 offen
s_mul_i32 s11, s17, 56
s_add_u32 s11, s11, 9465856
buffer_load_dwordx4 v[188:191], v25, s[4:7], s11 offen
s_mul_i32 s11, s18, 56
s_add_u32 s11, s11, 9437184
buffer_load_dwordx4 v[192:195], v25, s[4:7], s11 offen
s_mul_i32 s11, s18, 56
s_add_u32 s11, s11, 9465856
buffer_load_dwordx4 v[196:199], v25, s[4:7], s11 offen
s_mul_i32 s11, s12, 56
s_add_u32 s11, s11, 9437184
buffer_load_dwordx4 v[200:203], v26, s[4:7], s11 offen
s_mul_i32 s11, s12, 56
s_add_u32 s11, s11, 9465856
buffer_load_dwordx4 v[204:207], v26, s[4:7], s11 offen
s_mul_i32 s11, s13, 56
s_add_u32 s11, s11, 9437184
buffer_load_dwordx4 v[208:211], v26, s[4:7], s11 offen
s_mul_i32 s11, s13, 56
s_add_u32 s11, s11, 9465856
buffer_load_dwordx4 v[212:215], v26, s[4:7], s11 offen
s_mul_i32 s11, s14, 56
s_add_u32 s11, s11, 9437184
buffer_load_dwordx4 v[216:219], v26, s[4:7], s11 offen
s_mul_i32 s11, s14, 56
s_add_u32 s11, s11, 9465856
buffer_load_dwordx4 v[220:223], v26, s[4:7], s11 offen
s_lshl_b32 s33, s3, 2
s_add_u32 s33, s33, s9
s_getpc_b64 s[56:57]
CT_4:
s_add_u32 s56, s56, M_rec-CT_4
s_addc_u32 s57, s57, (M_rec-CT_4)>>32
s_mov_b32 s58, M_end-M_rec
s_mov_b32 s59, 0x20000
s_lshl_b32 s11, s33, 9
v_lshlrev_b32 v2, 3, v0
buffer_load_dword v102, v2, s[56:59], s11 offen
s_mul_i32 s11, s15, 56
s_add_u32 s11, s11, 9437184
buffer_load_dwordx4 v[224:227], v26, s[4:7], s11 offen
s_mul_i32 s11, s15, 56
s_add_u32 s11, s11, 9465856
buffer_load_dwordx4 v[228:231], v26, s[4:7], s11 offen
s_mul_i32 s11, s16, 56
s_add_u32 s11, s11, 9437184
buffer_load_dwordx4 v[232:235], v26, s[4:7], s11 offen
s_mul_i32 s11, s16, 56
s_add_u32 s11, s11, 9465856
buffer_load_dwordx4 v[236:239], v26, s[4:7], s11 offen
s_mul_i32 s11, s17, 56
s_add_u32 s11, s11, 9437184
buffer_load_dwordx4 v[240:243], v26, s[4:7], s11 offen
s_mul_i32 s11, s17, 56
s_add_u32 s11, s11, 9465856
buffer_load_dwordx4 v[244:247], v26, s[4:7], s11 offen
s_waitcnt vmcnt(32)
s_mul_i32 s11, s18, 56
s_add_u32 s11, s11, 9437184
buffer_load_dwordx4 v[248:251], v26, s[4:7], s11 offen
s_mul_i32 s11, s18, 56
s_add_u32 s11, s11, 9465856
buffer_load_dwordx4 v[252:255], v26, s[4:7], s11 offen
v_mov_b64 v[28:29], 0
v_mov_b64 v[30:31], 0
v_mov_b64 v[32:33], 0
v_mov_b64 v[34:35], 0
v_mov_b64 v[36:37], 0
v_mov_b64 v[38:39], 0
v_mov_b64 v[40:41], 0
v_mov_b64 v[42:43], 0
v_mov_b64 v[44:45], 0
v_mov_b64 v[46:47], 0
v_mov_b64 v[48:49], 0
v_mov_b64 v[50:51], 0
v_mov_b64 v[52:53], 0
v_mov_b64 v[54:55], 0
s_mov_b32 s8, 0
s_mov_b32 s19, 524288
s_mov_b32 s20, 0
v_min_u32 v4, 1, v0
v_lshlrev_b32 v4, 7, v4
s_mov_b32 s11, 54722560
s_mov_b32 s19, 0x40000
RBl_fv:
buffer_load_dword v3, v4, s[4:7], s11 offen sc1
s_sub_u32 s19, s19, 1
s_cbranch_scc1 R_exit
s_waitcnt vmcnt(0)
v_cmp_gt_u32 vcc, 16, v3
s_cbranch_vccnz RBl_fv
s_mov_b32 s19, 524288
s_mov_b32 s25, s24
s_mov_b32 s44, s45
s_mov_b32 s26, s23
s_mov_b32 s47, 0
s_add_u32 m0, s26, 0
s_nop 0
buffer_load_dwordx4 v89, s[4:7], s25 offen offset:0  lds
buffer_load_dwordx4 v90, s[4:7], s25 offen offset:1024  lds
buffer_load_dwordx4 v91, s[4:7], s25 offen offset:2048  lds
buffer_load_dwordx4 v92, s[4:7], s25 offen offset:3072  lds
s_add_u32 m0, s26, 4096
s_nop 0
buffer_load_dwordx4 v93, s[4:7], s25 offen offset:0  lds
buffer_load_dwordx4 v94, s[4:7], s25 offen offset:1024  lds
buffer_load_dwordx4 v95, s[4:7], s25 offen offset:2048  lds
s_add_u32 m0, s26, 7168
s_nop 0
buffer_load_dwordx4 v89, s[4:7], s44 offen offset:0  lds
buffer_load_dwordx4 v90, s[4:7], s44 offen offset:1024  lds
buffer_load_dwordx4 v91, s[4:7], s44 offen offset:2048  lds
buffer_load_dwordx4 v92, s[4:7], s44 offen offset:3072  lds
s_add_u32 m0, s26, 11264
s_nop 0
buffer_load_dwordx4 v93, s[4:7], s44 offen offset:0  lds
buffer_load_dwordx4 v94, s[4:7], s44 offen offset:1024  lds
buffer_load_dwordx4 v95, s[4:7], s44 offen offset:2048  lds
s_cmp_lg_u32 s30, 0
s_cbranch_scc1 RBl_slow
RBlx_loop:
s_and_b32 s11, s8, 3
s_lshl_b32 s33, s11, 13
s_add_u32 s33, s33, 54525952
s_add_u32 s36, s33, s12
s_add_u32 s37, s33, s13
s_add_u32 s38, s33, s14
s_add_u32 s31, s8, 1
s_min_u32 s11, s31, 63
s_mul_i32 s11, s11, 458752
s_add_u32 s25, s11, s24
s_add_u32 s44, s11, s45
s_add_u32 s47, s47, 0x8000
s_cmp_eq_u32 s47, 0x18000
s_cselect_b32 s47, 0, s47
s_add_u32 s26, s47, s23
s_mul_i32 s29, s8, 7168
s_add_u32 s29, s29, 53477376
v_mov_b64 v[16:17], -1
v_mov_b64 v[18:19], -1
v_mov_b64 v[20:21], -1
v_mov_b64 v[22:23], -1
s_waitcnt vmcnt(0)
s_cmp_ge_u32 s8, 63
s_cbranch_scc1 RBlx_fok
RBlx_fchk:
v_readlane_b32 s11, v97, 63
s_nop 0
s_cmp_ge_u32 s11, 16
s_cbranch_scc1 RBlx_fok
s_lshl_b32 s11, s31, 7
s_add_u32 s11, s11, 54722560
buffer_load_dword v97, off, s[4:7], s11 sc1
s_sub_u32 s19, s19, 1
s_cbranch_scc1 R_exit
s_waitcnt vmcnt(0)
s_branch RBlx_fchk
RBlx_fok:
s_barrier
RBlx_mload:
buffer_load_dwordx4 v[16:19], v118, s[4:7], s36 offen sc1
buffer_load_dwordx4 v[20:23], v118, s[4:7], s37 offen sc1
s_waitcnt vmcnt(2)
v_max3_u32 v100, v16, v17, v18
v_max3_u32 v100, v100, v19, v20
v_max3_u32 v100, v100, v21, v22
v_max_u32 v100, v100, v23
v_cmp_eq_u32 vcc, -1, v100
s_sub_u32 s19, s19, 1
s_cbranch_scc1 R_exit
s_cbranch_vccnz RBlx_mload
s_add_u32 m0, s26, 0
s_nop 0
buffer_load_dwordx4 v89, s[4:7], s25 offen offset:0  lds
buffer_load_dwordx4 v90, s[4:7], s25 offen offset:1024  lds
v_smfmac_f32_16x16x64_bf16 v[28:31], v[16:19], a[0:7], v119
ds_write_b128 v115, v[16:19]
v_smfmac_f32_16x16x64_bf16 v[32:35], v[16:19], a[56:63], v119
ds_write_b128 v114, v[20:23]
buffer_load_dwordx4 v91, s[4:7], s25 offen offset:2048  lds
v_smfmac_f32_16x16x64_bf16 v[36:39], v[16:19], a[112:119], v119
buffer_load_dwordx4 v92, s[4:7], s25 offen offset:3072  lds
s_add_u32 m0, s26, 4096
v_smfmac_f32_16x16x64_bf16 v[40:43], v[16:19], a[168:175], v119
buffer_load_dwordx4 v93, s[4:7], s25 offen offset:0  lds
v_smfmac_f32_16x16x64_bf16 v[44:47], v[16:19], a[224:231], v119
buffer_load_dwordx4 v94, s[4:7], s25 offen offset:1024  lds
v_smfmac_f32_16x16x64_bf16 v[48:51], v[16:19], v[144:151], v119
s_waitcnt lgkmcnt(0)
s_barrier
ds_read_b128 v[24:27], v113
buffer_load_dwordx4 v95, s[4:7], s25 offen offset:2048  lds
s_add_u32 m0, s26, 7168
v_smfmac_f32_16x16x64_bf16 v[52:55], v[16:19], v[200:207], v119
ds_read_b128 v[0:3], v112
buffer_load_dwordx4 v89, s[4:7], s44 offen offset:0  lds
v_smfmac_f32_16x16x64_bf16 v[28:31], v[20:23], a[8:15], v119
ds_read_b128 v[4:7], v111
buffer_load_dwordx4 v90, s[4:7], s44 offen offset:1024  lds
v_smfmac_f32_16x16x64_bf16 v[32:35], v[20:23], a[64:71], v119
ds_read_b128 v[8:11], v110
buffer_load_dwordx4 v91, s[4:7], s44 offen offset:2048  lds
v_smfmac_f32_16x16x64_bf16 v[36:39], v[20:23], a[120:127], v119
ds_read_b128 v[12:15], v109
buffer_load_dwordx4 v92, s[4:7], s44 offen offset:3072  lds
s_add_u32 m0, s26, 11264
v_smfmac_f32_16x16x64_bf16 v[40:43], v[20:23], a[176:183], v119
buffer_load_dwordx4 v93, s[4:7], s44 offen offset:0  lds
ds_read_b128 v[56:59], v88
v_smfmac_f32_16x16x64_bf16 v[44:47], v[20:23], a[232:239], v119
buffer_load_dwordx4 v94, s[4:7], s44 offen offset:1024  lds
v_smfmac_f32_16x16x64_bf16 v[48:51], v[20:23], v[152:159], v119
buffer_load_dwordx4 v95, s[4:7], s44 offen offset:2048  lds
v_smfmac_f32_16x16x64_bf16 v[52:55], v[20:23], v[208:215], v119
buffer_load_dword v97, v99, s[4:7], 0 offen sc1
s_waitcnt lgkmcnt(5)
v_smfmac_f32_16x16x64_bf16 v[28:31], v[24:27], a[16:23], v119
v_smfmac_f32_16x16x64_bf16 v[32:35], v[24:27], a[72:79], v119
s_waitcnt lgkmcnt(0)
buffer_store_dwordx4 v[56:59], v107, s[4:7], s29 offen sc1
v_smfmac_f32_16x16x64_bf16 v[36:39], v[24:27], a[128:135], v119
v_smfmac_f32_16x16x64_bf16 v[40:43], v[24:27], a[184:191], v119
v_smfmac_f32_16x16x64_bf16 v[44:47], v[24:27], a[240:247], v119
v_smfmac_f32_16x16x64_bf16 v[48:51], v[24:27], v[160:167], v119
s_waitcnt vmcnt(16)
v_smfmac_f32_16x16x64_bf16 v[52:55], v[24:27], v[216:223], v119
v_smfmac_f32_16x16x64_bf16 v[28:31], v[0:3], a[24:31], v119
v_smfmac_f32_16x16x64_bf16 v[28:31], v[4:7], a[32:39], v119
v_smfmac_f32_16x16x64_bf16 v[28:31], v[8:11], a[40:47], v119
v_smfmac_f32_16x16x64_bf16 v[28:31], v[12:15], a[48:55], v119
v_smfmac_f32_16x16x64_bf16 v[32:35], v[0:3], a[80:87], v119
v_smfmac_f32_16x16x64_bf16 v[32:35], v[4:7], a[88:95], v119
v_add_f32 v100, v28, v30
v_smfmac_f32_16x16x64_bf16 v[32:35], v[8:11], a[96:103], v119
v_add_f32 v101, v29, v31
v_smfmac_f32_16x16x64_bf16 v[32:35], v[12:15], a[104:111], v119
v_cvt_pk_bf16_f32 v102, v100, v101
v_smfmac_f32_16x16x64_bf16 v[36:39], v[0:3], a[136:143], v119
ds_write_b32 v108, v102 offset:0
v_smfmac_f32_16x16x64_bf16 v[36:39], v[4:7], a[144:151], v119
v_add_f32 v100, v32, v34
v_smfmac_f32_16x16x64_bf16 v[36:39], v[8:11], a[152:159], v119
v_add_f32 v101, v33, v35
v_smfmac_f32_16x16x64_bf16 v[36:39], v[12:15], a[160:167], v119
v_cvt_pk_bf16_f32 v102, v100, v101
v_smfmac_f32_16x16x64_bf16 v[40:43], v[0:3], a[192:199], v119
ds_write_b32 v108, v102 offset:256
v_smfmac_f32_16x16x64_bf16 v[40:43], v[4:7], a[200:207], v119
v_add_f32 v100, v36, v38
v_smfmac_f32_16x16x64_bf16 v[40:43], v[8:11], a[208:215], v119
v_add_f32 v101, v37, v39
v_smfmac_f32_16x16x64_bf16 v[40:43], v[12:15], a[216:223], v119
v_cvt_pk_bf16_f32 v102, v100, v101
v_smfmac_f32_16x16x64_bf16 v[44:47], v[0:3], a[248:255], v119
ds_write_b32 v108, v102 offset:512
v_smfmac_f32_16x16x64_bf16 v[44:47], v[4:7], v[120:127], v119
v_add_f32 v100, v40, v42
v_smfmac_f32_16x16x64_bf16 v[44:47], v[8:11], v[128:135], v119
v_add_f32 v101, v41, v43
v_smfmac_f32_16x16x64_bf16 v[44:47], v[12:15], v[136:143], v119
v_cvt_pk_bf16_f32 v102, v100, v101
v_smfmac_f32_16x16x64_bf16 v[48:51], v[0:3], v[168:175], v119
ds_write_b32 v108, v102 offset:768
v_smfmac_f32_16x16x64_bf16 v[48:51], v[4:7], v[176:183], v119
v_add_f32 v100, v44, v46
v_smfmac_f32_16x16x64_bf16 v[48:51], v[8:11], v[184:191], v119
v_add_f32 v101, v45, v47
v_smfmac_f32_16x16x64_bf16 v[48:51], v[12:15], v[192:199], v119
v_cvt_pk_bf16_f32 v102, v100, v101
v_smfmac_f32_16x16x64_bf16 v[52:55], v[0:3], v[224:231], v119
ds_write_b32 v108, v102 offset:4096
v_smfmac_f32_16x16x64_bf16 v[52:55], v[4:7], v[232:239], v119
v_add_f32 v100, v48, v50
v_smfmac_f32_16x16x64_bf16 v[52:55], v[8:11], v[240:247], v119
v_add_f32 v101, v49, v51
v_smfmac_f32_16x16x64_bf16 v[52:55], v[12:15], v[248:255], v119
v_cvt_pk_bf16_f32 v102, v100, v101
ds_write_b32 v108, v102 offset:4352
s_nop 5
v_add_f32 v100, v52, v54
v_add_f32 v101, v53, v55
v_cvt_pk_bf16_f32 v102, v100, v101
ds_write_b32 v108, v102 offset:4608
s_waitcnt lgkmcnt(0)
v_mov_b64 v[28:29], 0
v_mov_b64 v[30:31], 0
v_mov_b64 v[32:33], 0
v_mov_b64 v[34:35], 0
v_mov_b64 v[36:37], 0
v_mov_b64 v[38:39], 0
v_mov_b64 v[40:41], 0
v_mov_b64 v[42:43], 0
v_mov_b64 v[44:45], 0
v_mov_b64 v[46:47], 0
v_mov_b64 v[48:49], 0
v_mov_b64 v[50:51], 0
v_mov_b64 v[52:53], 0
v_mov_b64 v[54:55], 0
v_mov_b32 v103, s31
v_add_u32 v99, v99, v98
s_barrier
s_cmp_eq_u32 s8, 62
s_cbranch_scc1 RBlx_done
s_mov_b32 s19, 524288
s_mov_b32 s8, s31
s_branch RBlx_loop
RBlx_done:
s_endpgm
RBlx_mretry:
s_add_u32 s20, s20, 1
s_sub_u32 s19, s19, 8
s_cbranch_scc1 R_exit
s_waitcnt vmcnt(0) lgkmcnt(0)
v_mov_b64 v[28:29], 0
v_mov_b64 v[30:31], 0
v_mov_b64 v[32:33], 0
v_mov_b64 v[34:35], 0
v_mov_b64 v[36:37], 0
v_mov_b64 v[38:39], 0
v_mov_b64 v[40:41], 0
v_mov_b64 v[42:43], 0
v_mov_b64 v[44:45], 0
v_mov_b64 v[46:47], 0
v_mov_b64 v[48:49], 0
v_mov_b64 v[50:51], 0
v_mov_b64 v[52:53], 0
v_mov_b64 v[54:55], 0
s_branch RBlx_mload
RBl_slow:
RBly_loop:
s_and_b32 s11, s8, 3
s_lshl_b32 s33, s11, 13
s_add_u32 s33, s33, 54525952
s_add_u32 s36, s33, s12
s_add_u32 s37, s33, s13
s_add_u32 s38, s33, s14
s_add_u32 s31, s8, 1
s_min_u32 s11, s31, 63
s_mul_i32 s11, s11, 458752
s_add_u32 s25, s11, s24
s_add_u32 s44, s11, s45
s_add_u32 s47, s47, 0x8000
s_cmp_eq_u32 s47, 0x18000
s_cselect_b32 s47, 0, s47
s_add_u32 s26, s47, s23
s_mul_i32 s29, s8, 7168
s_add_u32 s29, s29, 53477376
v_mov_b64 v[16:17], -1
v_mov_b64 v[18:19], -1
v_mov_b64 v[20:21], -1
v_mov_b64 v[22:23], -1
s_waitcnt vmcnt(0)
s_cmp_ge_u32 s8, 63
s_cbranch_scc1 RBly_fok
RBly_fchk:
v_readlane_b32 s11, v97, 63
s_nop 0
s_cmp_ge_u32 s11, 16
s_cbranch_scc1 RBly_fok
s_lshl_b32 s11, s31, 7
s_add_u32 s11, s11, 54722560
buffer_load_dword v97, off, s[4:7], s11 sc1
s_sub_u32 s19, s19, 1
s_cbranch_scc1 R_exit
s_waitcnt vmcnt(0)
s_branch RBly_fchk
RBly_fok:
s_barrier
RBly_mload:
buffer_load_dwordx4 v[16:19], v118, s[4:7], s36 offen sc1
buffer_load_dwordx4 v[20:23], v118, s[4:7], s37 offen sc1
s_waitcnt vmcnt(2)
v_max3_u32 v100, v16, v17, v18
v_max3_u32 v100, v100, v19, v20
v_max3_u32 v100, v100, v21, v22
v_max_u32 v100, v100, v23
v_cmp_eq_u32 vcc, -1, v100
s_sub_u32 s19, s19, 1
s_cbranch_scc1 R_exit
s_cbranch_vccnz RBly_mload
s_add_u32 m0, s26, 0
s_nop 0
buffer_load_dwordx4 v89, s[4:7], s25 offen offset:0  lds
buffer_load_dwordx4 v90, s[4:7], s25 offen offset:1024  lds
v_smfmac_f32_16x16x64_bf16 v[28:31], v[16:19], a[0:7], v119
ds_write_b128 v115, v[16:19]
v_smfmac_f32_16x16x64_bf16 v[32:35], v[16:19], a[56:63], v119
ds_write_b128 v114, v[20:23]
buffer_load_dwordx4 v91, s[4:7], s25 offen offset:2048  lds
v_smfmac_f32_16x16x64_bf16 v[36:39], v[16:19], a[112:119], v119
buffer_load_dwordx4 v92, s[4:7], s25 offen offset:3072  lds
s_add_u32 m0, s26, 4096
v_smfmac_f32_16x16x64_bf16 v[40:43], v[16:19], a[168:175], v119
buffer_load_dwordx4 v93, s[4:7], s25 offen offset:0  lds
v_smfmac_f32_16x16x64_bf16 v[44:47], v[16:19], a[224:231], v119
buffer_load_dwordx4 v94, s[4:7], s25 offen offset:1024  lds
v_smfmac_f32_16x16x64_bf16 v[48:51], v[16:19], v[144:151], v119
s_waitcnt lgkmcnt(0)
s_barrier
ds_read_b128 v[24:27], v113
buffer_load_dwordx4 v95, s[4:7], s25 offen offset:2048  lds
s_add_u32 m0, s26, 7168
v_smfmac_f32_16x16x64_bf16 v[52:55], v[16:19], v[200:207], v119
ds_read_b128 v[0:3], v112
buffer_load_dwordx4 v89, s[4:7], s44 offen offset:0  lds
v_smfmac_f32_16x16x64_bf16 v[28:31], v[20:23], a[8:15], v119
ds_read_b128 v[4:7], v111
buffer_load_dwordx4 v90, s[4:7], s44 offen offset:1024  lds
v_smfmac_f32_16x16x64_bf16 v[32:35], v[20:23], a[64:71], v119
ds_read_b128 v[8:11], v110
buffer_load_dwordx4 v91, s[4:7], s44 offen offset:2048  lds
v_smfmac_f32_16x16x64_bf16 v[36:39], v[20:23], a[120:127], v119
ds_read_b128 v[12:15], v109
buffer_load_dwordx4 v92, s[4:7], s44 offen offset:3072  lds
s_add_u32 m0, s26, 11264
v_smfmac_f32_16x16x64_bf16 v[40:43], v[20:23], a[176:183], v119
buffer_load_dwordx4 v93, s[4:7], s44 offen offset:0  lds
ds_read_b128 v[56:59], v88
v_smfmac_f32_16x16x64_bf16 v[44:47], v[20:23], a[232:239], v119
buffer_load_dwordx4 v94, s[4:7], s44 offen offset:1024  lds
v_smfmac_f32_16x16x64_bf16 v[48:51], v[20:23], v[152:159], v119
buffer_load_dwordx4 v95, s[4:7], s44 offen offset:2048  lds
v_smfmac_f32_16x16x64_bf16 v[52:55], v[20:23], v[208:215], v119
buffer_load_dword v97, v99, s[4:7], 0 offen sc1
s_waitcnt lgkmcnt(5)
v_smfmac_f32_16x16x64_bf16 v[28:31], v[24:27], a[16:23], v119
v_smfmac_f32_16x16x64_bf16 v[32:35], v[24:27], a[72:79], v119
s_waitcnt lgkmcnt(0)
buffer_store_dwordx4 v[56:59], v107, s[4:7], s29 offen sc1
v_smfmac_f32_16x16x64_bf16 v[36:39], v[24:27], a[128:135], v119
v_smfmac_f32_16x16x64_bf16 v[40:43], v[24:27], a[184:191], v119
v_smfmac_f32_16x16x64_bf16 v[44:47], v[24:27], a[240:247], v119
v_smfmac_f32_16x16x64_bf16 v[48:51], v[24:27], v[160:167], v119
s_waitcnt vmcnt(16)
v_smfmac_f32_16x16x64_bf16 v[52:55], v[24:27], v[216:223], v119
v_smfmac_f32_16x16x64_bf16 v[28:31], v[0:3], a[24:31], v119
v_smfmac_f32_16x16x64_bf16 v[28:31], v[4:7], a[32:39], v119
v_smfmac_f32_16x16x64_bf16 v[28:31], v[8:11], a[40:47], v119
v_smfmac_f32_16x16x64_bf16 v[28:31], v[12:15], a[48:55], v119
v_smfmac_f32_16x16x64_bf16 v[32:35], v[0:3], a[80:87], v119
v_smfmac_f32_16x16x64_bf16 v[32:35], v[4:7], a[88:95], v119
v_add_f32 v100, v28, v30
v_smfmac_f32_16x16x64_bf16 v[32:35], v[8:11], a[96:103], v119
v_add_f32 v101, v29, v31
v_smfmac_f32_16x16x64_bf16 v[32:35], v[12:15], a[104:111], v119
v_cvt_pk_bf16_f32 v102, v100, v101
v_smfmac_f32_16x16x64_bf16 v[36:39], v[0:3], a[136:143], v119
ds_write_b32 v108, v102 offset:0
v_smfmac_f32_16x16x64_bf16 v[36:39], v[4:7], a[144:151], v119
v_add_f32 v100, v32, v34
v_smfmac_f32_16x16x64_bf16 v[36:39], v[8:11], a[152:159], v119
v_add_f32 v101, v33, v35
v_smfmac_f32_16x16x64_bf16 v[36:39], v[12:15], a[160:167], v119
v_cvt_pk_bf16_f32 v102, v100, v101
v_smfmac_f32_16x16x64_bf16 v[40:43], v[0:3], a[192:199], v119
ds_write_b32 v108, v102 offset:256
v_smfmac_f32_16x16x64_bf16 v[40:43], v[4:7], a[200:207], v119
v_add_f32 v100, v36, v38
v_smfmac_f32_16x16x64_bf16 v[40:43], v[8:11], a[208:215], v119
v_add_f32 v101, v37, v39
v_smfmac_f32_16x16x64_bf16 v[40:43], v[12:15], a[216:223], v119
v_cvt_pk_bf16_f32 v102, v100, v101
v_smfmac_f32_16x16x64_bf16 v[44:47], v[0:3], a[248:255], v119
ds_write_b32 v108, v102 offset:512
v_smfmac_f32_16x16x64_bf16 v[44:47], v[4:7], v[120:127], v119
v_add_f32 v100, v40, v42
v_smfmac_f32_16x16x64_bf16 v[44:47], v[8:11], v[128:135], v119
v_add_f32 v101, v41, v43
v_smfmac_f32_16x16x64_bf16 v[44:47], v[12:15], v[136:143], v119
v_cvt_pk_bf16_f32 v102, v100, v101
v_smfmac_f32_16x16x64_bf16 v[48:51], v[0:3], v[168:175], v119
ds_write_b32 v108, v102 offset:768
v_smfmac_f32_16x16x64_bf16 v[48:51], v[4:7], v[176:183], v119
v_add_f32 v100, v44, v46
v_smfmac_f32_16x16x64_bf16 v[48:51], v[8:11], v[184:191], v119
v_add_f32 v101, v45, v47
v_smfmac_f32_16x16x64_bf16 v[48:51], v[12:15], v[192:199], v119
v_cvt_pk_bf16_f32 v102, v100, v101
v_smfmac_f32_16x16x64_bf16 v[52:55], v[0:3], v[224:231], v119
ds_write_b32 v108, v102 offset:4096
v_smfmac_f32_16x16x64_bf16 v[52:55], v[4:7], v[232:239], v119
v_add_f32 v100, v48, v50
v_smfmac_f32_16x16x64_bf16 v[52:55], v[8:11], v[240:247], v119
v_add_f32 v101, v49, v51
v_smfmac_f32_16x16x64_bf16 v[52:55], v[12:15], v[248:255], v119
v_cvt_pk_bf16_f32 v102, v100, v101
ds_write_b32 v108, v102 offset:4352
s_nop 5
v_add_f32 v100, v52, v54
v_add_f32 v101, v53, v55
v_cvt_pk_bf16_f32 v102, v100, v101
ds_write_b32 v108, v102 offset:4608
s_waitcnt lgkmcnt(0)
v_mov_b64 v[28:29], 0
v_mov_b64 v[30:31], 0
v_mov_b64 v[32:33], 0
v_mov_b64 v[34:35], 0
v_mov_b64 v[36:37], 0
v_mov_b64 v[38:39], 0
v_mov_b64 v[40:41], 0
v_mov_b64 v[42:43], 0
v_mov_b64 v[44:45], 0
v_mov_b64 v[46:47], 0
v_mov_b64 v[48:49], 0
v_mov_b64 v[50:51], 0
v_mov_b64 v[52:53], 0
v_mov_b64 v[54:55], 0
v_mov_b32 v103, s31
v_add_u32 v99, v99, v98
s_barrier
s_cmp_eq_u32 s8, 62
s_cbranch_scc1 RBly_done
s_mov_b32 s19, 524288
s_mov_b32 s8, s31
s_branch RBly_loop
RBly_done:
s_endpgm
RBly_mretry:
s_add_u32 s20, s20, 1
s_sub_u32 s19, s19, 8
s_cbranch_scc1 R_exit
s_waitcnt vmcnt(0) lgkmcnt(0)
v_mov_b64 v[28:29], 0
v_mov_b64 v[30:31], 0
v_mov_b64 v[32:33], 0
v_mov_b64 v[34:35], 0
v_mov_b64 v[36:37], 0
v_mov_b64 v[38:39], 0
v_mov_b64 v[40:41], 0
v_mov_b64 v[42:43], 0
v_mov_b64 v[44:45], 0
v_mov_b64 v[46:47], 0
v_mov_b64 v[48:49], 0
v_mov_b64 v[50:51], 0
v_mov_b64 v[52:53], 0
v_mov_b64 v[54:55], 0
s_branch RBly_mload
M_end:
.section .rodata,"a"
.p2align 6
.amdhsa_kernel recurrent_scan__memory_aug_recurrent_mem_tr__dense_activation_squared_relu__prompt_kernel
  .amdhsa_next_free_vgpr 512
  .amdhsa_next_free_sgpr 102
  .amdhsa_accum_offset 256
  .amdhsa_group_segment_fixed_size 0
  .amdhsa_kernarg_size 120
  .amdhsa_user_sgpr_count 2
  .amdhsa_user_sgpr_kernarg_segment_ptr 1
  .amdhsa_system_sgpr_workgroup_id_x 1
  .amdhsa_float_denorm_mode_32 3
.end_amdhsa_kernel
```
